```python
import torch

def _softmax(x, axis=-1):
    return torch.softmax(x, dim=axis)
def _gelu(x):
    return torch.nn.functional.gelu(x, approximate="tanh")
def _silu(x):
    return torch.nn.functional.silu(x)
def _sigmoid(x):
    return torch.sigmoid(x)
def _layernorm(x, axis=-1, eps=1e-5):
    m = x.mean(dim=axis, keepdim=True)
    v = x.var(dim=axis, keepdim=True, unbiased=False)
    return (x - m) / torch.sqrt(v + eps)
def _scatter_add(tgt, idx, src, axis=0):
    return tgt.clone().index_add_(axis, idx, src)
def _segment_sum(src, seg, n):
    out = torch.zeros((n,) + src.shape[1:], dtype=src.dtype)
    return out.index_add_(0, seg, src)
def _pad(x, pw):
    flat = tuple(v for pair in reversed(pw) for v in pair)
    return torch.nn.functional.pad(x, flat)

kernel_name = 'interleave_layers__linear_attn_block__moe_arch_mod__prompt'

def setup_inputs():

    _w = (lambda a: (lambda t: t.to(torch.bfloat16) if t.is_floating_point() else t)(torch.as_tensor(a)))
    def _A_setup():
        B, S, D = 1, 2048, 1024
        return {
            "x": _w((lambda *s: torch.randn(*s, dtype=torch.bfloat16) * 0.05)(B, S, D)),
            "wqkv": _w((lambda *s: torch.randn(*s, dtype=torch.bfloat16) * 0.05)(D, 3 * D)),
            "wo": _w((lambda *s: torch.randn(*s, dtype=torch.bfloat16) * 0.05)(D, D)),
        }
    _A_in = _A_setup()

    def _B_setup():
        B, S, D, F, C = 1, 2048, 1024, 3584, 8
        return {
            "x": _w((lambda *s: torch.randn(*s, dtype=torch.bfloat16) * 0.05)(B, S, D)),
            "w_r": _w((lambda *s: torch.randn(*s, dtype=torch.bfloat16) * 0.05)(D)),
            "w_gate": _w((lambda *s: torch.randn(*s, dtype=torch.bfloat16) * 0.05)(D, F)),
            "w_up": _w((lambda *s: torch.randn(*s, dtype=torch.bfloat16) * 0.05)(D, F)),
            "w_down": _w((lambda *s: torch.randn(*s, dtype=torch.bfloat16) * 0.05)(F, D)),
        }
    _B_in = _B_setup()

    return {
        "A_x": _A_in["x"],
        "A_wqkv": _A_in["wqkv"],
        "A_wo": _A_in["wo"],
        "B_x": _B_in["x"],
        "B_w_r": _B_in["w_r"],
        "B_w_gate": _B_in["w_gate"],
        "B_w_up": _B_in["w_up"],
        "B_w_down": _B_in["w_down"],
    }

def reference(A_x, A_wqkv, A_wo, B_x, B_w_r, B_w_gate, B_w_up, B_w_down):
    def _A_ref(x, wqkv, wo):
        B, S, D = x.shape
        H = 32; Dh = D // H
        qkv = (lambda x, *d: x.permute(*d))((x @ wqkv).reshape(B, S, 3, H, Dh), 2, 0, 3, 1, 4)
        q, k, v = qkv[0], qkv[1], qkv[2]
        phi = lambda t: torch.where(t > 0, t + 1, torch.exp(t)) + 1e-6
        pq, pk = phi(q), phi(k)
        kv = torch.einsum("bhsd,bhse->bhde", pk, v)
        z = torch.einsum("bhsd->bhd", pk)
        num = torch.einsum("bhqd,bhde->bhqe", pq, kv)
        den = torch.einsum("bhqd,bhd->bhq", pq, z)[..., None] + 1e-6
        o = num / den
        return (lambda x, *d: x.permute(*d))(o, 0, 2, 1, 3).reshape(B, S, D) @ wo

    def _B_ref(x, w_r, w_gate, w_up, w_down):
        B, S, D = x.shape
        C = 8
        r = x @ w_r
        idx = torch.argsort(-r, axis=-1)[:, :C]
        idx_e = (lambda x, n, axis: torch.repeat_interleave(x, n, dim=axis))(idx.reshape(B, C, 1), D, axis=2)
        x_sel = (lambda x, i, axis: torch.take_along_dim(x, i, dim=axis))(x, idx_e, axis=1)
        g = _silu(x_sel @ w_gate)
        u = x_sel @ w_up
        y = (g * u) @ w_down
        r_sel = _sigmoid((lambda x, i, axis: torch.take_along_dim(x, i, dim=axis))(r, idx, axis=1))
        y = y * r_sel.reshape(B, C, 1)
        b_off = (torch.arange(B) * S).reshape(B, 1)
        flat_idx = (idx + b_off).reshape(B * C)
        zero = (x * 0.0).reshape(B * S, D)
        upd = _scatter_add(zero, flat_idx, y.reshape(B * C, D), axis=0)
        return x + upd.reshape(B, S, D)

    x = A_x
    x = x + _A_ref(_layernorm(x, axis=-1), A_wqkv, A_wo)
    x = x + _B_ref(_layernorm(x, axis=-1), B_w_r, B_w_gate, B_w_up, B_w_down)
    x = x + _A_ref(_layernorm(x, axis=-1), A_wqkv, A_wo)
    x = x + _B_ref(_layernorm(x, axis=-1), B_w_r, B_w_gate, B_w_up, B_w_down)
    return x
```

```asm
; @launch kernel=ln0_kernel grid=(512,1,1) block=(256,1,1) lds=0
; @launch kernel=k1a_kernel grid=(256,1,1) block=(256,1,1) lds=163840
; @launch kernel=kmida_kernel grid=(256,1,1) block=(256,1,1) lds=8192
; @launch kernel=k2a_kernel grid=(256,1,1) block=(256,1,1) lds=98304
; @launch kernel=k3a_kernel grid=(224,1,1) block=(256,1,1) lds=73984
; @launch kernel=k4a_kernel grid=(224,1,1) block=(256,1,1) lds=40960
; @launch kernel=k5a_kernel grid=(512,1,1) block=(256,1,1) lds=0
; @launch kernel=k1b_kernel grid=(256,1,1) block=(256,1,1) lds=163840
; @launch kernel=kmidb_kernel grid=(256,1,1) block=(256,1,1) lds=8192
; @launch kernel=k2b_kernel grid=(256,1,1) block=(256,1,1) lds=98304
; @launch kernel=k3b_kernel grid=(224,1,1) block=(256,1,1) lds=73984
; @launch kernel=k4b_kernel grid=(224,1,1) block=(256,1,1) lds=40960
; @launch kernel=k5b_kernel grid=(512,1,1) block=(256,1,1) lds=0
.amdgcn_target "amdgcn-amd-amdhsa--gfx950"
.text
.globl ln0_kernel
.p2align 8
.type ln0_kernel,@function
ln0_kernel:
    s_cmp_ge_u32 s2, 512
    s_cbranch_scc1 L_end_ln0_kernel
    s_load_dwordx2 s[4:5], s[0:1], 80
    s_load_dwordx2 s[6:7], s[0:1], 0
    v_lshrrev_b32 v1, 6, v0
    v_and_b32 v2, 63, v0
    s_nop 0
    v_readfirstlane_b32 s3, v1
    s_lshl_b32 s20, s2, 2
    s_add_u32 s20, s20, s3
    s_lshl_b32 s21, s20, 11
    v_lshlrev_b32 v3, 4, v2
    s_waitcnt lgkmcnt(0)
    s_mov_b32 s8, s6
    s_mov_b32 s9, s7
    s_mov_b32 s10, 4194304
    s_mov_b32 s11, 0x00020000
    s_mov_b32 s12, s4
    s_mov_b32 s13, s5
    s_mov_b32 s14, 4194304
    s_mov_b32 s15, 0x00020000
    s_mov_b32 s16, s4
    s_mov_b32 s17, s5
    s_mov_b32 s18, 29360128
    s_mov_b32 s19, 0x00020000
    buffer_load_dwordx4 v[4:7], v3, s[8:11], s21 offen
    buffer_load_dwordx4 v[8:11], v3, s[8:11], s21 offen offset:1024
    s_waitcnt vmcnt(0)
    v_lshlrev_b32 v16, 16, v4
    v_and_b32 v17, 0xffff0000, v4
    v_lshlrev_b32 v18, 16, v5
    v_and_b32 v19, 0xffff0000, v5
    v_lshlrev_b32 v20, 16, v6
    v_and_b32 v21, 0xffff0000, v6
    v_lshlrev_b32 v22, 16, v7
    v_and_b32 v23, 0xffff0000, v7
    v_lshlrev_b32 v24, 16, v8
    v_and_b32 v25, 0xffff0000, v8
    v_lshlrev_b32 v26, 16, v9
    v_and_b32 v27, 0xffff0000, v9
    v_lshlrev_b32 v28, 16, v10
    v_and_b32 v29, 0xffff0000, v10
    v_lshlrev_b32 v30, 16, v11
    v_and_b32 v31, 0xffff0000, v11
    v_add_f32 v32, v16, v17
    v_add_f32 v32, v32, v18
    v_add_f32 v32, v32, v19
    v_add_f32 v32, v32, v20
    v_add_f32 v32, v32, v21
    v_add_f32 v32, v32, v22
    v_add_f32 v32, v32, v23
    v_add_f32 v32, v32, v24
    v_add_f32 v32, v32, v25
    v_add_f32 v32, v32, v26
    v_add_f32 v32, v32, v27
    v_add_f32 v32, v32, v28
    v_add_f32 v32, v32, v29
    v_add_f32 v32, v32, v30
    v_add_f32 v32, v32, v31
    s_nop 1
    v_add_f32_dpp v32, v32, v32 quad_perm:[1,0,3,2] row_mask:0xf bank_mask:0xf
    s_nop 1
    v_add_f32_dpp v32, v32, v32 quad_perm:[2,3,0,1] row_mask:0xf bank_mask:0xf
    s_nop 1
    v_add_f32_dpp v32, v32, v32 row_half_mirror row_mask:0xf bank_mask:0xf
    s_nop 1
    v_add_f32_dpp v32, v32, v32 row_mirror row_mask:0xf bank_mask:0xf
    s_nop 1
    v_readlane_b32 s60, v32, 0
    v_readlane_b32 s61, v32, 16
    v_readlane_b32 s62, v32, 32
    v_readlane_b32 s63, v32, 48
    s_nop 1
    v_mov_b32 v32, s60
    v_add_f32 v32, s61, v32
    v_add_f32 v32, s62, v32
    v_add_f32 v32, s63, v32
    v_mul_f32 v32, 0x3a800000, v32
    v_sub_f32 v34, v16, v32
    v_mul_f32 v33, v34, v34
    v_sub_f32 v34, v17, v32
    v_fmac_f32 v33, v34, v34
    v_sub_f32 v34, v18, v32
    v_fmac_f32 v33, v34, v34
    v_sub_f32 v34, v19, v32
    v_fmac_f32 v33, v34, v34
    v_sub_f32 v34, v20, v32
    v_fmac_f32 v33, v34, v34
    v_sub_f32 v34, v21, v32
    v_fmac_f32 v33, v34, v34
    v_sub_f32 v34, v22, v32
    v_fmac_f32 v33, v34, v34
    v_sub_f32 v34, v23, v32
    v_fmac_f32 v33, v34, v34
    v_sub_f32 v34, v24, v32
    v_fmac_f32 v33, v34, v34
    v_sub_f32 v34, v25, v32
    v_fmac_f32 v33, v34, v34
    v_sub_f32 v34, v26, v32
    v_fmac_f32 v33, v34, v34
    v_sub_f32 v34, v27, v32
    v_fmac_f32 v33, v34, v34
    v_sub_f32 v34, v28, v32
    v_fmac_f32 v33, v34, v34
    v_sub_f32 v34, v29, v32
    v_fmac_f32 v33, v34, v34
    v_sub_f32 v34, v30, v32
    v_fmac_f32 v33, v34, v34
    v_sub_f32 v34, v31, v32
    v_fmac_f32 v33, v34, v34
    s_nop 1
    v_add_f32_dpp v33, v33, v33 quad_perm:[1,0,3,2] row_mask:0xf bank_mask:0xf
    s_nop 1
    v_add_f32_dpp v33, v33, v33 quad_perm:[2,3,0,1] row_mask:0xf bank_mask:0xf
    s_nop 1
    v_add_f32_dpp v33, v33, v33 row_half_mirror row_mask:0xf bank_mask:0xf
    s_nop 1
    v_add_f32_dpp v33, v33, v33 row_mirror row_mask:0xf bank_mask:0xf
    s_nop 1
    v_readlane_b32 s60, v33, 0
    v_readlane_b32 s61, v33, 16
    v_readlane_b32 s62, v33, 32
    v_readlane_b32 s63, v33, 48
    s_nop 1
    v_mov_b32 v33, s60
    v_add_f32 v33, s61, v33
    v_add_f32 v33, s62, v33
    v_add_f32 v33, s63, v33
    v_mul_f32 v33, 0x3a800000, v33
    v_cvt_pk_bf16_f32 v34, v32, v32
    v_lshlrev_b32 v32, 16, v34
    v_cvt_pk_bf16_f32 v34, v33, v33
    v_lshlrev_b32 v33, 16, v34
    v_add_f32 v33, 0x3727c5ac, v33
    v_cvt_pk_bf16_f32 v34, v33, v33
    v_lshlrev_b32 v33, 16, v34
    v_sqrt_f32 v33, v33
    s_nop 0
    v_cvt_pk_bf16_f32 v34, v33, v33
    v_lshlrev_b32 v33, 16, v34
    v_rcp_f32 v33, v33
    s_nop 0
    v_sub_f32 v16, v16, v32
    v_sub_f32 v17, v17, v32
    v_cvt_pk_bf16_f32 v34, v16, v17
    v_lshlrev_b32 v16, 16, v34
    v_and_b32 v17, 0xffff0000, v34
    v_mul_f32 v16, v16, v33
    v_mul_f32 v17, v17, v33
    v_cvt_pk_bf16_f32 v16, v16, v17
    v_sub_f32 v18, v18, v32
    v_sub_f32 v19, v19, v32
    v_cvt_pk_bf16_f32 v34, v18, v19
    v_lshlrev_b32 v18, 16, v34
    v_and_b32 v19, 0xffff0000, v34
    v_mul_f32 v18, v18, v33
    v_mul_f32 v19, v19, v33
    v_cvt_pk_bf16_f32 v18, v18, v19
    v_sub_f32 v20, v20, v32
    v_sub_f32 v21, v21, v32
    v_cvt_pk_bf16_f32 v34, v20, v21
    v_lshlrev_b32 v20, 16, v34
    v_and_b32 v21, 0xffff0000, v34
    v_mul_f32 v20, v20, v33
    v_mul_f32 v21, v21, v33
    v_cvt_pk_bf16_f32 v20, v20, v21
    v_sub_f32 v22, v22, v32
    v_sub_f32 v23, v23, v32
    v_cvt_pk_bf16_f32 v34, v22, v23
    v_lshlrev_b32 v22, 16, v34
    v_and_b32 v23, 0xffff0000, v34
    v_mul_f32 v22, v22, v33
    v_mul_f32 v23, v23, v33
    v_cvt_pk_bf16_f32 v22, v22, v23
    v_sub_f32 v24, v24, v32
    v_sub_f32 v25, v25, v32
    v_cvt_pk_bf16_f32 v34, v24, v25
    v_lshlrev_b32 v24, 16, v34
    v_and_b32 v25, 0xffff0000, v34
    v_mul_f32 v24, v24, v33
    v_mul_f32 v25, v25, v33
    v_cvt_pk_bf16_f32 v24, v24, v25
    v_sub_f32 v26, v26, v32
    v_sub_f32 v27, v27, v32
    v_cvt_pk_bf16_f32 v34, v26, v27
    v_lshlrev_b32 v26, 16, v34
    v_and_b32 v27, 0xffff0000, v34
    v_mul_f32 v26, v26, v33
    v_mul_f32 v27, v27, v33
    v_cvt_pk_bf16_f32 v26, v26, v27
    v_sub_f32 v28, v28, v32
    v_sub_f32 v29, v29, v32
    v_cvt_pk_bf16_f32 v34, v28, v29
    v_lshlrev_b32 v28, 16, v34
    v_and_b32 v29, 0xffff0000, v34
    v_mul_f32 v28, v28, v33
    v_mul_f32 v29, v29, v33
    v_cvt_pk_bf16_f32 v28, v28, v29
    v_sub_f32 v30, v30, v32
    v_sub_f32 v31, v31, v32
    v_cvt_pk_bf16_f32 v34, v30, v31
    v_lshlrev_b32 v30, 16, v34
    v_and_b32 v31, 0xffff0000, v34
    v_mul_f32 v30, v30, v33
    v_mul_f32 v31, v31, v33
    v_cvt_pk_bf16_f32 v30, v30, v31
    v_mov_b32 v36, v16
    v_mov_b32 v37, v18
    v_mov_b32 v38, v20
    v_mov_b32 v39, v22
    v_mov_b32 v40, v24
    v_mov_b32 v41, v26
    v_mov_b32 v42, v28
    v_mov_b32 v43, v30
    buffer_store_dwordx4 v[36:39], v3, s[12:15], s21 offen
    buffer_store_dwordx4 v[40:43], v3, s[12:15], s21 offen offset:1024
    s_endpgm
L_end_ln0_kernel:
    s_endpgm
.text
.globl k1a_kernel
.p2align 8
.type k1a_kernel,@function
k1a_kernel:
    s_cmp_ge_u32 s2, 256
    s_cbranch_scc1 L_end_k1a_kernel
    s_load_dwordx2 s[4:5], s[0:1], 80
    s_load_dwordx2 s[6:7], s[0:1], 8
    v_lshrrev_b32 v1, 6, v0
    v_and_b32 v2, 63, v0
    s_nop 0
    v_readfirstlane_b32 s3, v1
    s_lshr_b32 s20, s2, 4
    s_and_b32 s21, s2, 15
    s_lshr_b32 s22, s3, 1
    s_and_b32 s23, s3, 1
    s_lshl_b32 s24, s22, 13
    s_lshl_b32 s25, s23, 2
    s_lshl_b32 s26, s21, 7
    s_waitcnt lgkmcnt(0)
    s_mov_b32 s8, s4
    s_mov_b32 s9, s5
    s_mov_b32 s10, 4194304
    s_mov_b32 s11, 0x00020000
    s_mov_b32 s12, s6
    s_mov_b32 s13, s7
    s_mov_b32 s14, 6291456
    s_mov_b32 s15, 0x00020000
    s_mov_b32 s16, s4
    s_mov_b32 s17, s5
    s_mov_b32 s18, 29360128
    s_mov_b32 s19, 0x00020000
    v_mov_b32 v32, 0
    v_mov_b32 v33, 0
    v_mov_b32 v34, 0
    v_mov_b32 v35, 0
    v_mov_b32 v36, 0
    v_mov_b32 v37, 0
    v_mov_b32 v38, 0
    v_mov_b32 v39, 0
    v_mov_b32 v40, 0
    v_mov_b32 v41, 0
    v_mov_b32 v42, 0
    v_mov_b32 v43, 0
    v_mov_b32 v44, 0
    v_mov_b32 v45, 0
    v_mov_b32 v46, 0
    v_mov_b32 v47, 0
    v_mov_b32 v48, 0
    v_mov_b32 v49, 0
    v_mov_b32 v50, 0
    v_mov_b32 v51, 0
    v_mov_b32 v52, 0
    v_mov_b32 v53, 0
    v_mov_b32 v54, 0
    v_mov_b32 v55, 0
    v_mov_b32 v56, 0
    v_mov_b32 v57, 0
    v_mov_b32 v58, 0
    v_mov_b32 v59, 0
    v_mov_b32 v60, 0
    v_mov_b32 v61, 0
    v_mov_b32 v62, 0
    v_mov_b32 v63, 0
    v_mov_b32 v64, 0
    v_mov_b32 v65, 0
    v_mov_b32 v66, 0
    v_mov_b32 v67, 0
    v_mov_b32 v68, 0
    v_mov_b32 v69, 0
    v_mov_b32 v70, 0
    v_mov_b32 v71, 0
    v_mov_b32 v72, 0
    v_mov_b32 v73, 0
    v_mov_b32 v74, 0
    v_mov_b32 v75, 0
    v_mov_b32 v76, 0
    v_mov_b32 v77, 0
    v_mov_b32 v78, 0
    v_mov_b32 v79, 0
    v_mov_b32 v80, 0
    v_mov_b32 v81, 0
    v_mov_b32 v82, 0
    v_mov_b32 v83, 0
    v_mov_b32 v84, 0
    v_mov_b32 v85, 0
    v_mov_b32 v86, 0
    v_mov_b32 v87, 0
    v_mov_b32 v88, 0
    v_mov_b32 v89, 0
    v_mov_b32 v90, 0
    v_mov_b32 v91, 0
    v_mov_b32 v92, 0
    v_mov_b32 v93, 0
    v_mov_b32 v94, 0
    v_mov_b32 v95, 0
    v_mov_b32 v96, 0
    v_mov_b32 v97, 0
    v_mov_b32 v98, 0
    v_mov_b32 v99, 0
    v_mov_b32 v100, 0
    v_mov_b32 v101, 0
    v_mov_b32 v102, 0
    v_mov_b32 v103, 0
    v_mov_b32 v104, 0
    v_mov_b32 v105, 0
    v_mov_b32 v106, 0
    v_mov_b32 v107, 0
    v_mov_b32 v108, 0
    v_mov_b32 v109, 0
    v_mov_b32 v110, 0
    v_mov_b32 v111, 0
    v_mov_b32 v112, 0
    v_mov_b32 v113, 0
    v_mov_b32 v114, 0
    v_mov_b32 v115, 0
    v_mov_b32 v116, 0
    v_mov_b32 v117, 0
    v_mov_b32 v118, 0
    v_mov_b32 v119, 0
    v_mov_b32 v120, 0
    v_mov_b32 v121, 0
    v_mov_b32 v122, 0
    v_mov_b32 v123, 0
    v_mov_b32 v124, 0
    v_mov_b32 v125, 0
    v_mov_b32 v126, 0
    v_mov_b32 v127, 0
    v_lshrrev_b32 v181, 4, v2
    v_add_u32 v181, 0, v181
    v_and_b32 v181, 7, v181
    v_and_b32 v182, 7, v2
    v_xor_b32 v181, v181, v182
    v_lshlrev_b32 v181, 4, v181
    v_lshrrev_b32 v182, 3, v2
    v_add_u32 v182, 0, v182
    v_lshlrev_b32 v182, 11, v182
    v_add_u32 v176, v181, v182
    v_lshrrev_b32 v181, 4, v2
    v_add_u32 v181, 4, v181
    v_and_b32 v181, 7, v181
    v_and_b32 v182, 7, v2
    v_xor_b32 v181, v181, v182
    v_lshlrev_b32 v181, 4, v181
    v_lshrrev_b32 v182, 3, v2
    v_add_u32 v182, 8, v182
    v_lshlrev_b32 v182, 11, v182
    v_add_u32 v177, v181, v182
    v_lshrrev_b32 v181, 4, v2
    v_add_u32 v181, 8, v181
    v_and_b32 v181, 7, v181
    v_and_b32 v182, 7, v2
    v_xor_b32 v181, v181, v182
    v_lshlrev_b32 v181, 4, v181
    v_lshrrev_b32 v182, 3, v2
    v_add_u32 v182, 16, v182
    v_lshlrev_b32 v182, 11, v182
    v_add_u32 v178, v181, v182
    v_lshrrev_b32 v181, 4, v2
    v_add_u32 v181, 12, v181
    v_and_b32 v181, 7, v181
    v_and_b32 v182, 7, v2
    v_xor_b32 v181, v181, v182
    v_lshlrev_b32 v181, 4, v181
    v_lshrrev_b32 v182, 3, v2
    v_add_u32 v182, 24, v182
    v_lshlrev_b32 v182, 11, v182
    v_add_u32 v179, v181, v182
    v_lshrrev_b32 v181, 4, v2
    v_and_b32 v181, 1, v181
    v_lshlrev_b32 v181, 2, v181
    v_and_b32 v182, 7, v2
    v_xor_b32 v181, v181, v182
    v_lshlrev_b32 v181, 4, v181
    v_lshrrev_b32 v182, 3, v2
    s_mov_b32 s40, 6144
    v_mul_lo_u32 v182, v182, s40
    v_add_u32 v180, v181, v182
    s_lshl_b32 s41, s20, 18
    s_lshl_b32 s43, s3, 16
    s_add_u32 s41, s41, s43
    s_mul_i32 s43, s3, 6
    s_add_u32 s43, s43, 0
    s_lshr_b32 s44, s43, 3
    s_and_b32 s43, s43, 7
    s_lshl_b32 s51, s44, 13
    s_lshl_b32 s45, s43, 10
    s_add_u32 s51, s51, s45
    s_add_u32 s51, s51, 16384
    s_mul_i32 s45, s43, 49152
    s_mul_i32 s44, s44, 2048
    s_add_u32 s45, s45, s44
    s_add_u32 s45, s45, s26
    s_mul_i32 s43, s3, 6
    s_add_u32 s43, s43, 1
    s_lshr_b32 s44, s43, 3
    s_and_b32 s43, s43, 7
    s_lshl_b32 s52, s44, 13
    s_lshl_b32 s46, s43, 10
    s_add_u32 s52, s52, s46
    s_add_u32 s52, s52, 16384
    s_mul_i32 s46, s43, 49152
    s_mul_i32 s44, s44, 2048
    s_add_u32 s46, s46, s44
    s_add_u32 s46, s46, s26
    s_mul_i32 s43, s3, 6
    s_add_u32 s43, s43, 2
    s_lshr_b32 s44, s43, 3
    s_and_b32 s43, s43, 7
    s_lshl_b32 s53, s44, 13
    s_lshl_b32 s47, s43, 10
    s_add_u32 s53, s53, s47
    s_add_u32 s53, s53, 16384
    s_mul_i32 s47, s43, 49152
    s_mul_i32 s44, s44, 2048
    s_add_u32 s47, s47, s44
    s_add_u32 s47, s47, s26
    s_mul_i32 s43, s3, 6
    s_add_u32 s43, s43, 3
    s_lshr_b32 s44, s43, 3
    s_and_b32 s43, s43, 7
    s_lshl_b32 s54, s44, 13
    s_lshl_b32 s48, s43, 10
    s_add_u32 s54, s54, s48
    s_add_u32 s54, s54, 16384
    s_mul_i32 s48, s43, 49152
    s_mul_i32 s44, s44, 2048
    s_add_u32 s48, s48, s44
    s_add_u32 s48, s48, s26
    s_mul_i32 s43, s3, 6
    s_add_u32 s43, s43, 4
    s_lshr_b32 s44, s43, 3
    s_and_b32 s43, s43, 7
    s_lshl_b32 s55, s44, 13
    s_lshl_b32 s49, s43, 10
    s_add_u32 s55, s55, s49
    s_add_u32 s55, s55, 16384
    s_mul_i32 s49, s43, 49152
    s_mul_i32 s44, s44, 2048
    s_add_u32 s49, s49, s44
    s_add_u32 s49, s49, s26
    s_mul_i32 s43, s3, 6
    s_add_u32 s43, s43, 5
    s_lshr_b32 s44, s43, 3
    s_and_b32 s43, s43, 7
    s_lshl_b32 s56, s44, 13
    s_lshl_b32 s50, s43, 10
    s_add_u32 s56, s56, s50
    s_add_u32 s56, s56, 16384
    s_mul_i32 s50, s43, 49152
    s_mul_i32 s44, s44, 2048
    s_add_u32 s50, s50, s44
    s_add_u32 s50, s50, s26
    s_lshl_b32 s57, s3, 12
    v_lshrrev_b32 v181, 5, v2
    v_add_u32 v181, 0, v181
    v_lshrrev_b32 v182, 1, v2
    v_and_b32 v182, 7, v182
    v_xor_b32 v181, v181, v182
    v_lshlrev_b32 v181, 4, v181
    v_and_b32 v182, 31, v2
    v_lshlrev_b32 v182, 7, v182
    v_add_u32 v181, v181, v182
    v_add_u32 v184, s24, v181
    v_add_u32 v188, 40960, v184
    v_add_u32 v192, 81920, v184
    v_add_u32 v196, 122880, v184
    v_lshrrev_b32 v181, 5, v2
    v_add_u32 v181, 2, v181
    v_lshrrev_b32 v182, 1, v2
    v_and_b32 v182, 7, v182
    v_xor_b32 v181, v181, v182
    v_lshlrev_b32 v181, 4, v181
    v_and_b32 v182, 31, v2
    v_lshlrev_b32 v182, 7, v182
    v_add_u32 v181, v181, v182
    v_add_u32 v185, s24, v181
    v_add_u32 v189, 40960, v185
    v_add_u32 v193, 81920, v185
    v_add_u32 v197, 122880, v185
    v_lshrrev_b32 v181, 5, v2
    v_add_u32 v181, 4, v181
    v_lshrrev_b32 v182, 1, v2
    v_and_b32 v182, 7, v182
    v_xor_b32 v181, v181, v182
    v_lshlrev_b32 v181, 4, v181
    v_and_b32 v182, 31, v2
    v_lshlrev_b32 v182, 7, v182
    v_add_u32 v181, v181, v182
    v_add_u32 v186, s24, v181
    v_add_u32 v190, 40960, v186
    v_add_u32 v194, 81920, v186
    v_add_u32 v198, 122880, v186
    v_lshrrev_b32 v181, 5, v2
    v_add_u32 v181, 6, v181
    v_lshrrev_b32 v182, 1, v2
    v_and_b32 v182, 7, v182
    v_xor_b32 v181, v181, v182
    v_lshlrev_b32 v181, 4, v181
    v_and_b32 v182, 31, v2
    v_lshlrev_b32 v182, 7, v182
    v_add_u32 v181, v181, v182
    v_add_u32 v187, s24, v181
    v_add_u32 v191, 40960, v187
    v_add_u32 v195, 81920, v187
    v_add_u32 v199, 122880, v187
    v_lshrrev_b32 v181, 5, v2
    v_lshlrev_b32 v181, 3, v181
    v_lshrrev_b32 v182, 2, v2
    v_and_b32 v182, 3, v182
    v_add_u32 v181, v181, v182
    v_lshlrev_b32 v200, 7, v181
    v_lshrrev_b32 v181, 4, v2
    v_and_b32 v181, 1, v181
    v_lshlrev_b32 v181, 1, v181
    v_lshrrev_b32 v182, 1, v2
    v_and_b32 v182, 1, v182
    v_add_u32 v181, v181, v182
    v_add_u32 v181, s25, v181
    v_lshrrev_b32 v182, 3, v2
    v_and_b32 v182, 1, v182
    v_lshlrev_b32 v182, 2, v182
    v_xor_b32 v181, v181, v182
    v_lshlrev_b32 v181, 4, v181
    v_add_u32 v200, v200, v181
    v_and_b32 v181, 1, v2
    v_lshlrev_b32 v181, 3, v181
    v_add_u32 v200, v200, v181
    v_add_u32 v200, 16384, v200
    v_add_u32 v201, 40960, v200
    v_add_u32 v202, 81920, v200
    v_add_u32 v203, 122880, v200
    s_mov_b32 s60, 0
    s_mov_b32 s61, 0
    s_add_u32 s58, s57, 0
    s_mov_b32 m0, s58
    s_add_u32 s59, s41, s60
    buffer_load_dwordx4 v176, s[8:11], s59 offen lds
    s_add_u32 s58, s57, 1024
    s_mov_b32 m0, s58
    s_add_u32 s59, s41, s60
    buffer_load_dwordx4 v177, s[8:11], s59 offen lds
    s_add_u32 s58, s57, 2048
    s_mov_b32 m0, s58
    s_add_u32 s59, s41, s60
    buffer_load_dwordx4 v178, s[8:11], s59 offen lds
    s_add_u32 s58, s57, 3072
    s_mov_b32 m0, s58
    s_add_u32 s59, s41, s60
    buffer_load_dwordx4 v179, s[8:11], s59 offen lds
    s_add_u32 s58, s51, 0
    s_mov_b32 m0, s58
    s_add_u32 s59, s45, s61
    buffer_load_dwordx4 v180, s[12:15], s59 offen lds
    s_add_u32 s58, s52, 0
    s_mov_b32 m0, s58
    s_add_u32 s59, s46, s61
    buffer_load_dwordx4 v180, s[12:15], s59 offen lds
    s_add_u32 s58, s53, 0
    s_mov_b32 m0, s58
    s_add_u32 s59, s47, s61
    buffer_load_dwordx4 v180, s[12:15], s59 offen lds
    s_add_u32 s58, s54, 0
    s_mov_b32 m0, s58
    s_add_u32 s59, s48, s61
    buffer_load_dwordx4 v180, s[12:15], s59 offen lds
    s_add_u32 s58, s55, 0
    s_mov_b32 m0, s58
    s_add_u32 s59, s49, s61
    buffer_load_dwordx4 v180, s[12:15], s59 offen lds
    s_add_u32 s58, s56, 0
    s_mov_b32 m0, s58
    s_add_u32 s59, s50, s61
    buffer_load_dwordx4 v180, s[12:15], s59 offen lds
    s_add_u32 s60, s60, 128
    s_add_u32 s61, s61, 393216
    s_add_u32 s58, s57, 40960
    s_mov_b32 m0, s58
    s_add_u32 s59, s41, s60
    buffer_load_dwordx4 v176, s[8:11], s59 offen lds
    s_add_u32 s58, s57, 41984
    s_mov_b32 m0, s58
    s_add_u32 s59, s41, s60
    buffer_load_dwordx4 v177, s[8:11], s59 offen lds
    s_add_u32 s58, s57, 43008
    s_mov_b32 m0, s58
    s_add_u32 s59, s41, s60
    buffer_load_dwordx4 v178, s[8:11], s59 offen lds
    s_add_u32 s58, s57, 44032
    s_mov_b32 m0, s58
    s_add_u32 s59, s41, s60
    buffer_load_dwordx4 v179, s[8:11], s59 offen lds
    s_add_u32 s58, s51, 40960
    s_mov_b32 m0, s58
    s_add_u32 s59, s45, s61
    buffer_load_dwordx4 v180, s[12:15], s59 offen lds
    s_add_u32 s58, s52, 40960
    s_mov_b32 m0, s58
    s_add_u32 s59, s46, s61
    buffer_load_dwordx4 v180, s[12:15], s59 offen lds
    s_add_u32 s58, s53, 40960
    s_mov_b32 m0, s58
    s_add_u32 s59, s47, s61
    buffer_load_dwordx4 v180, s[12:15], s59 offen lds
    s_add_u32 s58, s54, 40960
    s_mov_b32 m0, s58
    s_add_u32 s59, s48, s61
    buffer_load_dwordx4 v180, s[12:15], s59 offen lds
    s_add_u32 s58, s55, 40960
    s_mov_b32 m0, s58
    s_add_u32 s59, s49, s61
    buffer_load_dwordx4 v180, s[12:15], s59 offen lds
    s_add_u32 s58, s56, 40960
    s_mov_b32 m0, s58
    s_add_u32 s59, s50, s61
    buffer_load_dwordx4 v180, s[12:15], s59 offen lds
    s_add_u32 s60, s60, 128
    s_add_u32 s61, s61, 393216
    s_add_u32 s58, s57, 81920
    s_mov_b32 m0, s58
    s_add_u32 s59, s41, s60
    buffer_load_dwordx4 v176, s[8:11], s59 offen lds
    s_add_u32 s58, s57, 82944
    s_mov_b32 m0, s58
    s_add_u32 s59, s41, s60
    buffer_load_dwordx4 v177, s[8:11], s59 offen lds
    s_add_u32 s58, s57, 83968
    s_mov_b32 m0, s58
    s_add_u32 s59, s41, s60
    buffer_load_dwordx4 v178, s[8:11], s59 offen lds
    s_add_u32 s58, s57, 84992
    s_mov_b32 m0, s58
    s_add_u32 s59, s41, s60
    buffer_load_dwordx4 v179, s[8:11], s59 offen lds
    s_add_u32 s58, s51, 81920
    s_mov_b32 m0, s58
    s_add_u32 s59, s45, s61
    buffer_load_dwordx4 v180, s[12:15], s59 offen lds
    s_add_u32 s58, s52, 81920
    s_mov_b32 m0, s58
    s_add_u32 s59, s46, s61
    buffer_load_dwordx4 v180, s[12:15], s59 offen lds
    s_add_u32 s58, s53, 81920
    s_mov_b32 m0, s58
    s_add_u32 s59, s47, s61
    buffer_load_dwordx4 v180, s[12:15], s59 offen lds
    s_add_u32 s58, s54, 81920
    s_mov_b32 m0, s58
    s_add_u32 s59, s48, s61
    buffer_load_dwordx4 v180, s[12:15], s59 offen lds
    s_add_u32 s58, s55, 81920
    s_mov_b32 m0, s58
    s_add_u32 s59, s49, s61
    buffer_load_dwordx4 v180, s[12:15], s59 offen lds
    s_add_u32 s58, s56, 81920
    s_mov_b32 m0, s58
    s_add_u32 s59, s50, s61
    buffer_load_dwordx4 v180, s[12:15], s59 offen lds
    s_add_u32 s60, s60, 128
    s_add_u32 s61, s61, 393216
    s_waitcnt vmcnt(20)
    s_barrier
    s_mov_b32 s62, 0
L_gl_k1a_kernel:
    s_add_u32 s58, s57, 122880
    s_mov_b32 m0, s58
    s_add_u32 s59, s41, s60
    buffer_load_dwordx4 v176, s[8:11], s59 offen lds
    s_add_u32 s58, s57, 123904
    s_mov_b32 m0, s58
    s_add_u32 s59, s41, s60
    buffer_load_dwordx4 v177, s[8:11], s59 offen lds
    s_add_u32 s58, s57, 124928
    s_mov_b32 m0, s58
    s_add_u32 s59, s41, s60
    buffer_load_dwordx4 v178, s[8:11], s59 offen lds
    s_add_u32 s58, s57, 125952
    s_mov_b32 m0, s58
    s_add_u32 s59, s41, s60
    buffer_load_dwordx4 v179, s[8:11], s59 offen lds
    s_add_u32 s58, s51, 122880
    s_mov_b32 m0, s58
    s_add_u32 s59, s45, s61
    buffer_load_dwordx4 v180, s[12:15], s59 offen lds
    s_add_u32 s58, s52, 122880
    s_mov_b32 m0, s58
    s_add_u32 s59, s46, s61
    buffer_load_dwordx4 v180, s[12:15], s59 offen lds
    s_add_u32 s58, s53, 122880
    s_mov_b32 m0, s58
    s_add_u32 s59, s47, s61
    buffer_load_dwordx4 v180, s[12:15], s59 offen lds
    s_add_u32 s58, s54, 122880
    s_mov_b32 m0, s58
    s_add_u32 s59, s48, s61
    buffer_load_dwordx4 v180, s[12:15], s59 offen lds
    s_add_u32 s58, s55, 122880
    s_mov_b32 m0, s58
    s_add_u32 s59, s49, s61
    buffer_load_dwordx4 v180, s[12:15], s59 offen lds
    s_add_u32 s58, s56, 122880
    s_mov_b32 m0, s58
    s_add_u32 s59, s50, s61
    buffer_load_dwordx4 v180, s[12:15], s59 offen lds
    s_add_u32 s60, s60, 128
    s_add_u32 s61, s61, 393216
    ds_read_b128 v[128:131], v184 offset:0
    ds_read_b128 v[132:135], v184 offset:4096
    ds_read_b64_tr_b16 v[136:137], v200 offset:0
    ds_read_b64_tr_b16 v[138:139], v200 offset:512
    ds_read_b64_tr_b16 v[140:141], v200 offset:8192
    ds_read_b64_tr_b16 v[142:143], v200 offset:8704
    ds_read_b64_tr_b16 v[144:145], v200 offset:16384
    ds_read_b64_tr_b16 v[146:147], v200 offset:16896
    ds_read_b128 v[148:151], v185 offset:0
    ds_read_b128 v[152:155], v185 offset:4096
    ds_read_b64_tr_b16 v[156:157], v200 offset:2048
    ds_read_b64_tr_b16 v[158:159], v200 offset:2560
    ds_read_b64_tr_b16 v[160:161], v200 offset:10240
    ds_read_b64_tr_b16 v[162:163], v200 offset:10752
    ds_read_b64_tr_b16 v[164:165], v200 offset:18432
    ds_read_b64_tr_b16 v[166:167], v200 offset:18944
    s_waitcnt lgkmcnt(8)
    v_mfma_f32_32x32x16_bf16 v[32:47], v[136:139], v[128:131], v[32:47]
    v_mfma_f32_32x32x16_bf16 v[48:63], v[128:131], v[140:143], v[48:63]
    v_mfma_f32_32x32x16_bf16 v[64:79], v[128:131], v[144:147], v[64:79]
    v_mfma_f32_32x32x16_bf16 v[80:95], v[136:139], v[132:135], v[80:95]
    v_mfma_f32_32x32x16_bf16 v[96:111], v[132:135], v[140:143], v[96:111]
    v_mfma_f32_32x32x16_bf16 v[112:127], v[132:135], v[144:147], v[112:127]
    ds_read_b128 v[128:131], v186 offset:0
    ds_read_b128 v[132:135], v186 offset:4096
    ds_read_b64_tr_b16 v[136:137], v200 offset:4096
    ds_read_b64_tr_b16 v[138:139], v200 offset:4608
    ds_read_b64_tr_b16 v[140:141], v200 offset:12288
    ds_read_b64_tr_b16 v[142:143], v200 offset:12800
    ds_read_b64_tr_b16 v[144:145], v200 offset:20480
    ds_read_b64_tr_b16 v[146:147], v200 offset:20992
    s_waitcnt lgkmcnt(8)
    v_mfma_f32_32x32x16_bf16 v[32:47], v[156:159], v[148:151], v[32:47]
    v_mfma_f32_32x32x16_bf16 v[48:63], v[148:151], v[160:163], v[48:63]
    v_mfma_f32_32x32x16_bf16 v[64:79], v[148:151], v[164:167], v[64:79]
    v_mfma_f32_32x32x16_bf16 v[80:95], v[156:159], v[152:155], v[80:95]
    v_mfma_f32_32x32x16_bf16 v[96:111], v[152:155], v[160:163], v[96:111]
    v_mfma_f32_32x32x16_bf16 v[112:127], v[152:155], v[164:167], v[112:127]
    ds_read_b128 v[148:151], v187 offset:0
    ds_read_b128 v[152:155], v187 offset:4096
    ds_read_b64_tr_b16 v[156:157], v200 offset:6144
    ds_read_b64_tr_b16 v[158:159], v200 offset:6656
    ds_read_b64_tr_b16 v[160:161], v200 offset:14336
    ds_read_b64_tr_b16 v[162:163], v200 offset:14848
    ds_read_b64_tr_b16 v[164:165], v200 offset:22528
    ds_read_b64_tr_b16 v[166:167], v200 offset:23040
    s_waitcnt lgkmcnt(8)
    v_mfma_f32_32x32x16_bf16 v[32:47], v[136:139], v[128:131], v[32:47]
    v_mfma_f32_32x32x16_bf16 v[48:63], v[128:131], v[140:143], v[48:63]
    v_mfma_f32_32x32x16_bf16 v[64:79], v[128:131], v[144:147], v[64:79]
    v_mfma_f32_32x32x16_bf16 v[80:95], v[136:139], v[132:135], v[80:95]
    v_mfma_f32_32x32x16_bf16 v[96:111], v[132:135], v[140:143], v[96:111]
    v_mfma_f32_32x32x16_bf16 v[112:127], v[132:135], v[144:147], v[112:127]
    s_waitcnt lgkmcnt(0)
    v_mfma_f32_32x32x16_bf16 v[32:47], v[156:159], v[148:151], v[32:47]
    v_mfma_f32_32x32x16_bf16 v[48:63], v[148:151], v[160:163], v[48:63]
    v_mfma_f32_32x32x16_bf16 v[64:79], v[148:151], v[164:167], v[64:79]
    v_mfma_f32_32x32x16_bf16 v[80:95], v[156:159], v[152:155], v[80:95]
    v_mfma_f32_32x32x16_bf16 v[96:111], v[152:155], v[160:163], v[96:111]
    v_mfma_f32_32x32x16_bf16 v[112:127], v[152:155], v[164:167], v[112:127]
    s_waitcnt vmcnt(20)
    s_barrier
    s_add_u32 s58, s57, 0
    s_mov_b32 m0, s58
    s_add_u32 s59, s41, s60
    buffer_load_dwordx4 v176, s[8:11], s59 offen lds
    s_add_u32 s58, s57, 1024
    s_mov_b32 m0, s58
    s_add_u32 s59, s41, s60
    buffer_load_dwordx4 v177, s[8:11], s59 offen lds
    s_add_u32 s58, s57, 2048
    s_mov_b32 m0, s58
    s_add_u32 s59, s41, s60
    buffer_load_dwordx4 v178, s[8:11], s59 offen lds
    s_add_u32 s58, s57, 3072
    s_mov_b32 m0, s58
    s_add_u32 s59, s41, s60
    buffer_load_dwordx4 v179, s[8:11], s59 offen lds
    s_add_u32 s58, s51, 0
    s_mov_b32 m0, s58
    s_add_u32 s59, s45, s61
    buffer_load_dwordx4 v180, s[12:15], s59 offen lds
    s_add_u32 s58, s52, 0
    s_mov_b32 m0, s58
    s_add_u32 s59, s46, s61
    buffer_load_dwordx4 v180, s[12:15], s59 offen lds
    s_add_u32 s58, s53, 0
    s_mov_b32 m0, s58
    s_add_u32 s59, s47, s61
    buffer_load_dwordx4 v180, s[12:15], s59 offen lds
    s_add_u32 s58, s54, 0
    s_mov_b32 m0, s58
    s_add_u32 s59, s48, s61
    buffer_load_dwordx4 v180, s[12:15], s59 offen lds
    s_add_u32 s58, s55, 0
    s_mov_b32 m0, s58
    s_add_u32 s59, s49, s61
    buffer_load_dwordx4 v180, s[12:15], s59 offen lds
    s_add_u32 s58, s56, 0
    s_mov_b32 m0, s58
    s_add_u32 s59, s50, s61
    buffer_load_dwordx4 v180, s[12:15], s59 offen lds
    s_add_u32 s60, s60, 128
    s_add_u32 s61, s61, 393216
    ds_read_b128 v[128:131], v188 offset:0
    ds_read_b128 v[132:135], v188 offset:4096
    ds_read_b64_tr_b16 v[136:137], v201 offset:0
    ds_read_b64_tr_b16 v[138:139], v201 offset:512
    ds_read_b64_tr_b16 v[140:141], v201 offset:8192
    ds_read_b64_tr_b16 v[142:143], v201 offset:8704
    ds_read_b64_tr_b16 v[144:145], v201 offset:16384
    ds_read_b64_tr_b16 v[146:147], v201 offset:16896
    ds_read_b128 v[148:151], v189 offset:0
    ds_read_b128 v[152:155], v189 offset:4096
    ds_read_b64_tr_b16 v[156:157], v201 offset:2048
    ds_read_b64_tr_b16 v[158:159], v201 offset:2560
    ds_read_b64_tr_b16 v[160:161], v201 offset:10240
    ds_read_b64_tr_b16 v[162:163], v201 offset:10752
    ds_read_b64_tr_b16 v[164:165], v201 offset:18432
    ds_read_b64_tr_b16 v[166:167], v201 offset:18944
    s_waitcnt lgkmcnt(8)
    v_mfma_f32_32x32x16_bf16 v[32:47], v[136:139], v[128:131], v[32:47]
    v_mfma_f32_32x32x16_bf16 v[48:63], v[128:131], v[140:143], v[48:63]
    v_mfma_f32_32x32x16_bf16 v[64:79], v[128:131], v[144:147], v[64:79]
    v_mfma_f32_32x32x16_bf16 v[80:95], v[136:139], v[132:135], v[80:95]
    v_mfma_f32_32x32x16_bf16 v[96:111], v[132:135], v[140:143], v[96:111]
    v_mfma_f32_32x32x16_bf16 v[112:127], v[132:135], v[144:147], v[112:127]
    ds_read_b128 v[128:131], v190 offset:0
    ds_read_b128 v[132:135], v190 offset:4096
    ds_read_b64_tr_b16 v[136:137], v201 offset:4096
    ds_read_b64_tr_b16 v[138:139], v201 offset:4608
    ds_read_b64_tr_b16 v[140:141], v201 offset:12288
    ds_read_b64_tr_b16 v[142:143], v201 offset:12800
    ds_read_b64_tr_b16 v[144:145], v201 offset:20480
    ds_read_b64_tr_b16 v[146:147], v201 offset:20992
    s_waitcnt lgkmcnt(8)
    v_mfma_f32_32x32x16_bf16 v[32:47], v[156:159], v[148:151], v[32:47]
    v_mfma_f32_32x32x16_bf16 v[48:63], v[148:151], v[160:163], v[48:63]
    v_mfma_f32_32x32x16_bf16 v[64:79], v[148:151], v[164:167], v[64:79]
    v_mfma_f32_32x32x16_bf16 v[80:95], v[156:159], v[152:155], v[80:95]
    v_mfma_f32_32x32x16_bf16 v[96:111], v[152:155], v[160:163], v[96:111]
    v_mfma_f32_32x32x16_bf16 v[112:127], v[152:155], v[164:167], v[112:127]
    ds_read_b128 v[148:151], v191 offset:0
    ds_read_b128 v[152:155], v191 offset:4096
    ds_read_b64_tr_b16 v[156:157], v201 offset:6144
    ds_read_b64_tr_b16 v[158:159], v201 offset:6656
    ds_read_b64_tr_b16 v[160:161], v201 offset:14336
    ds_read_b64_tr_b16 v[162:163], v201 offset:14848
    ds_read_b64_tr_b16 v[164:165], v201 offset:22528
    ds_read_b64_tr_b16 v[166:167], v201 offset:23040
    s_waitcnt lgkmcnt(8)
    v_mfma_f32_32x32x16_bf16 v[32:47], v[136:139], v[128:131], v[32:47]
    v_mfma_f32_32x32x16_bf16 v[48:63], v[128:131], v[140:143], v[48:63]
    v_mfma_f32_32x32x16_bf16 v[64:79], v[128:131], v[144:147], v[64:79]
    v_mfma_f32_32x32x16_bf16 v[80:95], v[136:139], v[132:135], v[80:95]
    v_mfma_f32_32x32x16_bf16 v[96:111], v[132:135], v[140:143], v[96:111]
    v_mfma_f32_32x32x16_bf16 v[112:127], v[132:135], v[144:147], v[112:127]
    s_waitcnt lgkmcnt(0)
    v_mfma_f32_32x32x16_bf16 v[32:47], v[156:159], v[148:151], v[32:47]
    v_mfma_f32_32x32x16_bf16 v[48:63], v[148:151], v[160:163], v[48:63]
    v_mfma_f32_32x32x16_bf16 v[64:79], v[148:151], v[164:167], v[64:79]
    v_mfma_f32_32x32x16_bf16 v[80:95], v[156:159], v[152:155], v[80:95]
    v_mfma_f32_32x32x16_bf16 v[96:111], v[152:155], v[160:163], v[96:111]
    v_mfma_f32_32x32x16_bf16 v[112:127], v[152:155], v[164:167], v[112:127]
    s_waitcnt vmcnt(20)
    s_barrier
    s_add_u32 s58, s57, 40960
    s_mov_b32 m0, s58
    s_add_u32 s59, s41, s60
    buffer_load_dwordx4 v176, s[8:11], s59 offen lds
    s_add_u32 s58, s57, 41984
    s_mov_b32 m0, s58
    s_add_u32 s59, s41, s60
    buffer_load_dwordx4 v177, s[8:11], s59 offen lds
    s_add_u32 s58, s57, 43008
    s_mov_b32 m0, s58
    s_add_u32 s59, s41, s60
    buffer_load_dwordx4 v178, s[8:11], s59 offen lds
    s_add_u32 s58, s57, 44032
    s_mov_b32 m0, s58
    s_add_u32 s59, s41, s60
    buffer_load_dwordx4 v179, s[8:11], s59 offen lds
    s_add_u32 s58, s51, 40960
    s_mov_b32 m0, s58
    s_add_u32 s59, s45, s61
    buffer_load_dwordx4 v180, s[12:15], s59 offen lds
    s_add_u32 s58, s52, 40960
    s_mov_b32 m0, s58
    s_add_u32 s59, s46, s61
    buffer_load_dwordx4 v180, s[12:15], s59 offen lds
    s_add_u32 s58, s53, 40960
    s_mov_b32 m0, s58
    s_add_u32 s59, s47, s61
    buffer_load_dwordx4 v180, s[12:15], s59 offen lds
    s_add_u32 s58, s54, 40960
    s_mov_b32 m0, s58
    s_add_u32 s59, s48, s61
    buffer_load_dwordx4 v180, s[12:15], s59 offen lds
    s_add_u32 s58, s55, 40960
    s_mov_b32 m0, s58
    s_add_u32 s59, s49, s61
    buffer_load_dwordx4 v180, s[12:15], s59 offen lds
    s_add_u32 s58, s56, 40960
    s_mov_b32 m0, s58
    s_add_u32 s59, s50, s61
    buffer_load_dwordx4 v180, s[12:15], s59 offen lds
    s_add_u32 s60, s60, 128
    s_add_u32 s61, s61, 393216
    ds_read_b128 v[128:131], v192 offset:0
    ds_read_b128 v[132:135], v192 offset:4096
    ds_read_b64_tr_b16 v[136:137], v202 offset:0
    ds_read_b64_tr_b16 v[138:139], v202 offset:512
    ds_read_b64_tr_b16 v[140:141], v202 offset:8192
    ds_read_b64_tr_b16 v[142:143], v202 offset:8704
    ds_read_b64_tr_b16 v[144:145], v202 offset:16384
    ds_read_b64_tr_b16 v[146:147], v202 offset:16896
    ds_read_b128 v[148:151], v193 offset:0
    ds_read_b128 v[152:155], v193 offset:4096
    ds_read_b64_tr_b16 v[156:157], v202 offset:2048
    ds_read_b64_tr_b16 v[158:159], v202 offset:2560
    ds_read_b64_tr_b16 v[160:161], v202 offset:10240
    ds_read_b64_tr_b16 v[162:163], v202 offset:10752
    ds_read_b64_tr_b16 v[164:165], v202 offset:18432
    ds_read_b64_tr_b16 v[166:167], v202 offset:18944
    s_waitcnt lgkmcnt(8)
    v_mfma_f32_32x32x16_bf16 v[32:47], v[136:139], v[128:131], v[32:47]
    v_mfma_f32_32x32x16_bf16 v[48:63], v[128:131], v[140:143], v[48:63]
    v_mfma_f32_32x32x16_bf16 v[64:79], v[128:131], v[144:147], v[64:79]
    v_mfma_f32_32x32x16_bf16 v[80:95], v[136:139], v[132:135], v[80:95]
    v_mfma_f32_32x32x16_bf16 v[96:111], v[132:135], v[140:143], v[96:111]
    v_mfma_f32_32x32x16_bf16 v[112:127], v[132:135], v[144:147], v[112:127]
    ds_read_b128 v[128:131], v194 offset:0
    ds_read_b128 v[132:135], v194 offset:4096
    ds_read_b64_tr_b16 v[136:137], v202 offset:4096
    ds_read_b64_tr_b16 v[138:139], v202 offset:4608
    ds_read_b64_tr_b16 v[140:141], v202 offset:12288
    ds_read_b64_tr_b16 v[142:143], v202 offset:12800
    ds_read_b64_tr_b16 v[144:145], v202 offset:20480
    ds_read_b64_tr_b16 v[146:147], v202 offset:20992
    s_waitcnt lgkmcnt(8)
    v_mfma_f32_32x32x16_bf16 v[32:47], v[156:159], v[148:151], v[32:47]
    v_mfma_f32_32x32x16_bf16 v[48:63], v[148:151], v[160:163], v[48:63]
    v_mfma_f32_32x32x16_bf16 v[64:79], v[148:151], v[164:167], v[64:79]
    v_mfma_f32_32x32x16_bf16 v[80:95], v[156:159], v[152:155], v[80:95]
    v_mfma_f32_32x32x16_bf16 v[96:111], v[152:155], v[160:163], v[96:111]
    v_mfma_f32_32x32x16_bf16 v[112:127], v[152:155], v[164:167], v[112:127]
    ds_read_b128 v[148:151], v195 offset:0
    ds_read_b128 v[152:155], v195 offset:4096
    ds_read_b64_tr_b16 v[156:157], v202 offset:6144
    ds_read_b64_tr_b16 v[158:159], v202 offset:6656
    ds_read_b64_tr_b16 v[160:161], v202 offset:14336
    ds_read_b64_tr_b16 v[162:163], v202 offset:14848
    ds_read_b64_tr_b16 v[164:165], v202 offset:22528
    ds_read_b64_tr_b16 v[166:167], v202 offset:23040
    s_waitcnt lgkmcnt(8)
    v_mfma_f32_32x32x16_bf16 v[32:47], v[136:139], v[128:131], v[32:47]
    v_mfma_f32_32x32x16_bf16 v[48:63], v[128:131], v[140:143], v[48:63]
    v_mfma_f32_32x32x16_bf16 v[64:79], v[128:131], v[144:147], v[64:79]
    v_mfma_f32_32x32x16_bf16 v[80:95], v[136:139], v[132:135], v[80:95]
    v_mfma_f32_32x32x16_bf16 v[96:111], v[132:135], v[140:143], v[96:111]
    v_mfma_f32_32x32x16_bf16 v[112:127], v[132:135], v[144:147], v[112:127]
    s_waitcnt lgkmcnt(0)
    v_mfma_f32_32x32x16_bf16 v[32:47], v[156:159], v[148:151], v[32:47]
    v_mfma_f32_32x32x16_bf16 v[48:63], v[148:151], v[160:163], v[48:63]
    v_mfma_f32_32x32x16_bf16 v[64:79], v[148:151], v[164:167], v[64:79]
    v_mfma_f32_32x32x16_bf16 v[80:95], v[156:159], v[152:155], v[80:95]
    v_mfma_f32_32x32x16_bf16 v[96:111], v[152:155], v[160:163], v[96:111]
    v_mfma_f32_32x32x16_bf16 v[112:127], v[152:155], v[164:167], v[112:127]
    s_waitcnt vmcnt(20)
    s_barrier
    s_add_u32 s58, s57, 81920
    s_mov_b32 m0, s58
    s_add_u32 s59, s41, s60
    buffer_load_dwordx4 v176, s[8:11], s59 offen lds
    s_add_u32 s58, s57, 82944
    s_mov_b32 m0, s58
    s_add_u32 s59, s41, s60
    buffer_load_dwordx4 v177, s[8:11], s59 offen lds
    s_add_u32 s58, s57, 83968
    s_mov_b32 m0, s58
    s_add_u32 s59, s41, s60
    buffer_load_dwordx4 v178, s[8:11], s59 offen lds
    s_add_u32 s58, s57, 84992
    s_mov_b32 m0, s58
    s_add_u32 s59, s41, s60
    buffer_load_dwordx4 v179, s[8:11], s59 offen lds
    s_add_u32 s58, s51, 81920
    s_mov_b32 m0, s58
    s_add_u32 s59, s45, s61
    buffer_load_dwordx4 v180, s[12:15], s59 offen lds
    s_add_u32 s58, s52, 81920
    s_mov_b32 m0, s58
    s_add_u32 s59, s46, s61
    buffer_load_dwordx4 v180, s[12:15], s59 offen lds
    s_add_u32 s58, s53, 81920
    s_mov_b32 m0, s58
    s_add_u32 s59, s47, s61
    buffer_load_dwordx4 v180, s[12:15], s59 offen lds
    s_add_u32 s58, s54, 81920
    s_mov_b32 m0, s58
    s_add_u32 s59, s48, s61
    buffer_load_dwordx4 v180, s[12:15], s59 offen lds
    s_add_u32 s58, s55, 81920
    s_mov_b32 m0, s58
    s_add_u32 s59, s49, s61
    buffer_load_dwordx4 v180, s[12:15], s59 offen lds
    s_add_u32 s58, s56, 81920
    s_mov_b32 m0, s58
    s_add_u32 s59, s50, s61
    buffer_load_dwordx4 v180, s[12:15], s59 offen lds
    s_add_u32 s60, s60, 128
    s_add_u32 s61, s61, 393216
    ds_read_b128 v[128:131], v196 offset:0
    ds_read_b128 v[132:135], v196 offset:4096
    ds_read_b64_tr_b16 v[136:137], v203 offset:0
    ds_read_b64_tr_b16 v[138:139], v203 offset:512
    ds_read_b64_tr_b16 v[140:141], v203 offset:8192
    ds_read_b64_tr_b16 v[142:143], v203 offset:8704
    ds_read_b64_tr_b16 v[144:145], v203 offset:16384
    ds_read_b64_tr_b16 v[146:147], v203 offset:16896
    ds_read_b128 v[148:151], v197 offset:0
    ds_read_b128 v[152:155], v197 offset:4096
    ds_read_b64_tr_b16 v[156:157], v203 offset:2048
    ds_read_b64_tr_b16 v[158:159], v203 offset:2560
    ds_read_b64_tr_b16 v[160:161], v203 offset:10240
    ds_read_b64_tr_b16 v[162:163], v203 offset:10752
    ds_read_b64_tr_b16 v[164:165], v203 offset:18432
    ds_read_b64_tr_b16 v[166:167], v203 offset:18944
    s_waitcnt lgkmcnt(8)
    v_mfma_f32_32x32x16_bf16 v[32:47], v[136:139], v[128:131], v[32:47]
    v_mfma_f32_32x32x16_bf16 v[48:63], v[128:131], v[140:143], v[48:63]
    v_mfma_f32_32x32x16_bf16 v[64:79], v[128:131], v[144:147], v[64:79]
    v_mfma_f32_32x32x16_bf16 v[80:95], v[136:139], v[132:135], v[80:95]
    v_mfma_f32_32x32x16_bf16 v[96:111], v[132:135], v[140:143], v[96:111]
    v_mfma_f32_32x32x16_bf16 v[112:127], v[132:135], v[144:147], v[112:127]
    ds_read_b128 v[128:131], v198 offset:0
    ds_read_b128 v[132:135], v198 offset:4096
    ds_read_b64_tr_b16 v[136:137], v203 offset:4096
    ds_read_b64_tr_b16 v[138:139], v203 offset:4608
    ds_read_b64_tr_b16 v[140:141], v203 offset:12288
    ds_read_b64_tr_b16 v[142:143], v203 offset:12800
    ds_read_b64_tr_b16 v[144:145], v203 offset:20480
    ds_read_b64_tr_b16 v[146:147], v203 offset:20992
    s_waitcnt lgkmcnt(8)
    v_mfma_f32_32x32x16_bf16 v[32:47], v[156:159], v[148:151], v[32:47]
    v_mfma_f32_32x32x16_bf16 v[48:63], v[148:151], v[160:163], v[48:63]
    v_mfma_f32_32x32x16_bf16 v[64:79], v[148:151], v[164:167], v[64:79]
    v_mfma_f32_32x32x16_bf16 v[80:95], v[156:159], v[152:155], v[80:95]
    v_mfma_f32_32x32x16_bf16 v[96:111], v[152:155], v[160:163], v[96:111]
    v_mfma_f32_32x32x16_bf16 v[112:127], v[152:155], v[164:167], v[112:127]
    ds_read_b128 v[148:151], v199 offset:0
    ds_read_b128 v[152:155], v199 offset:4096
    ds_read_b64_tr_b16 v[156:157], v203 offset:6144
    ds_read_b64_tr_b16 v[158:159], v203 offset:6656
    ds_read_b64_tr_b16 v[160:161], v203 offset:14336
    ds_read_b64_tr_b16 v[162:163], v203 offset:14848
    ds_read_b64_tr_b16 v[164:165], v203 offset:22528
    ds_read_b64_tr_b16 v[166:167], v203 offset:23040
    s_waitcnt lgkmcnt(8)
    v_mfma_f32_32x32x16_bf16 v[32:47], v[136:139], v[128:131], v[32:47]
    v_mfma_f32_32x32x16_bf16 v[48:63], v[128:131], v[140:143], v[48:63]
    v_mfma_f32_32x32x16_bf16 v[64:79], v[128:131], v[144:147], v[64:79]
    v_mfma_f32_32x32x16_bf16 v[80:95], v[136:139], v[132:135], v[80:95]
    v_mfma_f32_32x32x16_bf16 v[96:111], v[132:135], v[140:143], v[96:111]
    v_mfma_f32_32x32x16_bf16 v[112:127], v[132:135], v[144:147], v[112:127]
    s_waitcnt lgkmcnt(0)
    v_mfma_f32_32x32x16_bf16 v[32:47], v[156:159], v[148:151], v[32:47]
    v_mfma_f32_32x32x16_bf16 v[48:63], v[148:151], v[160:163], v[48:63]
    v_mfma_f32_32x32x16_bf16 v[64:79], v[148:151], v[164:167], v[64:79]
    v_mfma_f32_32x32x16_bf16 v[80:95], v[156:159], v[152:155], v[80:95]
    v_mfma_f32_32x32x16_bf16 v[96:111], v[152:155], v[160:163], v[96:111]
    v_mfma_f32_32x32x16_bf16 v[112:127], v[152:155], v[164:167], v[112:127]
    s_waitcnt vmcnt(20)
    s_barrier
    s_add_u32 s62, s62, 1
    s_cmp_lt_u32 s62, 3
    s_cbranch_scc1 L_gl_k1a_kernel
    s_add_u32 s58, s57, 122880
    s_mov_b32 m0, s58
    s_add_u32 s59, s41, s60
    buffer_load_dwordx4 v176, s[8:11], s59 offen lds
    s_add_u32 s58, s57, 123904
    s_mov_b32 m0, s58
    s_add_u32 s59, s41, s60
    buffer_load_dwordx4 v177, s[8:11], s59 offen lds
    s_add_u32 s58, s57, 124928
    s_mov_b32 m0, s58
    s_add_u32 s59, s41, s60
    buffer_load_dwordx4 v178, s[8:11], s59 offen lds
    s_add_u32 s58, s57, 125952
    s_mov_b32 m0, s58
    s_add_u32 s59, s41, s60
    buffer_load_dwordx4 v179, s[8:11], s59 offen lds
    s_add_u32 s58, s51, 122880
    s_mov_b32 m0, s58
    s_add_u32 s59, s45, s61
    buffer_load_dwordx4 v180, s[12:15], s59 offen lds
    s_add_u32 s58, s52, 122880
    s_mov_b32 m0, s58
    s_add_u32 s59, s46, s61
    buffer_load_dwordx4 v180, s[12:15], s59 offen lds
    s_add_u32 s58, s53, 122880
    s_mov_b32 m0, s58
    s_add_u32 s59, s47, s61
    buffer_load_dwordx4 v180, s[12:15], s59 offen lds
    s_add_u32 s58, s54, 122880
    s_mov_b32 m0, s58
    s_add_u32 s59, s48, s61
    buffer_load_dwordx4 v180, s[12:15], s59 offen lds
    s_add_u32 s58, s55, 122880
    s_mov_b32 m0, s58
    s_add_u32 s59, s49, s61
    buffer_load_dwordx4 v180, s[12:15], s59 offen lds
    s_add_u32 s58, s56, 122880
    s_mov_b32 m0, s58
    s_add_u32 s59, s50, s61
    buffer_load_dwordx4 v180, s[12:15], s59 offen lds
    s_add_u32 s60, s60, 128
    s_add_u32 s61, s61, 393216
    ds_read_b128 v[128:131], v184 offset:0
    ds_read_b128 v[132:135], v184 offset:4096
    ds_read_b64_tr_b16 v[136:137], v200 offset:0
    ds_read_b64_tr_b16 v[138:139], v200 offset:512
    ds_read_b64_tr_b16 v[140:141], v200 offset:8192
    ds_read_b64_tr_b16 v[142:143], v200 offset:8704
    ds_read_b64_tr_b16 v[144:145], v200 offset:16384
    ds_read_b64_tr_b16 v[146:147], v200 offset:16896
    ds_read_b128 v[148:151], v185 offset:0
    ds_read_b128 v[152:155], v185 offset:4096
    ds_read_b64_tr_b16 v[156:157], v200 offset:2048
    ds_read_b64_tr_b16 v[158:159], v200 offset:2560
    ds_read_b64_tr_b16 v[160:161], v200 offset:10240
    ds_read_b64_tr_b16 v[162:163], v200 offset:10752
    ds_read_b64_tr_b16 v[164:165], v200 offset:18432
    ds_read_b64_tr_b16 v[166:167], v200 offset:18944
    s_waitcnt lgkmcnt(8)
    v_mfma_f32_32x32x16_bf16 v[32:47], v[136:139], v[128:131], v[32:47]
    v_mfma_f32_32x32x16_bf16 v[48:63], v[128:131], v[140:143], v[48:63]
    v_mfma_f32_32x32x16_bf16 v[64:79], v[128:131], v[144:147], v[64:79]
    v_mfma_f32_32x32x16_bf16 v[80:95], v[136:139], v[132:135], v[80:95]
    v_mfma_f32_32x32x16_bf16 v[96:111], v[132:135], v[140:143], v[96:111]
    v_mfma_f32_32x32x16_bf16 v[112:127], v[132:135], v[144:147], v[112:127]
    ds_read_b128 v[128:131], v186 offset:0
    ds_read_b128 v[132:135], v186 offset:4096
    ds_read_b64_tr_b16 v[136:137], v200 offset:4096
    ds_read_b64_tr_b16 v[138:139], v200 offset:4608
    ds_read_b64_tr_b16 v[140:141], v200 offset:12288
    ds_read_b64_tr_b16 v[142:143], v200 offset:12800
    ds_read_b64_tr_b16 v[144:145], v200 offset:20480
    ds_read_b64_tr_b16 v[146:147], v200 offset:20992
    s_waitcnt lgkmcnt(8)
    v_mfma_f32_32x32x16_bf16 v[32:47], v[156:159], v[148:151], v[32:47]
    v_mfma_f32_32x32x16_bf16 v[48:63], v[148:151], v[160:163], v[48:63]
    v_mfma_f32_32x32x16_bf16 v[64:79], v[148:151], v[164:167], v[64:79]
    v_mfma_f32_32x32x16_bf16 v[80:95], v[156:159], v[152:155], v[80:95]
    v_mfma_f32_32x32x16_bf16 v[96:111], v[152:155], v[160:163], v[96:111]
    v_mfma_f32_32x32x16_bf16 v[112:127], v[152:155], v[164:167], v[112:127]
    ds_read_b128 v[148:151], v187 offset:0
    ds_read_b128 v[152:155], v187 offset:4096
    ds_read_b64_tr_b16 v[156:157], v200 offset:6144
    ds_read_b64_tr_b16 v[158:159], v200 offset:6656
    ds_read_b64_tr_b16 v[160:161], v200 offset:14336
    ds_read_b64_tr_b16 v[162:163], v200 offset:14848
    ds_read_b64_tr_b16 v[164:165], v200 offset:22528
    ds_read_b64_tr_b16 v[166:167], v200 offset:23040
    s_waitcnt lgkmcnt(8)
    v_mfma_f32_32x32x16_bf16 v[32:47], v[136:139], v[128:131], v[32:47]
    v_mfma_f32_32x32x16_bf16 v[48:63], v[128:131], v[140:143], v[48:63]
    v_mfma_f32_32x32x16_bf16 v[64:79], v[128:131], v[144:147], v[64:79]
    v_mfma_f32_32x32x16_bf16 v[80:95], v[136:139], v[132:135], v[80:95]
    v_mfma_f32_32x32x16_bf16 v[96:111], v[132:135], v[140:143], v[96:111]
    v_mfma_f32_32x32x16_bf16 v[112:127], v[132:135], v[144:147], v[112:127]
    s_waitcnt lgkmcnt(0)
    v_mfma_f32_32x32x16_bf16 v[32:47], v[156:159], v[148:151], v[32:47]
    v_mfma_f32_32x32x16_bf16 v[48:63], v[148:151], v[160:163], v[48:63]
    v_mfma_f32_32x32x16_bf16 v[64:79], v[148:151], v[164:167], v[64:79]
    v_mfma_f32_32x32x16_bf16 v[80:95], v[156:159], v[152:155], v[80:95]
    v_mfma_f32_32x32x16_bf16 v[96:111], v[152:155], v[160:163], v[96:111]
    v_mfma_f32_32x32x16_bf16 v[112:127], v[152:155], v[164:167], v[112:127]
    s_waitcnt vmcnt(20)
    s_barrier
    ds_read_b128 v[128:131], v188 offset:0
    ds_read_b128 v[132:135], v188 offset:4096
    ds_read_b64_tr_b16 v[136:137], v201 offset:0
    ds_read_b64_tr_b16 v[138:139], v201 offset:512
    ds_read_b64_tr_b16 v[140:141], v201 offset:8192
    ds_read_b64_tr_b16 v[142:143], v201 offset:8704
    ds_read_b64_tr_b16 v[144:145], v201 offset:16384
    ds_read_b64_tr_b16 v[146:147], v201 offset:16896
    ds_read_b128 v[148:151], v189 offset:0
    ds_read_b128 v[152:155], v189 offset:4096
    ds_read_b64_tr_b16 v[156:157], v201 offset:2048
    ds_read_b64_tr_b16 v[158:159], v201 offset:2560
    ds_read_b64_tr_b16 v[160:161], v201 offset:10240
    ds_read_b64_tr_b16 v[162:163], v201 offset:10752
    ds_read_b64_tr_b16 v[164:165], v201 offset:18432
    ds_read_b64_tr_b16 v[166:167], v201 offset:18944
    s_waitcnt lgkmcnt(8)
    v_mfma_f32_32x32x16_bf16 v[32:47], v[136:139], v[128:131], v[32:47]
    v_mfma_f32_32x32x16_bf16 v[48:63], v[128:131], v[140:143], v[48:63]
    v_mfma_f32_32x32x16_bf16 v[64:79], v[128:131], v[144:147], v[64:79]
    v_mfma_f32_32x32x16_bf16 v[80:95], v[136:139], v[132:135], v[80:95]
    v_mfma_f32_32x32x16_bf16 v[96:111], v[132:135], v[140:143], v[96:111]
    v_mfma_f32_32x32x16_bf16 v[112:127], v[132:135], v[144:147], v[112:127]
    ds_read_b128 v[128:131], v190 offset:0
    ds_read_b128 v[132:135], v190 offset:4096
    ds_read_b64_tr_b16 v[136:137], v201 offset:4096
    ds_read_b64_tr_b16 v[138:139], v201 offset:4608
    ds_read_b64_tr_b16 v[140:141], v201 offset:12288
    ds_read_b64_tr_b16 v[142:143], v201 offset:12800
    ds_read_b64_tr_b16 v[144:145], v201 offset:20480
    ds_read_b64_tr_b16 v[146:147], v201 offset:20992
    s_waitcnt lgkmcnt(8)
    v_mfma_f32_32x32x16_bf16 v[32:47], v[156:159], v[148:151], v[32:47]
    v_mfma_f32_32x32x16_bf16 v[48:63], v[148:151], v[160:163], v[48:63]
    v_mfma_f32_32x32x16_bf16 v[64:79], v[148:151], v[164:167], v[64:79]
    v_mfma_f32_32x32x16_bf16 v[80:95], v[156:159], v[152:155], v[80:95]
    v_mfma_f32_32x32x16_bf16 v[96:111], v[152:155], v[160:163], v[96:111]
    v_mfma_f32_32x32x16_bf16 v[112:127], v[152:155], v[164:167], v[112:127]
    ds_read_b128 v[148:151], v191 offset:0
    ds_read_b128 v[152:155], v191 offset:4096
    ds_read_b64_tr_b16 v[156:157], v201 offset:6144
    ds_read_b64_tr_b16 v[158:159], v201 offset:6656
    ds_read_b64_tr_b16 v[160:161], v201 offset:14336
    ds_read_b64_tr_b16 v[162:163], v201 offset:14848
    ds_read_b64_tr_b16 v[164:165], v201 offset:22528
    ds_read_b64_tr_b16 v[166:167], v201 offset:23040
    s_waitcnt lgkmcnt(8)
    v_mfma_f32_32x32x16_bf16 v[32:47], v[136:139], v[128:131], v[32:47]
    v_mfma_f32_32x32x16_bf16 v[48:63], v[128:131], v[140:143], v[48:63]
    v_mfma_f32_32x32x16_bf16 v[64:79], v[128:131], v[144:147], v[64:79]
    v_mfma_f32_32x32x16_bf16 v[80:95], v[136:139], v[132:135], v[80:95]
    v_mfma_f32_32x32x16_bf16 v[96:111], v[132:135], v[140:143], v[96:111]
    v_mfma_f32_32x32x16_bf16 v[112:127], v[132:135], v[144:147], v[112:127]
    s_waitcnt lgkmcnt(0)
    v_mfma_f32_32x32x16_bf16 v[32:47], v[156:159], v[148:151], v[32:47]
    v_mfma_f32_32x32x16_bf16 v[48:63], v[148:151], v[160:163], v[48:63]
    v_mfma_f32_32x32x16_bf16 v[64:79], v[148:151], v[164:167], v[64:79]
    v_mfma_f32_32x32x16_bf16 v[80:95], v[156:159], v[152:155], v[80:95]
    v_mfma_f32_32x32x16_bf16 v[96:111], v[152:155], v[160:163], v[96:111]
    v_mfma_f32_32x32x16_bf16 v[112:127], v[152:155], v[164:167], v[112:127]
    s_waitcnt vmcnt(10)
    s_barrier
    ds_read_b128 v[128:131], v192 offset:0
    ds_read_b128 v[132:135], v192 offset:4096
    ds_read_b64_tr_b16 v[136:137], v202 offset:0
    ds_read_b64_tr_b16 v[138:139], v202 offset:512
    ds_read_b64_tr_b16 v[140:141], v202 offset:8192
    ds_read_b64_tr_b16 v[142:143], v202 offset:8704
    ds_read_b64_tr_b16 v[144:145], v202 offset:16384
    ds_read_b64_tr_b16 v[146:147], v202 offset:16896
    ds_read_b128 v[148:151], v193 offset:0
    ds_read_b128 v[152:155], v193 offset:4096
    ds_read_b64_tr_b16 v[156:157], v202 offset:2048
    ds_read_b64_tr_b16 v[158:159], v202 offset:2560
    ds_read_b64_tr_b16 v[160:161], v202 offset:10240
    ds_read_b64_tr_b16 v[162:163], v202 offset:10752
    ds_read_b64_tr_b16 v[164:165], v202 offset:18432
    ds_read_b64_tr_b16 v[166:167], v202 offset:18944
    s_waitcnt lgkmcnt(8)
    v_mfma_f32_32x32x16_bf16 v[32:47], v[136:139], v[128:131], v[32:47]
    v_mfma_f32_32x32x16_bf16 v[48:63], v[128:131], v[140:143], v[48:63]
    v_mfma_f32_32x32x16_bf16 v[64:79], v[128:131], v[144:147], v[64:79]
    v_mfma_f32_32x32x16_bf16 v[80:95], v[136:139], v[132:135], v[80:95]
    v_mfma_f32_32x32x16_bf16 v[96:111], v[132:135], v[140:143], v[96:111]
    v_mfma_f32_32x32x16_bf16 v[112:127], v[132:135], v[144:147], v[112:127]
    ds_read_b128 v[128:131], v194 offset:0
    ds_read_b128 v[132:135], v194 offset:4096
    ds_read_b64_tr_b16 v[136:137], v202 offset:4096
    ds_read_b64_tr_b16 v[138:139], v202 offset:4608
    ds_read_b64_tr_b16 v[140:141], v202 offset:12288
    ds_read_b64_tr_b16 v[142:143], v202 offset:12800
    ds_read_b64_tr_b16 v[144:145], v202 offset:20480
    ds_read_b64_tr_b16 v[146:147], v202 offset:20992
    s_waitcnt lgkmcnt(8)
    v_mfma_f32_32x32x16_bf16 v[32:47], v[156:159], v[148:151], v[32:47]
    v_mfma_f32_32x32x16_bf16 v[48:63], v[148:151], v[160:163], v[48:63]
    v_mfma_f32_32x32x16_bf16 v[64:79], v[148:151], v[164:167], v[64:79]
    v_mfma_f32_32x32x16_bf16 v[80:95], v[156:159], v[152:155], v[80:95]
    v_mfma_f32_32x32x16_bf16 v[96:111], v[152:155], v[160:163], v[96:111]
    v_mfma_f32_32x32x16_bf16 v[112:127], v[152:155], v[164:167], v[112:127]
    ds_read_b128 v[148:151], v195 offset:0
    ds_read_b128 v[152:155], v195 offset:4096
    ds_read_b64_tr_b16 v[156:157], v202 offset:6144
    ds_read_b64_tr_b16 v[158:159], v202 offset:6656
    ds_read_b64_tr_b16 v[160:161], v202 offset:14336
    ds_read_b64_tr_b16 v[162:163], v202 offset:14848
    ds_read_b64_tr_b16 v[164:165], v202 offset:22528
    ds_read_b64_tr_b16 v[166:167], v202 offset:23040
    s_waitcnt lgkmcnt(8)
    v_mfma_f32_32x32x16_bf16 v[32:47], v[136:139], v[128:131], v[32:47]
    v_mfma_f32_32x32x16_bf16 v[48:63], v[128:131], v[140:143], v[48:63]
    v_mfma_f32_32x32x16_bf16 v[64:79], v[128:131], v[144:147], v[64:79]
    v_mfma_f32_32x32x16_bf16 v[80:95], v[136:139], v[132:135], v[80:95]
    v_mfma_f32_32x32x16_bf16 v[96:111], v[132:135], v[140:143], v[96:111]
    v_mfma_f32_32x32x16_bf16 v[112:127], v[132:135], v[144:147], v[112:127]
    s_waitcnt lgkmcnt(0)
    v_mfma_f32_32x32x16_bf16 v[32:47], v[156:159], v[148:151], v[32:47]
    v_mfma_f32_32x32x16_bf16 v[48:63], v[148:151], v[160:163], v[48:63]
    v_mfma_f32_32x32x16_bf16 v[64:79], v[148:151], v[164:167], v[64:79]
    v_mfma_f32_32x32x16_bf16 v[80:95], v[156:159], v[152:155], v[80:95]
    v_mfma_f32_32x32x16_bf16 v[96:111], v[152:155], v[160:163], v[96:111]
    v_mfma_f32_32x32x16_bf16 v[112:127], v[152:155], v[164:167], v[112:127]
    s_waitcnt vmcnt(0)
    s_barrier
    ds_read_b128 v[128:131], v196 offset:0
    ds_read_b128 v[132:135], v196 offset:4096
    ds_read_b64_tr_b16 v[136:137], v203 offset:0
    ds_read_b64_tr_b16 v[138:139], v203 offset:512
    ds_read_b64_tr_b16 v[140:141], v203 offset:8192
    ds_read_b64_tr_b16 v[142:143], v203 offset:8704
    ds_read_b64_tr_b16 v[144:145], v203 offset:16384
    ds_read_b64_tr_b16 v[146:147], v203 offset:16896
    ds_read_b128 v[148:151], v197 offset:0
    ds_read_b128 v[152:155], v197 offset:4096
    ds_read_b64_tr_b16 v[156:157], v203 offset:2048
    ds_read_b64_tr_b16 v[158:159], v203 offset:2560
    ds_read_b64_tr_b16 v[160:161], v203 offset:10240
    ds_read_b64_tr_b16 v[162:163], v203 offset:10752
    ds_read_b64_tr_b16 v[164:165], v203 offset:18432
    ds_read_b64_tr_b16 v[166:167], v203 offset:18944
    s_waitcnt lgkmcnt(8)
    v_mfma_f32_32x32x16_bf16 v[32:47], v[136:139], v[128:131], v[32:47]
    v_mfma_f32_32x32x16_bf16 v[48:63], v[128:131], v[140:143], v[48:63]
    v_mfma_f32_32x32x16_bf16 v[64:79], v[128:131], v[144:147], v[64:79]
    v_mfma_f32_32x32x16_bf16 v[80:95], v[136:139], v[132:135], v[80:95]
    v_mfma_f32_32x32x16_bf16 v[96:111], v[132:135], v[140:143], v[96:111]
    v_mfma_f32_32x32x16_bf16 v[112:127], v[132:135], v[144:147], v[112:127]
    ds_read_b128 v[128:131], v198 offset:0
    ds_read_b128 v[132:135], v198 offset:4096
    ds_read_b64_tr_b16 v[136:137], v203 offset:4096
    ds_read_b64_tr_b16 v[138:139], v203 offset:4608
    ds_read_b64_tr_b16 v[140:141], v203 offset:12288
    ds_read_b64_tr_b16 v[142:143], v203 offset:12800
    ds_read_b64_tr_b16 v[144:145], v203 offset:20480
    ds_read_b64_tr_b16 v[146:147], v203 offset:20992
    s_waitcnt lgkmcnt(8)
    v_mfma_f32_32x32x16_bf16 v[32:47], v[156:159], v[148:151], v[32:47]
    v_mfma_f32_32x32x16_bf16 v[48:63], v[148:151], v[160:163], v[48:63]
    v_mfma_f32_32x32x16_bf16 v[64:79], v[148:151], v[164:167], v[64:79]
    v_mfma_f32_32x32x16_bf16 v[80:95], v[156:159], v[152:155], v[80:95]
    v_mfma_f32_32x32x16_bf16 v[96:111], v[152:155], v[160:163], v[96:111]
    v_mfma_f32_32x32x16_bf16 v[112:127], v[152:155], v[164:167], v[112:127]
    ds_read_b128 v[148:151], v199 offset:0
    ds_read_b128 v[152:155], v199 offset:4096
    ds_read_b64_tr_b16 v[156:157], v203 offset:6144
    ds_read_b64_tr_b16 v[158:159], v203 offset:6656
    ds_read_b64_tr_b16 v[160:161], v203 offset:14336
    ds_read_b64_tr_b16 v[162:163], v203 offset:14848
    ds_read_b64_tr_b16 v[164:165], v203 offset:22528
    ds_read_b64_tr_b16 v[166:167], v203 offset:23040
    s_waitcnt lgkmcnt(8)
    v_mfma_f32_32x32x16_bf16 v[32:47], v[136:139], v[128:131], v[32:47]
    v_mfma_f32_32x32x16_bf16 v[48:63], v[128:131], v[140:143], v[48:63]
    v_mfma_f32_32x32x16_bf16 v[64:79], v[128:131], v[144:147], v[64:79]
    v_mfma_f32_32x32x16_bf16 v[80:95], v[136:139], v[132:135], v[80:95]
    v_mfma_f32_32x32x16_bf16 v[96:111], v[132:135], v[140:143], v[96:111]
    v_mfma_f32_32x32x16_bf16 v[112:127], v[132:135], v[144:147], v[112:127]
    s_waitcnt lgkmcnt(0)
    v_mfma_f32_32x32x16_bf16 v[32:47], v[156:159], v[148:151], v[32:47]
    v_mfma_f32_32x32x16_bf16 v[48:63], v[148:151], v[160:163], v[48:63]
    v_mfma_f32_32x32x16_bf16 v[64:79], v[148:151], v[164:167], v[64:79]
    v_mfma_f32_32x32x16_bf16 v[80:95], v[156:159], v[152:155], v[80:95]
    v_mfma_f32_32x32x16_bf16 v[96:111], v[152:155], v[160:163], v[96:111]
    v_mfma_f32_32x32x16_bf16 v[112:127], v[152:155], v[164:167], v[112:127]
    s_nop 15
    s_nop 7
    v_cvt_pk_bf16_f32 v176, v32, v33
    v_lshlrev_b32 v32, 16, v176
    v_and_b32 v33, 0xffff0000, v176
    v_mul_f32 v176, 1069066811, v32
    v_mul_f32 v177, 1069066811, v33
    v_exp_f32 v176, v176
    v_exp_f32 v177, v177
    v_add_f32 v178, 1.0, v32
    v_add_f32 v179, 1.0, v33
    v_cmp_lt_f32 vcc, 0, v32
    s_nop 1
    v_cndmask_b32 v176, v176, v178, vcc
    v_cmp_lt_f32 vcc, 0, v33
    s_nop 1
    v_cndmask_b32 v177, v177, v179, vcc
    v_cvt_pk_bf16_f32 v178, v176, v177
    v_lshlrev_b32 v176, 16, v178
    v_and_b32 v177, 0xffff0000, v178
    v_add_f32 v32, 0x358637bd, v176
    v_add_f32 v33, 0x358637bd, v177
    v_cvt_pk_bf16_f32 v178, v32, v33
    v_lshlrev_b32 v32, 16, v178
    v_and_b32 v33, 0xffff0000, v178
    v_cvt_pk_bf16_f32 v176, v34, v35
    v_lshlrev_b32 v34, 16, v176
    v_and_b32 v35, 0xffff0000, v176
    v_mul_f32 v176, 1069066811, v34
    v_mul_f32 v177, 1069066811, v35
    v_exp_f32 v176, v176
    v_exp_f32 v177, v177
    v_add_f32 v178, 1.0, v34
    v_add_f32 v179, 1.0, v35
    v_cmp_lt_f32 vcc, 0, v34
    s_nop 1
    v_cndmask_b32 v176, v176, v178, vcc
    v_cmp_lt_f32 vcc, 0, v35
    s_nop 1
    v_cndmask_b32 v177, v177, v179, vcc
    v_cvt_pk_bf16_f32 v178, v176, v177
    v_lshlrev_b32 v176, 16, v178
    v_and_b32 v177, 0xffff0000, v178
    v_add_f32 v34, 0x358637bd, v176
    v_add_f32 v35, 0x358637bd, v177
    v_cvt_pk_bf16_f32 v178, v34, v35
    v_lshlrev_b32 v34, 16, v178
    v_and_b32 v35, 0xffff0000, v178
    v_cvt_pk_bf16_f32 v176, v36, v37
    v_lshlrev_b32 v36, 16, v176
    v_and_b32 v37, 0xffff0000, v176
    v_mul_f32 v176, 1069066811, v36
    v_mul_f32 v177, 1069066811, v37
    v_exp_f32 v176, v176
    v_exp_f32 v177, v177
    v_add_f32 v178, 1.0, v36
    v_add_f32 v179, 1.0, v37
    v_cmp_lt_f32 vcc, 0, v36
    s_nop 1
    v_cndmask_b32 v176, v176, v178, vcc
    v_cmp_lt_f32 vcc, 0, v37
    s_nop 1
    v_cndmask_b32 v177, v177, v179, vcc
    v_cvt_pk_bf16_f32 v178, v176, v177
    v_lshlrev_b32 v176, 16, v178
    v_and_b32 v177, 0xffff0000, v178
    v_add_f32 v36, 0x358637bd, v176
    v_add_f32 v37, 0x358637bd, v177
    v_cvt_pk_bf16_f32 v178, v36, v37
    v_lshlrev_b32 v36, 16, v178
    v_and_b32 v37, 0xffff0000, v178
    v_cvt_pk_bf16_f32 v176, v38, v39
    v_lshlrev_b32 v38, 16, v176
    v_and_b32 v39, 0xffff0000, v176
    v_mul_f32 v176, 1069066811, v38
    v_mul_f32 v177, 1069066811, v39
    v_exp_f32 v176, v176
    v_exp_f32 v177, v177
    v_add_f32 v178, 1.0, v38
    v_add_f32 v179, 1.0, v39
    v_cmp_lt_f32 vcc, 0, v38
    s_nop 1
    v_cndmask_b32 v176, v176, v178, vcc
    v_cmp_lt_f32 vcc, 0, v39
    s_nop 1
    v_cndmask_b32 v177, v177, v179, vcc
    v_cvt_pk_bf16_f32 v178, v176, v177
    v_lshlrev_b32 v176, 16, v178
    v_and_b32 v177, 0xffff0000, v178
    v_add_f32 v38, 0x358637bd, v176
    v_add_f32 v39, 0x358637bd, v177
    v_cvt_pk_bf16_f32 v178, v38, v39
    v_lshlrev_b32 v38, 16, v178
    v_and_b32 v39, 0xffff0000, v178
    v_cvt_pk_bf16_f32 v176, v40, v41
    v_lshlrev_b32 v40, 16, v176
    v_and_b32 v41, 0xffff0000, v176
    v_mul_f32 v176, 1069066811, v40
    v_mul_f32 v177, 1069066811, v41
    v_exp_f32 v176, v176
    v_exp_f32 v177, v177
    v_add_f32 v178, 1.0, v40
    v_add_f32 v179, 1.0, v41
    v_cmp_lt_f32 vcc, 0, v40
    s_nop 1
    v_cndmask_b32 v176, v176, v178, vcc
    v_cmp_lt_f32 vcc, 0, v41
    s_nop 1
    v_cndmask_b32 v177, v177, v179, vcc
    v_cvt_pk_bf16_f32 v178, v176, v177
    v_lshlrev_b32 v176, 16, v178
    v_and_b32 v177, 0xffff0000, v178
    v_add_f32 v40, 0x358637bd, v176
    v_add_f32 v41, 0x358637bd, v177
    v_cvt_pk_bf16_f32 v178, v40, v41
    v_lshlrev_b32 v40, 16, v178
    v_and_b32 v41, 0xffff0000, v178
    v_cvt_pk_bf16_f32 v176, v42, v43
    v_lshlrev_b32 v42, 16, v176
    v_and_b32 v43, 0xffff0000, v176
    v_mul_f32 v176, 1069066811, v42
    v_mul_f32 v177, 1069066811, v43
    v_exp_f32 v176, v176
    v_exp_f32 v177, v177
    v_add_f32 v178, 1.0, v42
    v_add_f32 v179, 1.0, v43
    v_cmp_lt_f32 vcc, 0, v42
    s_nop 1
    v_cndmask_b32 v176, v176, v178, vcc
    v_cmp_lt_f32 vcc, 0, v43
    s_nop 1
    v_cndmask_b32 v177, v177, v179, vcc
    v_cvt_pk_bf16_f32 v178, v176, v177
    v_lshlrev_b32 v176, 16, v178
    v_and_b32 v177, 0xffff0000, v178
    v_add_f32 v42, 0x358637bd, v176
    v_add_f32 v43, 0x358637bd, v177
    v_cvt_pk_bf16_f32 v178, v42, v43
    v_lshlrev_b32 v42, 16, v178
    v_and_b32 v43, 0xffff0000, v178
    v_cvt_pk_bf16_f32 v176, v44, v45
    v_lshlrev_b32 v44, 16, v176
    v_and_b32 v45, 0xffff0000, v176
    v_mul_f32 v176, 1069066811, v44
    v_mul_f32 v177, 1069066811, v45
    v_exp_f32 v176, v176
    v_exp_f32 v177, v177
    v_add_f32 v178, 1.0, v44
    v_add_f32 v179, 1.0, v45
    v_cmp_lt_f32 vcc, 0, v44
    s_nop 1
    v_cndmask_b32 v176, v176, v178, vcc
    v_cmp_lt_f32 vcc, 0, v45
    s_nop 1
    v_cndmask_b32 v177, v177, v179, vcc
    v_cvt_pk_bf16_f32 v178, v176, v177
    v_lshlrev_b32 v176, 16, v178
    v_and_b32 v177, 0xffff0000, v178
    v_add_f32 v44, 0x358637bd, v176
    v_add_f32 v45, 0x358637bd, v177
    v_cvt_pk_bf16_f32 v178, v44, v45
    v_lshlrev_b32 v44, 16, v178
    v_and_b32 v45, 0xffff0000, v178
    v_cvt_pk_bf16_f32 v176, v46, v47
    v_lshlrev_b32 v46, 16, v176
    v_and_b32 v47, 0xffff0000, v176
    v_mul_f32 v176, 1069066811, v46
    v_mul_f32 v177, 1069066811, v47
    v_exp_f32 v176, v176
    v_exp_f32 v177, v177
    v_add_f32 v178, 1.0, v46
    v_add_f32 v179, 1.0, v47
    v_cmp_lt_f32 vcc, 0, v46
    s_nop 1
    v_cndmask_b32 v176, v176, v178, vcc
    v_cmp_lt_f32 vcc, 0, v47
    s_nop 1
    v_cndmask_b32 v177, v177, v179, vcc
    v_cvt_pk_bf16_f32 v178, v176, v177
    v_lshlrev_b32 v176, 16, v178
    v_and_b32 v177, 0xffff0000, v178
    v_add_f32 v46, 0x358637bd, v176
    v_add_f32 v47, 0x358637bd, v177
    v_cvt_pk_bf16_f32 v178, v46, v47
    v_lshlrev_b32 v46, 16, v178
    v_and_b32 v47, 0xffff0000, v178
    v_cvt_pk_bf16_f32 v176, v48, v49
    v_lshlrev_b32 v48, 16, v176
    v_and_b32 v49, 0xffff0000, v176
    v_mul_f32 v176, 1069066811, v48
    v_mul_f32 v177, 1069066811, v49
    v_exp_f32 v176, v176
    v_exp_f32 v177, v177
    v_add_f32 v178, 1.0, v48
    v_add_f32 v179, 1.0, v49
    v_cmp_lt_f32 vcc, 0, v48
    s_nop 1
    v_cndmask_b32 v176, v176, v178, vcc
    v_cmp_lt_f32 vcc, 0, v49
    s_nop 1
    v_cndmask_b32 v177, v177, v179, vcc
    v_cvt_pk_bf16_f32 v178, v176, v177
    v_lshlrev_b32 v176, 16, v178
    v_and_b32 v177, 0xffff0000, v178
    v_add_f32 v48, 0x358637bd, v176
    v_add_f32 v49, 0x358637bd, v177
    v_cvt_pk_bf16_f32 v178, v48, v49
    v_lshlrev_b32 v48, 16, v178
    v_and_b32 v49, 0xffff0000, v178
    v_cvt_pk_bf16_f32 v176, v50, v51
    v_lshlrev_b32 v50, 16, v176
    v_and_b32 v51, 0xffff0000, v176
    v_mul_f32 v176, 1069066811, v50
    v_mul_f32 v177, 1069066811, v51
    v_exp_f32 v176, v176
    v_exp_f32 v177, v177
    v_add_f32 v178, 1.0, v50
    v_add_f32 v179, 1.0, v51
    v_cmp_lt_f32 vcc, 0, v50
    s_nop 1
    v_cndmask_b32 v176, v176, v178, vcc
    v_cmp_lt_f32 vcc, 0, v51
    s_nop 1
    v_cndmask_b32 v177, v177, v179, vcc
    v_cvt_pk_bf16_f32 v178, v176, v177
    v_lshlrev_b32 v176, 16, v178
    v_and_b32 v177, 0xffff0000, v178
    v_add_f32 v50, 0x358637bd, v176
    v_add_f32 v51, 0x358637bd, v177
    v_cvt_pk_bf16_f32 v178, v50, v51
    v_lshlrev_b32 v50, 16, v178
    v_and_b32 v51, 0xffff0000, v178
    v_cvt_pk_bf16_f32 v176, v52, v53
    v_lshlrev_b32 v52, 16, v176
    v_and_b32 v53, 0xffff0000, v176
    v_mul_f32 v176, 1069066811, v52
    v_mul_f32 v177, 1069066811, v53
    v_exp_f32 v176, v176
    v_exp_f32 v177, v177
    v_add_f32 v178, 1.0, v52
    v_add_f32 v179, 1.0, v53
    v_cmp_lt_f32 vcc, 0, v52
    s_nop 1
    v_cndmask_b32 v176, v176, v178, vcc
    v_cmp_lt_f32 vcc, 0, v53
    s_nop 1
    v_cndmask_b32 v177, v177, v179, vcc
    v_cvt_pk_bf16_f32 v178, v176, v177
    v_lshlrev_b32 v176, 16, v178
    v_and_b32 v177, 0xffff0000, v178
    v_add_f32 v52, 0x358637bd, v176
    v_add_f32 v53, 0x358637bd, v177
    v_cvt_pk_bf16_f32 v178, v52, v53
    v_lshlrev_b32 v52, 16, v178
    v_and_b32 v53, 0xffff0000, v178
    v_cvt_pk_bf16_f32 v176, v54, v55
    v_lshlrev_b32 v54, 16, v176
    v_and_b32 v55, 0xffff0000, v176
    v_mul_f32 v176, 1069066811, v54
    v_mul_f32 v177, 1069066811, v55
    v_exp_f32 v176, v176
    v_exp_f32 v177, v177
    v_add_f32 v178, 1.0, v54
    v_add_f32 v179, 1.0, v55
    v_cmp_lt_f32 vcc, 0, v54
    s_nop 1
    v_cndmask_b32 v176, v176, v178, vcc
    v_cmp_lt_f32 vcc, 0, v55
    s_nop 1
    v_cndmask_b32 v177, v177, v179, vcc
    v_cvt_pk_bf16_f32 v178, v176, v177
    v_lshlrev_b32 v176, 16, v178
    v_and_b32 v177, 0xffff0000, v178
    v_add_f32 v54, 0x358637bd, v176
    v_add_f32 v55, 0x358637bd, v177
    v_cvt_pk_bf16_f32 v178, v54, v55
    v_lshlrev_b32 v54, 16, v178
    v_and_b32 v55, 0xffff0000, v178
    v_cvt_pk_bf16_f32 v176, v56, v57
    v_lshlrev_b32 v56, 16, v176
    v_and_b32 v57, 0xffff0000, v176
    v_mul_f32 v176, 1069066811, v56
    v_mul_f32 v177, 1069066811, v57
    v_exp_f32 v176, v176
    v_exp_f32 v177, v177
    v_add_f32 v178, 1.0, v56
    v_add_f32 v179, 1.0, v57
    v_cmp_lt_f32 vcc, 0, v56
    s_nop 1
    v_cndmask_b32 v176, v176, v178, vcc
    v_cmp_lt_f32 vcc, 0, v57
    s_nop 1
    v_cndmask_b32 v177, v177, v179, vcc
    v_cvt_pk_bf16_f32 v178, v176, v177
    v_lshlrev_b32 v176, 16, v178
    v_and_b32 v177, 0xffff0000, v178
    v_add_f32 v56, 0x358637bd, v176
    v_add_f32 v57, 0x358637bd, v177
    v_cvt_pk_bf16_f32 v178, v56, v57
    v_lshlrev_b32 v56, 16, v178
    v_and_b32 v57, 0xffff0000, v178
    v_cvt_pk_bf16_f32 v176, v58, v59
    v_lshlrev_b32 v58, 16, v176
    v_and_b32 v59, 0xffff0000, v176
    v_mul_f32 v176, 1069066811, v58
    v_mul_f32 v177, 1069066811, v59
    v_exp_f32 v176, v176
    v_exp_f32 v177, v177
    v_add_f32 v178, 1.0, v58
    v_add_f32 v179, 1.0, v59
    v_cmp_lt_f32 vcc, 0, v58
    s_nop 1
    v_cndmask_b32 v176, v176, v178, vcc
    v_cmp_lt_f32 vcc, 0, v59
    s_nop 1
    v_cndmask_b32 v177, v177, v179, vcc
    v_cvt_pk_bf16_f32 v178, v176, v177
    v_lshlrev_b32 v176, 16, v178
    v_and_b32 v177, 0xffff0000, v178
    v_add_f32 v58, 0x358637bd, v176
    v_add_f32 v59, 0x358637bd, v177
    v_cvt_pk_bf16_f32 v178, v58, v59
    v_lshlrev_b32 v58, 16, v178
    v_and_b32 v59, 0xffff0000, v178
    v_cvt_pk_bf16_f32 v176, v60, v61
    v_lshlrev_b32 v60, 16, v176
    v_and_b32 v61, 0xffff0000, v176
    v_mul_f32 v176, 1069066811, v60
    v_mul_f32 v177, 1069066811, v61
    v_exp_f32 v176, v176
    v_exp_f32 v177, v177
    v_add_f32 v178, 1.0, v60
    v_add_f32 v179, 1.0, v61
    v_cmp_lt_f32 vcc, 0, v60
    s_nop 1
    v_cndmask_b32 v176, v176, v178, vcc
    v_cmp_lt_f32 vcc, 0, v61
    s_nop 1
    v_cndmask_b32 v177, v177, v179, vcc
    v_cvt_pk_bf16_f32 v178, v176, v177
    v_lshlrev_b32 v176, 16, v178
    v_and_b32 v177, 0xffff0000, v178
    v_add_f32 v60, 0x358637bd, v176
    v_add_f32 v61, 0x358637bd, v177
    v_cvt_pk_bf16_f32 v178, v60, v61
    v_lshlrev_b32 v60, 16, v178
    v_and_b32 v61, 0xffff0000, v178
    v_cvt_pk_bf16_f32 v176, v62, v63
    v_lshlrev_b32 v62, 16, v176
    v_and_b32 v63, 0xffff0000, v176
    v_mul_f32 v176, 1069066811, v62
    v_mul_f32 v177, 1069066811, v63
    v_exp_f32 v176, v176
    v_exp_f32 v177, v177
    v_add_f32 v178, 1.0, v62
    v_add_f32 v179, 1.0, v63
    v_cmp_lt_f32 vcc, 0, v62
    s_nop 1
    v_cndmask_b32 v176, v176, v178, vcc
    v_cmp_lt_f32 vcc, 0, v63
    s_nop 1
    v_cndmask_b32 v177, v177, v179, vcc
    v_cvt_pk_bf16_f32 v178, v176, v177
    v_lshlrev_b32 v176, 16, v178
    v_and_b32 v177, 0xffff0000, v178
    v_add_f32 v62, 0x358637bd, v176
    v_add_f32 v63, 0x358637bd, v177
    v_cvt_pk_bf16_f32 v178, v62, v63
    v_lshlrev_b32 v62, 16, v178
    v_and_b32 v63, 0xffff0000, v178
    v_cvt_pk_bf16_f32 v176, v80, v81
    v_lshlrev_b32 v80, 16, v176
    v_and_b32 v81, 0xffff0000, v176
    v_mul_f32 v176, 1069066811, v80
    v_mul_f32 v177, 1069066811, v81
    v_exp_f32 v176, v176
    v_exp_f32 v177, v177
    v_add_f32 v178, 1.0, v80
    v_add_f32 v179, 1.0, v81
    v_cmp_lt_f32 vcc, 0, v80
    s_nop 1
    v_cndmask_b32 v176, v176, v178, vcc
    v_cmp_lt_f32 vcc, 0, v81
    s_nop 1
    v_cndmask_b32 v177, v177, v179, vcc
    v_cvt_pk_bf16_f32 v178, v176, v177
    v_lshlrev_b32 v176, 16, v178
    v_and_b32 v177, 0xffff0000, v178
    v_add_f32 v80, 0x358637bd, v176
    v_add_f32 v81, 0x358637bd, v177
    v_cvt_pk_bf16_f32 v178, v80, v81
    v_lshlrev_b32 v80, 16, v178
    v_and_b32 v81, 0xffff0000, v178
    v_cvt_pk_bf16_f32 v176, v82, v83
    v_lshlrev_b32 v82, 16, v176
    v_and_b32 v83, 0xffff0000, v176
    v_mul_f32 v176, 1069066811, v82
    v_mul_f32 v177, 1069066811, v83
    v_exp_f32 v176, v176
    v_exp_f32 v177, v177
    v_add_f32 v178, 1.0, v82
    v_add_f32 v179, 1.0, v83
    v_cmp_lt_f32 vcc, 0, v82
    s_nop 1
    v_cndmask_b32 v176, v176, v178, vcc
    v_cmp_lt_f32 vcc, 0, v83
    s_nop 1
    v_cndmask_b32 v177, v177, v179, vcc
    v_cvt_pk_bf16_f32 v178, v176, v177
    v_lshlrev_b32 v176, 16, v178
    v_and_b32 v177, 0xffff0000, v178
    v_add_f32 v82, 0x358637bd, v176
    v_add_f32 v83, 0x358637bd, v177
    v_cvt_pk_bf16_f32 v178, v82, v83
    v_lshlrev_b32 v82, 16, v178
    v_and_b32 v83, 0xffff0000, v178
    v_cvt_pk_bf16_f32 v176, v84, v85
    v_lshlrev_b32 v84, 16, v176
    v_and_b32 v85, 0xffff0000, v176
    v_mul_f32 v176, 1069066811, v84
    v_mul_f32 v177, 1069066811, v85
    v_exp_f32 v176, v176
    v_exp_f32 v177, v177
    v_add_f32 v178, 1.0, v84
    v_add_f32 v179, 1.0, v85
    v_cmp_lt_f32 vcc, 0, v84
    s_nop 1
    v_cndmask_b32 v176, v176, v178, vcc
    v_cmp_lt_f32 vcc, 0, v85
    s_nop 1
    v_cndmask_b32 v177, v177, v179, vcc
    v_cvt_pk_bf16_f32 v178, v176, v177
    v_lshlrev_b32 v176, 16, v178
    v_and_b32 v177, 0xffff0000, v178
    v_add_f32 v84, 0x358637bd, v176
    v_add_f32 v85, 0x358637bd, v177
    v_cvt_pk_bf16_f32 v178, v84, v85
    v_lshlrev_b32 v84, 16, v178
    v_and_b32 v85, 0xffff0000, v178
    v_cvt_pk_bf16_f32 v176, v86, v87
    v_lshlrev_b32 v86, 16, v176
    v_and_b32 v87, 0xffff0000, v176
    v_mul_f32 v176, 1069066811, v86
    v_mul_f32 v177, 1069066811, v87
    v_exp_f32 v176, v176
    v_exp_f32 v177, v177
    v_add_f32 v178, 1.0, v86
    v_add_f32 v179, 1.0, v87
    v_cmp_lt_f32 vcc, 0, v86
    s_nop 1
    v_cndmask_b32 v176, v176, v178, vcc
    v_cmp_lt_f32 vcc, 0, v87
    s_nop 1
    v_cndmask_b32 v177, v177, v179, vcc
    v_cvt_pk_bf16_f32 v178, v176, v177
    v_lshlrev_b32 v176, 16, v178
    v_and_b32 v177, 0xffff0000, v178
    v_add_f32 v86, 0x358637bd, v176
    v_add_f32 v87, 0x358637bd, v177
    v_cvt_pk_bf16_f32 v178, v86, v87
    v_lshlrev_b32 v86, 16, v178
    v_and_b32 v87, 0xffff0000, v178
    v_cvt_pk_bf16_f32 v176, v88, v89
    v_lshlrev_b32 v88, 16, v176
    v_and_b32 v89, 0xffff0000, v176
    v_mul_f32 v176, 1069066811, v88
    v_mul_f32 v177, 1069066811, v89
    v_exp_f32 v176, v176
    v_exp_f32 v177, v177
    v_add_f32 v178, 1.0, v88
    v_add_f32 v179, 1.0, v89
    v_cmp_lt_f32 vcc, 0, v88
    s_nop 1
    v_cndmask_b32 v176, v176, v178, vcc
    v_cmp_lt_f32 vcc, 0, v89
    s_nop 1
    v_cndmask_b32 v177, v177, v179, vcc
    v_cvt_pk_bf16_f32 v178, v176, v177
    v_lshlrev_b32 v176, 16, v178
    v_and_b32 v177, 0xffff0000, v178
    v_add_f32 v88, 0x358637bd, v176
    v_add_f32 v89, 0x358637bd, v177
    v_cvt_pk_bf16_f32 v178, v88, v89
    v_lshlrev_b32 v88, 16, v178
    v_and_b32 v89, 0xffff0000, v178
    v_cvt_pk_bf16_f32 v176, v90, v91
    v_lshlrev_b32 v90, 16, v176
    v_and_b32 v91, 0xffff0000, v176
    v_mul_f32 v176, 1069066811, v90
    v_mul_f32 v177, 1069066811, v91
    v_exp_f32 v176, v176
    v_exp_f32 v177, v177
    v_add_f32 v178, 1.0, v90
    v_add_f32 v179, 1.0, v91
    v_cmp_lt_f32 vcc, 0, v90
    s_nop 1
    v_cndmask_b32 v176, v176, v178, vcc
    v_cmp_lt_f32 vcc, 0, v91
    s_nop 1
    v_cndmask_b32 v177, v177, v179, vcc
    v_cvt_pk_bf16_f32 v178, v176, v177
    v_lshlrev_b32 v176, 16, v178
    v_and_b32 v177, 0xffff0000, v178
    v_add_f32 v90, 0x358637bd, v176
    v_add_f32 v91, 0x358637bd, v177
    v_cvt_pk_bf16_f32 v178, v90, v91
    v_lshlrev_b32 v90, 16, v178
    v_and_b32 v91, 0xffff0000, v178
    v_cvt_pk_bf16_f32 v176, v92, v93
    v_lshlrev_b32 v92, 16, v176
    v_and_b32 v93, 0xffff0000, v176
    v_mul_f32 v176, 1069066811, v92
    v_mul_f32 v177, 1069066811, v93
    v_exp_f32 v176, v176
    v_exp_f32 v177, v177
    v_add_f32 v178, 1.0, v92
    v_add_f32 v179, 1.0, v93
    v_cmp_lt_f32 vcc, 0, v92
    s_nop 1
    v_cndmask_b32 v176, v176, v178, vcc
    v_cmp_lt_f32 vcc, 0, v93
    s_nop 1
    v_cndmask_b32 v177, v177, v179, vcc
    v_cvt_pk_bf16_f32 v178, v176, v177
    v_lshlrev_b32 v176, 16, v178
    v_and_b32 v177, 0xffff0000, v178
    v_add_f32 v92, 0x358637bd, v176
    v_add_f32 v93, 0x358637bd, v177
    v_cvt_pk_bf16_f32 v178, v92, v93
    v_lshlrev_b32 v92, 16, v178
    v_and_b32 v93, 0xffff0000, v178
    v_cvt_pk_bf16_f32 v176, v94, v95
    v_lshlrev_b32 v94, 16, v176
    v_and_b32 v95, 0xffff0000, v176
    v_mul_f32 v176, 1069066811, v94
    v_mul_f32 v177, 1069066811, v95
    v_exp_f32 v176, v176
    v_exp_f32 v177, v177
    v_add_f32 v178, 1.0, v94
    v_add_f32 v179, 1.0, v95
    v_cmp_lt_f32 vcc, 0, v94
    s_nop 1
    v_cndmask_b32 v176, v176, v178, vcc
    v_cmp_lt_f32 vcc, 0, v95
    s_nop 1
    v_cndmask_b32 v177, v177, v179, vcc
    v_cvt_pk_bf16_f32 v178, v176, v177
    v_lshlrev_b32 v176, 16, v178
    v_and_b32 v177, 0xffff0000, v178
    v_add_f32 v94, 0x358637bd, v176
    v_add_f32 v95, 0x358637bd, v177
    v_cvt_pk_bf16_f32 v178, v94, v95
    v_lshlrev_b32 v94, 16, v178
    v_and_b32 v95, 0xffff0000, v178
    v_cvt_pk_bf16_f32 v176, v96, v97
    v_lshlrev_b32 v96, 16, v176
    v_and_b32 v97, 0xffff0000, v176
    v_mul_f32 v176, 1069066811, v96
    v_mul_f32 v177, 1069066811, v97
    v_exp_f32 v176, v176
    v_exp_f32 v177, v177
    v_add_f32 v178, 1.0, v96
    v_add_f32 v179, 1.0, v97
    v_cmp_lt_f32 vcc, 0, v96
    s_nop 1
    v_cndmask_b32 v176, v176, v178, vcc
    v_cmp_lt_f32 vcc, 0, v97
    s_nop 1
    v_cndmask_b32 v177, v177, v179, vcc
    v_cvt_pk_bf16_f32 v178, v176, v177
    v_lshlrev_b32 v176, 16, v178
    v_and_b32 v177, 0xffff0000, v178
    v_add_f32 v96, 0x358637bd, v176
    v_add_f32 v97, 0x358637bd, v177
    v_cvt_pk_bf16_f32 v178, v96, v97
    v_lshlrev_b32 v96, 16, v178
    v_and_b32 v97, 0xffff0000, v178
    v_cvt_pk_bf16_f32 v176, v98, v99
    v_lshlrev_b32 v98, 16, v176
    v_and_b32 v99, 0xffff0000, v176
    v_mul_f32 v176, 1069066811, v98
    v_mul_f32 v177, 1069066811, v99
    v_exp_f32 v176, v176
    v_exp_f32 v177, v177
    v_add_f32 v178, 1.0, v98
    v_add_f32 v179, 1.0, v99
    v_cmp_lt_f32 vcc, 0, v98
    s_nop 1
    v_cndmask_b32 v176, v176, v178, vcc
    v_cmp_lt_f32 vcc, 0, v99
    s_nop 1
    v_cndmask_b32 v177, v177, v179, vcc
    v_cvt_pk_bf16_f32 v178, v176, v177
    v_lshlrev_b32 v176, 16, v178
    v_and_b32 v177, 0xffff0000, v178
    v_add_f32 v98, 0x358637bd, v176
    v_add_f32 v99, 0x358637bd, v177
    v_cvt_pk_bf16_f32 v178, v98, v99
    v_lshlrev_b32 v98, 16, v178
    v_and_b32 v99, 0xffff0000, v178
    v_cvt_pk_bf16_f32 v176, v100, v101
    v_lshlrev_b32 v100, 16, v176
    v_and_b32 v101, 0xffff0000, v176
    v_mul_f32 v176, 1069066811, v100
    v_mul_f32 v177, 1069066811, v101
    v_exp_f32 v176, v176
    v_exp_f32 v177, v177
    v_add_f32 v178, 1.0, v100
    v_add_f32 v179, 1.0, v101
    v_cmp_lt_f32 vcc, 0, v100
    s_nop 1
    v_cndmask_b32 v176, v176, v178, vcc
    v_cmp_lt_f32 vcc, 0, v101
    s_nop 1
    v_cndmask_b32 v177, v177, v179, vcc
    v_cvt_pk_bf16_f32 v178, v176, v177
    v_lshlrev_b32 v176, 16, v178
    v_and_b32 v177, 0xffff0000, v178
    v_add_f32 v100, 0x358637bd, v176
    v_add_f32 v101, 0x358637bd, v177
    v_cvt_pk_bf16_f32 v178, v100, v101
    v_lshlrev_b32 v100, 16, v178
    v_and_b32 v101, 0xffff0000, v178
    v_cvt_pk_bf16_f32 v176, v102, v103
    v_lshlrev_b32 v102, 16, v176
    v_and_b32 v103, 0xffff0000, v176
    v_mul_f32 v176, 1069066811, v102
    v_mul_f32 v177, 1069066811, v103
    v_exp_f32 v176, v176
    v_exp_f32 v177, v177
    v_add_f32 v178, 1.0, v102
    v_add_f32 v179, 1.0, v103
    v_cmp_lt_f32 vcc, 0, v102
    s_nop 1
    v_cndmask_b32 v176, v176, v178, vcc
    v_cmp_lt_f32 vcc, 0, v103
    s_nop 1
    v_cndmask_b32 v177, v177, v179, vcc
    v_cvt_pk_bf16_f32 v178, v176, v177
    v_lshlrev_b32 v176, 16, v178
    v_and_b32 v177, 0xffff0000, v178
    v_add_f32 v102, 0x358637bd, v176
    v_add_f32 v103, 0x358637bd, v177
    v_cvt_pk_bf16_f32 v178, v102, v103
    v_lshlrev_b32 v102, 16, v178
    v_and_b32 v103, 0xffff0000, v178
    v_cvt_pk_bf16_f32 v176, v104, v105
    v_lshlrev_b32 v104, 16, v176
    v_and_b32 v105, 0xffff0000, v176
    v_mul_f32 v176, 1069066811, v104
    v_mul_f32 v177, 1069066811, v105
    v_exp_f32 v176, v176
    v_exp_f32 v177, v177
    v_add_f32 v178, 1.0, v104
    v_add_f32 v179, 1.0, v105
    v_cmp_lt_f32 vcc, 0, v104
    s_nop 1
    v_cndmask_b32 v176, v176, v178, vcc
    v_cmp_lt_f32 vcc, 0, v105
    s_nop 1
    v_cndmask_b32 v177, v177, v179, vcc
    v_cvt_pk_bf16_f32 v178, v176, v177
    v_lshlrev_b32 v176, 16, v178
    v_and_b32 v177, 0xffff0000, v178
    v_add_f32 v104, 0x358637bd, v176
    v_add_f32 v105, 0x358637bd, v177
    v_cvt_pk_bf16_f32 v178, v104, v105
    v_lshlrev_b32 v104, 16, v178
    v_and_b32 v105, 0xffff0000, v178
    v_cvt_pk_bf16_f32 v176, v106, v107
    v_lshlrev_b32 v106, 16, v176
    v_and_b32 v107, 0xffff0000, v176
    v_mul_f32 v176, 1069066811, v106
    v_mul_f32 v177, 1069066811, v107
    v_exp_f32 v176, v176
    v_exp_f32 v177, v177
    v_add_f32 v178, 1.0, v106
    v_add_f32 v179, 1.0, v107
    v_cmp_lt_f32 vcc, 0, v106
    s_nop 1
    v_cndmask_b32 v176, v176, v178, vcc
    v_cmp_lt_f32 vcc, 0, v107
    s_nop 1
    v_cndmask_b32 v177, v177, v179, vcc
    v_cvt_pk_bf16_f32 v178, v176, v177
    v_lshlrev_b32 v176, 16, v178
    v_and_b32 v177, 0xffff0000, v178
    v_add_f32 v106, 0x358637bd, v176
    v_add_f32 v107, 0x358637bd, v177
    v_cvt_pk_bf16_f32 v178, v106, v107
    v_lshlrev_b32 v106, 16, v178
    v_and_b32 v107, 0xffff0000, v178
    v_cvt_pk_bf16_f32 v176, v108, v109
    v_lshlrev_b32 v108, 16, v176
    v_and_b32 v109, 0xffff0000, v176
    v_mul_f32 v176, 1069066811, v108
    v_mul_f32 v177, 1069066811, v109
    v_exp_f32 v176, v176
    v_exp_f32 v177, v177
    v_add_f32 v178, 1.0, v108
    v_add_f32 v179, 1.0, v109
    v_cmp_lt_f32 vcc, 0, v108
    s_nop 1
    v_cndmask_b32 v176, v176, v178, vcc
    v_cmp_lt_f32 vcc, 0, v109
    s_nop 1
    v_cndmask_b32 v177, v177, v179, vcc
    v_cvt_pk_bf16_f32 v178, v176, v177
    v_lshlrev_b32 v176, 16, v178
    v_and_b32 v177, 0xffff0000, v178
    v_add_f32 v108, 0x358637bd, v176
    v_add_f32 v109, 0x358637bd, v177
    v_cvt_pk_bf16_f32 v178, v108, v109
    v_lshlrev_b32 v108, 16, v178
    v_and_b32 v109, 0xffff0000, v178
    v_cvt_pk_bf16_f32 v176, v110, v111
    v_lshlrev_b32 v110, 16, v176
    v_and_b32 v111, 0xffff0000, v176
    v_mul_f32 v176, 1069066811, v110
    v_mul_f32 v177, 1069066811, v111
    v_exp_f32 v176, v176
    v_exp_f32 v177, v177
    v_add_f32 v178, 1.0, v110
    v_add_f32 v179, 1.0, v111
    v_cmp_lt_f32 vcc, 0, v110
    s_nop 1
    v_cndmask_b32 v176, v176, v178, vcc
    v_cmp_lt_f32 vcc, 0, v111
    s_nop 1
    v_cndmask_b32 v177, v177, v179, vcc
    v_cvt_pk_bf16_f32 v178, v176, v177
    v_lshlrev_b32 v176, 16, v178
    v_and_b32 v177, 0xffff0000, v178
    v_add_f32 v110, 0x358637bd, v176
    v_add_f32 v111, 0x358637bd, v177
    v_cvt_pk_bf16_f32 v178, v110, v111
    v_lshlrev_b32 v110, 16, v178
    v_and_b32 v111, 0xffff0000, v178
    v_and_b32 v176, 31, v2
    v_lshlrev_b32 v176, 11, v176
    v_lshrrev_b32 v177, 5, v2
    v_lshlrev_b32 v177, 4, v177
    v_add_u32 v176, v176, v177
    s_lshl_b32 s27, s20, 18
    s_lshl_b32 s28, s22, 17
    s_add_u32 s27, s27, s28
    s_lshl_b32 s28, s21, 7
    s_add_u32 s27, s27, s28
    s_lshl_b32 s28, s23, 6
    s_add_u32 s27, s27, s28
    s_add_u32 s27, s27, 4194304
    v_cvt_pk_bf16_f32 v180, v32, v33
    v_cvt_pk_bf16_f32 v181, v34, v35
    v_cvt_pk_bf16_f32 v182, v36, v37
    v_cvt_pk_bf16_f32 v183, v38, v39
    v_cvt_pk_bf16_f32 v184, v40, v41
    v_cvt_pk_bf16_f32 v185, v42, v43
    v_cvt_pk_bf16_f32 v186, v44, v45
    v_cvt_pk_bf16_f32 v187, v46, v47
    s_nop 1
    v_permlane32_swap_b32 v180, v182
    v_permlane32_swap_b32 v181, v183
    v_permlane32_swap_b32 v184, v186
    v_permlane32_swap_b32 v185, v187
    s_add_u32 s28, s27, 0
    buffer_store_dwordx4 v[180:183], v176, s[16:19], s28 offen
    buffer_store_dwordx4 v[184:187], v176, s[16:19], s28 offen offset:32
    s_nop 1
    v_cvt_pk_bf16_f32 v180, v80, v81
    v_cvt_pk_bf16_f32 v181, v82, v83
    v_cvt_pk_bf16_f32 v182, v84, v85
    v_cvt_pk_bf16_f32 v183, v86, v87
    v_cvt_pk_bf16_f32 v184, v88, v89
    v_cvt_pk_bf16_f32 v185, v90, v91
    v_cvt_pk_bf16_f32 v186, v92, v93
    v_cvt_pk_bf16_f32 v187, v94, v95
    s_nop 1
    v_permlane32_swap_b32 v180, v182
    v_permlane32_swap_b32 v181, v183
    v_permlane32_swap_b32 v184, v186
    v_permlane32_swap_b32 v185, v187
    s_add_u32 s28, s27, 65536
    buffer_store_dwordx4 v[180:183], v176, s[16:19], s28 offen
    buffer_store_dwordx4 v[184:187], v176, s[16:19], s28 offen offset:32
    s_nop 1
    v_mov_b32 v128, 0
    v_mov_b32 v129, 0
    v_mov_b32 v130, 0
    v_mov_b32 v131, 0
    v_mov_b32 v132, 0
    v_mov_b32 v133, 0
    v_mov_b32 v134, 0
    v_mov_b32 v135, 0
    v_mov_b32 v136, 0
    v_mov_b32 v137, 0
    v_mov_b32 v138, 0
    v_mov_b32 v139, 0
    v_mov_b32 v140, 0
    v_mov_b32 v141, 0
    v_mov_b32 v142, 0
    v_mov_b32 v143, 0
    v_mov_b32 v144, 0
    v_mov_b32 v145, 0
    v_mov_b32 v146, 0
    v_mov_b32 v147, 0
    v_mov_b32 v148, 0
    v_mov_b32 v149, 0
    v_mov_b32 v150, 0
    v_mov_b32 v151, 0
    v_mov_b32 v152, 0
    v_mov_b32 v153, 0
    v_mov_b32 v154, 0
    v_mov_b32 v155, 0
    v_mov_b32 v156, 0
    v_mov_b32 v157, 0
    v_mov_b32 v158, 0
    v_mov_b32 v159, 0
    v_mov_b32 v188, 0x3f803f80
    v_mov_b32 v189, 0x3f803f80
    v_mov_b32 v190, 0x3f803f80
    v_mov_b32 v191, 0x3f803f80
    v_cvt_pk_bf16_f32 v160, v48, v49
    v_cvt_pk_bf16_f32 v168, v64, v65
    v_cvt_pk_bf16_f32 v161, v50, v51
    v_cvt_pk_bf16_f32 v169, v66, v67
    v_cvt_pk_bf16_f32 v162, v52, v53
    v_cvt_pk_bf16_f32 v170, v68, v69
    v_cvt_pk_bf16_f32 v163, v54, v55
    v_cvt_pk_bf16_f32 v171, v70, v71
    v_cvt_pk_bf16_f32 v164, v56, v57
    v_cvt_pk_bf16_f32 v172, v72, v73
    v_cvt_pk_bf16_f32 v165, v58, v59
    v_cvt_pk_bf16_f32 v173, v74, v75
    v_cvt_pk_bf16_f32 v166, v60, v61
    v_cvt_pk_bf16_f32 v174, v76, v77
    v_cvt_pk_bf16_f32 v167, v62, v63
    v_cvt_pk_bf16_f32 v175, v78, v79
    s_nop 1
    v_mfma_f32_32x32x16_bf16 v[128:143], v[168:171], v[160:163], v[128:143]
    v_mfma_f32_32x32x16_bf16 v[144:159], v[188:191], v[160:163], v[144:159]
    v_mfma_f32_32x32x16_bf16 v[128:143], v[172:175], v[164:167], v[128:143]
    v_mfma_f32_32x32x16_bf16 v[144:159], v[188:191], v[164:167], v[144:159]
    s_nop 7
    s_nop 7
    v_cvt_pk_bf16_f32 v160, v96, v97
    v_cvt_pk_bf16_f32 v168, v112, v113
    v_cvt_pk_bf16_f32 v161, v98, v99
    v_cvt_pk_bf16_f32 v169, v114, v115
    v_cvt_pk_bf16_f32 v162, v100, v101
    v_cvt_pk_bf16_f32 v170, v116, v117
    v_cvt_pk_bf16_f32 v163, v102, v103
    v_cvt_pk_bf16_f32 v171, v118, v119
    v_cvt_pk_bf16_f32 v164, v104, v105
    v_cvt_pk_bf16_f32 v172, v120, v121
    v_cvt_pk_bf16_f32 v165, v106, v107
    v_cvt_pk_bf16_f32 v173, v122, v123
    v_cvt_pk_bf16_f32 v166, v108, v109
    v_cvt_pk_bf16_f32 v174, v124, v125
    v_cvt_pk_bf16_f32 v167, v110, v111
    v_cvt_pk_bf16_f32 v175, v126, v127
    s_nop 1
    v_mfma_f32_32x32x16_bf16 v[128:143], v[168:171], v[160:163], v[128:143]
    v_mfma_f32_32x32x16_bf16 v[144:159], v[188:191], v[160:163], v[144:159]
    v_mfma_f32_32x32x16_bf16 v[128:143], v[172:175], v[164:167], v[128:143]
    v_mfma_f32_32x32x16_bf16 v[144:159], v[188:191], v[164:167], v[144:159]
    s_nop 7
    s_nop 7
    s_barrier
    s_nop 15
    v_lshlrev_b32 v176, 2, v2
    s_lshl_b32 s28, s23, 13
    v_add_u32 v176, s28, v176
    s_cmp_eq_u32 s22, 0
    s_cbranch_scc1 L_k1_wm0_k1a_kernel
    ds_write_b32 v176, v128 offset:0
    ds_write_b32 v176, v129 offset:256
    ds_write_b32 v176, v130 offset:512
    ds_write_b32 v176, v131 offset:768
    ds_write_b32 v176, v132 offset:1024
    ds_write_b32 v176, v133 offset:1280
    ds_write_b32 v176, v134 offset:1536
    ds_write_b32 v176, v135 offset:1792
    ds_write_b32 v176, v136 offset:2048
    ds_write_b32 v176, v137 offset:2304
    ds_write_b32 v176, v138 offset:2560
    ds_write_b32 v176, v139 offset:2816
    ds_write_b32 v176, v140 offset:3072
    ds_write_b32 v176, v141 offset:3328
    ds_write_b32 v176, v142 offset:3584
    ds_write_b32 v176, v143 offset:3840
    ds_write_b32 v176, v144 offset:4096
    s_waitcnt lgkmcnt(0)
    s_barrier
    s_endpgm
L_k1_wm0_k1a_kernel:
    s_barrier
    ds_read_b32 v160, v176 offset:0
    ds_read_b32 v161, v176 offset:256
    ds_read_b32 v162, v176 offset:512
    ds_read_b32 v163, v176 offset:768
    ds_read_b32 v164, v176 offset:1024
    ds_read_b32 v165, v176 offset:1280
    ds_read_b32 v166, v176 offset:1536
    ds_read_b32 v167, v176 offset:1792
    ds_read_b32 v168, v176 offset:2048
    ds_read_b32 v169, v176 offset:2304
    ds_read_b32 v170, v176 offset:2560
    ds_read_b32 v171, v176 offset:2816
    ds_read_b32 v172, v176 offset:3072
    ds_read_b32 v173, v176 offset:3328
    ds_read_b32 v174, v176 offset:3584
    ds_read_b32 v175, v176 offset:3840
    ds_read_b32 v177, v176 offset:4096
    s_waitcnt lgkmcnt(0)
    v_add_f32 v128, v128, v160
    v_add_f32 v129, v129, v161
    v_add_f32 v130, v130, v162
    v_add_f32 v131, v131, v163
    v_add_f32 v132, v132, v164
    v_add_f32 v133, v133, v165
    v_add_f32 v134, v134, v166
    v_add_f32 v135, v135, v167
    v_add_f32 v136, v136, v168
    v_add_f32 v137, v137, v169
    v_add_f32 v138, v138, v170
    v_add_f32 v139, v139, v171
    v_add_f32 v140, v140, v172
    v_add_f32 v141, v141, v173
    v_add_f32 v142, v142, v174
    v_add_f32 v143, v143, v175
    v_add_f32 v144, v144, v177
    s_lshl_b32 s27, s21, 1
    s_add_u32 s27, s27, s23
    s_lshl_b32 s27, s27, 4
    s_add_u32 s27, s27, s20
    s_mul_i32 s27, s27, 4224
    s_add_u32 s27, s27, 20971520
    v_and_b32 v176, 31, v2
    v_lshlrev_b32 v176, 2, v176
    v_lshrrev_b32 v178, 5, v2
    v_lshlrev_b32 v178, 9, v178
    v_add_u32 v178, v176, v178
    buffer_store_dword v128, v178, s[16:19], s27 offen offset:0
    buffer_store_dword v129, v178, s[16:19], s27 offen offset:128
    buffer_store_dword v130, v178, s[16:19], s27 offen offset:256
    buffer_store_dword v131, v178, s[16:19], s27 offen offset:384
    buffer_store_dword v132, v178, s[16:19], s27 offen offset:1024
    buffer_store_dword v133, v178, s[16:19], s27 offen offset:1152
    buffer_store_dword v134, v178, s[16:19], s27 offen offset:1280
    buffer_store_dword v135, v178, s[16:19], s27 offen offset:1408
    buffer_store_dword v136, v178, s[16:19], s27 offen offset:2048
    buffer_store_dword v137, v178, s[16:19], s27 offen offset:2176
    buffer_store_dword v138, v178, s[16:19], s27 offen offset:2304
    buffer_store_dword v139, v178, s[16:19], s27 offen offset:2432
    buffer_store_dword v140, v178, s[16:19], s27 offen offset:3072
    buffer_store_dword v141, v178, s[16:19], s27 offen offset:3200
    buffer_store_dword v142, v178, s[16:19], s27 offen offset:3328
    buffer_store_dword v143, v178, s[16:19], s27 offen offset:3456
    s_add_u32 s28, s27, 4096
    buffer_store_dword v144, v176, s[16:19], s28 offen
    s_endpgm
L_end_k1a_kernel:
    s_endpgm
.text
.globl kmida_kernel
.p2align 8
.type kmida_kernel,@function
kmida_kernel:
    s_cmp_ge_u32 s2, 256
    s_cbranch_scc1 L_end_kmida_kernel
    s_load_dwordx2 s[4:5], s[0:1], 80
    s_load_dwordx2 s[6:7], s[0:1], 32
    v_lshrrev_b32 v1, 6, v0
    v_and_b32 v2, 63, v0
    s_nop 0
    v_readfirstlane_b32 s3, v1
    s_and_b32 s20, s2, 15
    s_lshr_b32 s21, s2, 4
    s_waitcnt lgkmcnt(0)
    s_mov_b32 s16, s4
    s_mov_b32 s17, s5
    s_mov_b32 s18, 29360128
    s_mov_b32 s19, 0x00020000
    s_mov_b32 s8, s6
    s_mov_b32 s9, s7
    s_mov_b32 s10, 2048
    s_mov_b32 s11, 0x00020000
    s_cmp_ge_u32 s2, 24
    s_cbranch_scc1 L_nz_kmida_kernel
    v_lshlrev_b32 v4, 2, v0
    v_mov_b32 v5, 0
    s_lshl_b32 s22, s2, 10
    s_add_u32 s22, s22, 24117248
    buffer_store_dword v5, v4, s[16:19], s22 offen
L_nz_kmida_kernel:
    s_cmp_lg_u32 s2, 255
    s_cbranch_scc1 L_nw_kmida_kernel
    s_cmp_lg_u32 s3, 0
    s_cbranch_scc1 L_nw_kmida_kernel
    v_lshlrev_b32 v4, 4, v2
    buffer_load_dwordx4 v[8:11], v4, s[8:11], 0 offen
    buffer_load_dwordx4 v[12:15], v4, s[8:11], 0 offen offset:1024
    s_waitcnt vmcnt(0)
    v_mov_b32 v5, 0
    v_lshlrev_b32 v6, 16, v8
    v_and_b32 v7, 0xffff0000, v8
    v_add_f32 v5, v5, v6
    v_add_f32 v5, v5, v7
    v_lshlrev_b32 v6, 16, v9
    v_and_b32 v7, 0xffff0000, v9
    v_add_f32 v5, v5, v6
    v_add_f32 v5, v5, v7
    v_lshlrev_b32 v6, 16, v10
    v_and_b32 v7, 0xffff0000, v10
    v_add_f32 v5, v5, v6
    v_add_f32 v5, v5, v7
    v_lshlrev_b32 v6, 16, v11
    v_and_b32 v7, 0xffff0000, v11
    v_add_f32 v5, v5, v6
    v_add_f32 v5, v5, v7
    v_lshlrev_b32 v6, 16, v12
    v_and_b32 v7, 0xffff0000, v12
    v_add_f32 v5, v5, v6
    v_add_f32 v5, v5, v7
    v_lshlrev_b32 v6, 16, v13
    v_and_b32 v7, 0xffff0000, v13
    v_add_f32 v5, v5, v6
    v_add_f32 v5, v5, v7
    v_lshlrev_b32 v6, 16, v14
    v_and_b32 v7, 0xffff0000, v14
    v_add_f32 v5, v5, v6
    v_add_f32 v5, v5, v7
    v_lshlrev_b32 v6, 16, v15
    v_and_b32 v7, 0xffff0000, v15
    v_add_f32 v5, v5, v6
    v_add_f32 v5, v5, v7
    s_nop 1
    v_add_f32_dpp v5, v5, v5 quad_perm:[1,0,3,2] row_mask:0xf bank_mask:0xf
    s_nop 1
    v_add_f32_dpp v5, v5, v5 quad_perm:[2,3,0,1] row_mask:0xf bank_mask:0xf
    s_nop 1
    v_add_f32_dpp v5, v5, v5 row_half_mirror row_mask:0xf bank_mask:0xf
    s_nop 1
    v_add_f32_dpp v5, v5, v5 row_mirror row_mask:0xf bank_mask:0xf
    s_nop 1
    v_readlane_b32 s60, v5, 0
    v_readlane_b32 s61, v5, 16
    v_readlane_b32 s62, v5, 32
    v_readlane_b32 s63, v5, 48
    s_nop 1
    v_mov_b32 v5, s60
    v_add_f32 v5, s61, v5
    v_add_f32 v5, s62, v5
    v_add_f32 v5, s63, v5
    v_mov_b32 v4, 0
    s_mov_b32 s22, 24182784
    buffer_store_dword v5, v4, s[16:19], s22 offen
L_nw_kmida_kernel:
    v_lshlrev_b32 v4, 4, v0
    v_and_b32 v5, 31, v0
    v_lshlrev_b32 v5, 2, v5
    s_lshl_b32 s22, s20, 1
    s_add_u32 s22, s22, 0
    s_mul_i32 s22, s22, 67584
    s_add_u32 s22, s22, 20971520
    s_add_u32 s23, s22, 4096
    buffer_load_dwordx4 v[32:35], v4, s[16:19], s22 offen
    buffer_load_dword v96, v5, s[16:19], s23 offen
    s_add_u32 s22, s22, 4224
    s_add_u32 s23, s23, 4224
    buffer_load_dwordx4 v[36:39], v4, s[16:19], s22 offen
    buffer_load_dword v97, v5, s[16:19], s23 offen
    s_add_u32 s22, s22, 4224
    s_add_u32 s23, s23, 4224
    buffer_load_dwordx4 v[40:43], v4, s[16:19], s22 offen
    buffer_load_dword v98, v5, s[16:19], s23 offen
    s_add_u32 s22, s22, 4224
    s_add_u32 s23, s23, 4224
    buffer_load_dwordx4 v[44:47], v4, s[16:19], s22 offen
    buffer_load_dword v99, v5, s[16:19], s23 offen
    s_add_u32 s22, s22, 4224
    s_add_u32 s23, s23, 4224
    buffer_load_dwordx4 v[48:51], v4, s[16:19], s22 offen
    buffer_load_dword v100, v5, s[16:19], s23 offen
    s_add_u32 s22, s22, 4224
    s_add_u32 s23, s23, 4224
    buffer_load_dwordx4 v[52:55], v4, s[16:19], s22 offen
    buffer_load_dword v101, v5, s[16:19], s23 offen
    s_add_u32 s22, s22, 4224
    s_add_u32 s23, s23, 4224
    buffer_load_dwordx4 v[56:59], v4, s[16:19], s22 offen
    buffer_load_dword v102, v5, s[16:19], s23 offen
    s_add_u32 s22, s22, 4224
    s_add_u32 s23, s23, 4224
    buffer_load_dwordx4 v[60:63], v4, s[16:19], s22 offen
    buffer_load_dword v103, v5, s[16:19], s23 offen
    s_add_u32 s22, s22, 4224
    s_add_u32 s23, s23, 4224
    buffer_load_dwordx4 v[64:67], v4, s[16:19], s22 offen
    buffer_load_dword v104, v5, s[16:19], s23 offen
    s_add_u32 s22, s22, 4224
    s_add_u32 s23, s23, 4224
    buffer_load_dwordx4 v[68:71], v4, s[16:19], s22 offen
    buffer_load_dword v105, v5, s[16:19], s23 offen
    s_add_u32 s22, s22, 4224
    s_add_u32 s23, s23, 4224
    buffer_load_dwordx4 v[72:75], v4, s[16:19], s22 offen
    buffer_load_dword v106, v5, s[16:19], s23 offen
    s_add_u32 s22, s22, 4224
    s_add_u32 s23, s23, 4224
    buffer_load_dwordx4 v[76:79], v4, s[16:19], s22 offen
    buffer_load_dword v107, v5, s[16:19], s23 offen
    s_add_u32 s22, s22, 4224
    s_add_u32 s23, s23, 4224
    buffer_load_dwordx4 v[80:83], v4, s[16:19], s22 offen
    buffer_load_dword v108, v5, s[16:19], s23 offen
    s_add_u32 s22, s22, 4224
    s_add_u32 s23, s23, 4224
    buffer_load_dwordx4 v[84:87], v4, s[16:19], s22 offen
    buffer_load_dword v109, v5, s[16:19], s23 offen
    s_add_u32 s22, s22, 4224
    s_add_u32 s23, s23, 4224
    buffer_load_dwordx4 v[88:91], v4, s[16:19], s22 offen
    buffer_load_dword v110, v5, s[16:19], s23 offen
    s_add_u32 s22, s22, 4224
    s_add_u32 s23, s23, 4224
    buffer_load_dwordx4 v[92:95], v4, s[16:19], s22 offen
    buffer_load_dword v111, v5, s[16:19], s23 offen
    s_waitcnt vmcnt(0)
    v_add_f32 v32, v32, v36
    v_add_f32 v33, v33, v37
    v_add_f32 v34, v34, v38
    v_add_f32 v35, v35, v39
    v_add_f32 v96, v96, v97
    v_add_f32 v32, v32, v40
    v_add_f32 v33, v33, v41
    v_add_f32 v34, v34, v42
    v_add_f32 v35, v35, v43
    v_add_f32 v96, v96, v98
    v_add_f32 v32, v32, v44
    v_add_f32 v33, v33, v45
    v_add_f32 v34, v34, v46
    v_add_f32 v35, v35, v47
    v_add_f32 v96, v96, v99
    v_add_f32 v32, v32, v48
    v_add_f32 v33, v33, v49
    v_add_f32 v34, v34, v50
    v_add_f32 v35, v35, v51
    v_add_f32 v96, v96, v100
    v_add_f32 v32, v32, v52
    v_add_f32 v33, v33, v53
    v_add_f32 v34, v34, v54
    v_add_f32 v35, v35, v55
    v_add_f32 v96, v96, v101
    v_add_f32 v32, v32, v56
    v_add_f32 v33, v33, v57
    v_add_f32 v34, v34, v58
    v_add_f32 v35, v35, v59
    v_add_f32 v96, v96, v102
    v_add_f32 v32, v32, v60
    v_add_f32 v33, v33, v61
    v_add_f32 v34, v34, v62
    v_add_f32 v35, v35, v63
    v_add_f32 v96, v96, v103
    v_add_f32 v32, v32, v64
    v_add_f32 v33, v33, v65
    v_add_f32 v34, v34, v66
    v_add_f32 v35, v35, v67
    v_add_f32 v96, v96, v104
    v_add_f32 v32, v32, v68
    v_add_f32 v33, v33, v69
    v_add_f32 v34, v34, v70
    v_add_f32 v35, v35, v71
    v_add_f32 v96, v96, v105
    v_add_f32 v32, v32, v72
    v_add_f32 v33, v33, v73
    v_add_f32 v34, v34, v74
    v_add_f32 v35, v35, v75
    v_add_f32 v96, v96, v106
    v_add_f32 v32, v32, v76
    v_add_f32 v33, v33, v77
    v_add_f32 v34, v34, v78
    v_add_f32 v35, v35, v79
    v_add_f32 v96, v96, v107
    v_add_f32 v32, v32, v80
    v_add_f32 v33, v33, v81
    v_add_f32 v34, v34, v82
    v_add_f32 v35, v35, v83
    v_add_f32 v96, v96, v108
    v_add_f32 v32, v32, v84
    v_add_f32 v33, v33, v85
    v_add_f32 v34, v34, v86
    v_add_f32 v35, v35, v87
    v_add_f32 v96, v96, v109
    v_add_f32 v32, v32, v88
    v_add_f32 v33, v33, v89
    v_add_f32 v34, v34, v90
    v_add_f32 v35, v35, v91
    v_add_f32 v96, v96, v110
    v_add_f32 v32, v32, v92
    v_add_f32 v33, v33, v93
    v_add_f32 v34, v34, v94
    v_add_f32 v35, v35, v95
    v_add_f32 v96, v96, v111
    v_cvt_pk_bf16_f32 v8, v32, v33
    v_cvt_pk_bf16_f32 v9, v34, v35
    v_lshlrev_b32 v10, 3, v0
    ds_write_b64 v10, v[8:9] offset:0
    v_cvt_pk_bf16_f32 v8, v96, v96
    v_and_b32 v10, 31, v0
    v_lshlrev_b32 v10, 1, v10
    ds_write_b16 v10, v8 offset:4096
    s_lshl_b32 s22, s20, 1
    s_add_u32 s22, s22, 1
    s_mul_i32 s22, s22, 67584
    s_add_u32 s22, s22, 20971520
    s_add_u32 s23, s22, 4096
    buffer_load_dwordx4 v[32:35], v4, s[16:19], s22 offen
    buffer_load_dword v96, v5, s[16:19], s23 offen
    s_add_u32 s22, s22, 4224
    s_add_u32 s23, s23, 4224
    buffer_load_dwordx4 v[36:39], v4, s[16:19], s22 offen
    buffer_load_dword v97, v5, s[16:19], s23 offen
    s_add_u32 s22, s22, 4224
    s_add_u32 s23, s23, 4224
    buffer_load_dwordx4 v[40:43], v4, s[16:19], s22 offen
    buffer_load_dword v98, v5, s[16:19], s23 offen
    s_add_u32 s22, s22, 4224
    s_add_u32 s23, s23, 4224
    buffer_load_dwordx4 v[44:47], v4, s[16:19], s22 offen
    buffer_load_dword v99, v5, s[16:19], s23 offen
    s_add_u32 s22, s22, 4224
    s_add_u32 s23, s23, 4224
    buffer_load_dwordx4 v[48:51], v4, s[16:19], s22 offen
    buffer_load_dword v100, v5, s[16:19], s23 offen
    s_add_u32 s22, s22, 4224
    s_add_u32 s23, s23, 4224
    buffer_load_dwordx4 v[52:55], v4, s[16:19], s22 offen
    buffer_load_dword v101, v5, s[16:19], s23 offen
    s_add_u32 s22, s22, 4224
    s_add_u32 s23, s23, 4224
    buffer_load_dwordx4 v[56:59], v4, s[16:19], s22 offen
    buffer_load_dword v102, v5, s[16:19], s23 offen
    s_add_u32 s22, s22, 4224
    s_add_u32 s23, s23, 4224
    buffer_load_dwordx4 v[60:63], v4, s[16:19], s22 offen
    buffer_load_dword v103, v5, s[16:19], s23 offen
    s_add_u32 s22, s22, 4224
    s_add_u32 s23, s23, 4224
    buffer_load_dwordx4 v[64:67], v4, s[16:19], s22 offen
    buffer_load_dword v104, v5, s[16:19], s23 offen
    s_add_u32 s22, s22, 4224
    s_add_u32 s23, s23, 4224
    buffer_load_dwordx4 v[68:71], v4, s[16:19], s22 offen
    buffer_load_dword v105, v5, s[16:19], s23 offen
    s_add_u32 s22, s22, 4224
    s_add_u32 s23, s23, 4224
    buffer_load_dwordx4 v[72:75], v4, s[16:19], s22 offen
    buffer_load_dword v106, v5, s[16:19], s23 offen
    s_add_u32 s22, s22, 4224
    s_add_u32 s23, s23, 4224
    buffer_load_dwordx4 v[76:79], v4, s[16:19], s22 offen
    buffer_load_dword v107, v5, s[16:19], s23 offen
    s_add_u32 s22, s22, 4224
    s_add_u32 s23, s23, 4224
    buffer_load_dwordx4 v[80:83], v4, s[16:19], s22 offen
    buffer_load_dword v108, v5, s[16:19], s23 offen
    s_add_u32 s22, s22, 4224
    s_add_u32 s23, s23, 4224
    buffer_load_dwordx4 v[84:87], v4, s[16:19], s22 offen
    buffer_load_dword v109, v5, s[16:19], s23 offen
    s_add_u32 s22, s22, 4224
    s_add_u32 s23, s23, 4224
    buffer_load_dwordx4 v[88:91], v4, s[16:19], s22 offen
    buffer_load_dword v110, v5, s[16:19], s23 offen
    s_add_u32 s22, s22, 4224
    s_add_u32 s23, s23, 4224
    buffer_load_dwordx4 v[92:95], v4, s[16:19], s22 offen
    buffer_load_dword v111, v5, s[16:19], s23 offen
    s_waitcnt vmcnt(0)
    v_add_f32 v32, v32, v36
    v_add_f32 v33, v33, v37
    v_add_f32 v34, v34, v38
    v_add_f32 v35, v35, v39
    v_add_f32 v96, v96, v97
    v_add_f32 v32, v32, v40
    v_add_f32 v33, v33, v41
    v_add_f32 v34, v34, v42
    v_add_f32 v35, v35, v43
    v_add_f32 v96, v96, v98
    v_add_f32 v32, v32, v44
    v_add_f32 v33, v33, v45
    v_add_f32 v34, v34, v46
    v_add_f32 v35, v35, v47
    v_add_f32 v96, v96, v99
    v_add_f32 v32, v32, v48
    v_add_f32 v33, v33, v49
    v_add_f32 v34, v34, v50
    v_add_f32 v35, v35, v51
    v_add_f32 v96, v96, v100
    v_add_f32 v32, v32, v52
    v_add_f32 v33, v33, v53
    v_add_f32 v34, v34, v54
    v_add_f32 v35, v35, v55
    v_add_f32 v96, v96, v101
    v_add_f32 v32, v32, v56
    v_add_f32 v33, v33, v57
    v_add_f32 v34, v34, v58
    v_add_f32 v35, v35, v59
    v_add_f32 v96, v96, v102
    v_add_f32 v32, v32, v60
    v_add_f32 v33, v33, v61
    v_add_f32 v34, v34, v62
    v_add_f32 v35, v35, v63
    v_add_f32 v96, v96, v103
    v_add_f32 v32, v32, v64
    v_add_f32 v33, v33, v65
    v_add_f32 v34, v34, v66
    v_add_f32 v35, v35, v67
    v_add_f32 v96, v96, v104
    v_add_f32 v32, v32, v68
    v_add_f32 v33, v33, v69
    v_add_f32 v34, v34, v70
    v_add_f32 v35, v35, v71
    v_add_f32 v96, v96, v105
    v_add_f32 v32, v32, v72
    v_add_f32 v33, v33, v73
    v_add_f32 v34, v34, v74
    v_add_f32 v35, v35, v75
    v_add_f32 v96, v96, v106
    v_add_f32 v32, v32, v76
    v_add_f32 v33, v33, v77
    v_add_f32 v34, v34, v78
    v_add_f32 v35, v35, v79
    v_add_f32 v96, v96, v107
    v_add_f32 v32, v32, v80
    v_add_f32 v33, v33, v81
    v_add_f32 v34, v34, v82
    v_add_f32 v35, v35, v83
    v_add_f32 v96, v96, v108
    v_add_f32 v32, v32, v84
    v_add_f32 v33, v33, v85
    v_add_f32 v34, v34, v86
    v_add_f32 v35, v35, v87
    v_add_f32 v96, v96, v109
    v_add_f32 v32, v32, v88
    v_add_f32 v33, v33, v89
    v_add_f32 v34, v34, v90
    v_add_f32 v35, v35, v91
    v_add_f32 v96, v96, v110
    v_add_f32 v32, v32, v92
    v_add_f32 v33, v33, v93
    v_add_f32 v34, v34, v94
    v_add_f32 v35, v35, v95
    v_add_f32 v96, v96, v111
    v_cvt_pk_bf16_f32 v8, v32, v33
    v_cvt_pk_bf16_f32 v9, v34, v35
    v_lshlrev_b32 v10, 3, v0
    ds_write_b64 v10, v[8:9] offset:2048
    v_cvt_pk_bf16_f32 v8, v96, v96
    v_and_b32 v10, 31, v0
    v_lshlrev_b32 v10, 1, v10
    ds_write_b16 v10, v8 offset:4160
    v_and_b32 v4, 31, v2
    v_lshlrev_b32 v4, 11, v4
    v_lshrrev_b32 v5, 5, v2
    v_lshlrev_b32 v5, 4, v5
    v_add_u32 v4, v4, v5
    s_lshl_b32 s24, s21, 18
    s_lshl_b32 s25, s3, 16
    s_add_u32 s24, s24, s25
    s_lshl_b32 s25, s20, 7
    s_add_u32 s24, s24, s25
    s_add_u32 s26, s24, 4194304
    buffer_load_dwordx4 v[32:35], v4, s[16:19], s26 offen offset:0
    buffer_load_dwordx4 v[36:39], v4, s[16:19], s26 offen offset:32
    buffer_load_dwordx4 v[40:43], v4, s[16:19], s26 offen offset:64
    buffer_load_dwordx4 v[44:47], v4, s[16:19], s26 offen offset:96
    s_waitcnt lgkmcnt(0)
    s_barrier
    v_and_b32 v6, 31, v2
    v_lshlrev_b32 v6, 6, v6
    v_add_u32 v6, v6, v5
    ds_read_b128 v[48:51], v6 offset:0
    ds_read_b128 v[64:67], v5 offset:4096
    ds_read_b128 v[52:55], v6 offset:32
    ds_read_b128 v[68:71], v5 offset:4128
    ds_read_b128 v[56:59], v6 offset:2048
    ds_read_b128 v[72:75], v5 offset:4160
    ds_read_b128 v[60:63], v6 offset:2080
    ds_read_b128 v[76:79], v5 offset:4192
    v_mov_b32 v80, 0
    v_mov_b32 v81, 0
    v_mov_b32 v82, 0
    v_mov_b32 v83, 0
    v_mov_b32 v84, 0
    v_mov_b32 v85, 0
    v_mov_b32 v86, 0
    v_mov_b32 v87, 0
    v_mov_b32 v88, 0
    v_mov_b32 v89, 0
    v_mov_b32 v90, 0
    v_mov_b32 v91, 0
    v_mov_b32 v92, 0
    v_mov_b32 v93, 0
    v_mov_b32 v94, 0
    v_mov_b32 v95, 0
    v_mov_b32 v96, 0
    v_mov_b32 v97, 0
    v_mov_b32 v98, 0
    v_mov_b32 v99, 0
    v_mov_b32 v100, 0
    v_mov_b32 v101, 0
    v_mov_b32 v102, 0
    v_mov_b32 v103, 0
    v_mov_b32 v104, 0
    v_mov_b32 v105, 0
    v_mov_b32 v106, 0
    v_mov_b32 v107, 0
    v_mov_b32 v108, 0
    v_mov_b32 v109, 0
    v_mov_b32 v110, 0
    v_mov_b32 v111, 0
    v_mov_b32 v112, 0
    v_mov_b32 v113, 0
    v_mov_b32 v114, 0
    v_mov_b32 v115, 0
    v_mov_b32 v116, 0
    v_mov_b32 v117, 0
    v_mov_b32 v118, 0
    v_mov_b32 v119, 0
    v_mov_b32 v120, 0
    v_mov_b32 v121, 0
    v_mov_b32 v122, 0
    v_mov_b32 v123, 0
    v_mov_b32 v124, 0
    v_mov_b32 v125, 0
    v_mov_b32 v126, 0
    v_mov_b32 v127, 0
    v_mov_b32 v128, 0
    v_mov_b32 v129, 0
    v_mov_b32 v130, 0
    v_mov_b32 v131, 0
    v_mov_b32 v132, 0
    v_mov_b32 v133, 0
    v_mov_b32 v134, 0
    v_mov_b32 v135, 0
    v_mov_b32 v136, 0
    v_mov_b32 v137, 0
    v_mov_b32 v138, 0
    v_mov_b32 v139, 0
    v_mov_b32 v140, 0
    v_mov_b32 v141, 0
    v_mov_b32 v142, 0
    v_mov_b32 v143, 0
    s_waitcnt vmcnt(0) lgkmcnt(0)
    s_nop 1
    v_mfma_f32_32x32x16_bf16 v[80:95], v[48:51], v[32:35], v[80:95]
    v_mfma_f32_32x32x16_bf16 v[96:111], v[64:67], v[32:35], v[96:111]
    v_mfma_f32_32x32x16_bf16 v[80:95], v[52:55], v[36:39], v[80:95]
    v_mfma_f32_32x32x16_bf16 v[96:111], v[68:71], v[36:39], v[96:111]
    v_mfma_f32_32x32x16_bf16 v[112:127], v[56:59], v[40:43], v[112:127]
    v_mfma_f32_32x32x16_bf16 v[128:143], v[72:75], v[40:43], v[128:143]
    v_mfma_f32_32x32x16_bf16 v[112:127], v[60:63], v[44:47], v[112:127]
    v_mfma_f32_32x32x16_bf16 v[128:143], v[76:79], v[44:47], v[128:143]
    s_nop 15
    s_nop 3
    s_add_u32 s26, s24, 8388608
    v_cvt_pk_bf16_f32 v8, v96, v96
    v_lshlrev_b32 v96, 16, v8
    v_add_f32 v96, 0x358637bd, v96
    v_cvt_pk_bf16_f32 v8, v96, v96
    v_lshlrev_b32 v96, 16, v8
    v_rcp_f32 v96, v96
    s_nop 0
    v_cvt_pk_bf16_f32 v8, v80, v81
    v_lshlrev_b32 v80, 16, v8
    v_and_b32 v81, 0xffff0000, v8
    v_mul_f32 v80, v80, v96
    v_mul_f32 v81, v81, v96
    v_cvt_pk_bf16_f32 v8, v82, v83
    v_lshlrev_b32 v82, 16, v8
    v_and_b32 v83, 0xffff0000, v8
    v_mul_f32 v82, v82, v96
    v_mul_f32 v83, v83, v96
    v_cvt_pk_bf16_f32 v8, v84, v85
    v_lshlrev_b32 v84, 16, v8
    v_and_b32 v85, 0xffff0000, v8
    v_mul_f32 v84, v84, v96
    v_mul_f32 v85, v85, v96
    v_cvt_pk_bf16_f32 v8, v86, v87
    v_lshlrev_b32 v86, 16, v8
    v_and_b32 v87, 0xffff0000, v8
    v_mul_f32 v86, v86, v96
    v_mul_f32 v87, v87, v96
    v_cvt_pk_bf16_f32 v8, v88, v89
    v_lshlrev_b32 v88, 16, v8
    v_and_b32 v89, 0xffff0000, v8
    v_mul_f32 v88, v88, v96
    v_mul_f32 v89, v89, v96
    v_cvt_pk_bf16_f32 v8, v90, v91
    v_lshlrev_b32 v90, 16, v8
    v_and_b32 v91, 0xffff0000, v8
    v_mul_f32 v90, v90, v96
    v_mul_f32 v91, v91, v96
    v_cvt_pk_bf16_f32 v8, v92, v93
    v_lshlrev_b32 v92, 16, v8
    v_and_b32 v93, 0xffff0000, v8
    v_mul_f32 v92, v92, v96
    v_mul_f32 v93, v93, v96
    v_cvt_pk_bf16_f32 v8, v94, v95
    v_lshlrev_b32 v94, 16, v8
    v_and_b32 v95, 0xffff0000, v8
    v_mul_f32 v94, v94, v96
    v_mul_f32 v95, v95, v96
    v_cvt_pk_bf16_f32 v16, v80, v81
    v_cvt_pk_bf16_f32 v17, v82, v83
    v_cvt_pk_bf16_f32 v18, v84, v85
    v_cvt_pk_bf16_f32 v19, v86, v87
    v_cvt_pk_bf16_f32 v20, v88, v89
    v_cvt_pk_bf16_f32 v21, v90, v91
    v_cvt_pk_bf16_f32 v22, v92, v93
    v_cvt_pk_bf16_f32 v23, v94, v95
    s_nop 1
    v_permlane32_swap_b32 v16, v18
    v_permlane32_swap_b32 v17, v19
    v_permlane32_swap_b32 v20, v22
    v_permlane32_swap_b32 v21, v23
    buffer_store_dwordx4 v[16:19], v4, s[16:19], s26 offen offset:0
    buffer_store_dwordx4 v[20:23], v4, s[16:19], s26 offen offset:32
    v_cvt_pk_bf16_f32 v8, v128, v128
    v_lshlrev_b32 v128, 16, v8
    v_add_f32 v128, 0x358637bd, v128
    v_cvt_pk_bf16_f32 v8, v128, v128
    v_lshlrev_b32 v128, 16, v8
    v_rcp_f32 v128, v128
    s_nop 0
    v_cvt_pk_bf16_f32 v8, v112, v113
    v_lshlrev_b32 v112, 16, v8
    v_and_b32 v113, 0xffff0000, v8
    v_mul_f32 v112, v112, v128
    v_mul_f32 v113, v113, v128
    v_cvt_pk_bf16_f32 v8, v114, v115
    v_lshlrev_b32 v114, 16, v8
    v_and_b32 v115, 0xffff0000, v8
    v_mul_f32 v114, v114, v128
    v_mul_f32 v115, v115, v128
    v_cvt_pk_bf16_f32 v8, v116, v117
    v_lshlrev_b32 v116, 16, v8
    v_and_b32 v117, 0xffff0000, v8
    v_mul_f32 v116, v116, v128
    v_mul_f32 v117, v117, v128
    v_cvt_pk_bf16_f32 v8, v118, v119
    v_lshlrev_b32 v118, 16, v8
    v_and_b32 v119, 0xffff0000, v8
    v_mul_f32 v118, v118, v128
    v_mul_f32 v119, v119, v128
    v_cvt_pk_bf16_f32 v8, v120, v121
    v_lshlrev_b32 v120, 16, v8
    v_and_b32 v121, 0xffff0000, v8
    v_mul_f32 v120, v120, v128
    v_mul_f32 v121, v121, v128
    v_cvt_pk_bf16_f32 v8, v122, v123
    v_lshlrev_b32 v122, 16, v8
    v_and_b32 v123, 0xffff0000, v8
    v_mul_f32 v122, v122, v128
    v_mul_f32 v123, v123, v128
    v_cvt_pk_bf16_f32 v8, v124, v125
    v_lshlrev_b32 v124, 16, v8
    v_and_b32 v125, 0xffff0000, v8
    v_mul_f32 v124, v124, v128
    v_mul_f32 v125, v125, v128
    v_cvt_pk_bf16_f32 v8, v126, v127
    v_lshlrev_b32 v126, 16, v8
    v_and_b32 v127, 0xffff0000, v8
    v_mul_f32 v126, v126, v128
    v_mul_f32 v127, v127, v128
    v_cvt_pk_bf16_f32 v16, v112, v113
    v_cvt_pk_bf16_f32 v17, v114, v115
    v_cvt_pk_bf16_f32 v18, v116, v117
    v_cvt_pk_bf16_f32 v19, v118, v119
    v_cvt_pk_bf16_f32 v20, v120, v121
    v_cvt_pk_bf16_f32 v21, v122, v123
    v_cvt_pk_bf16_f32 v22, v124, v125
    v_cvt_pk_bf16_f32 v23, v126, v127
    s_nop 1
    v_permlane32_swap_b32 v16, v18
    v_permlane32_swap_b32 v17, v19
    v_permlane32_swap_b32 v20, v22
    v_permlane32_swap_b32 v21, v23
    buffer_store_dwordx4 v[16:19], v4, s[16:19], s26 offen offset:64
    buffer_store_dwordx4 v[20:23], v4, s[16:19], s26 offen offset:96
    s_endpgm
L_end_kmida_kernel:
    s_endpgm
.text
.globl k2a_kernel
.p2align 8
.type k2a_kernel,@function
k2a_kernel:
    s_cmp_ge_u32 s2, 256
    s_cbranch_scc1 L_end_k2a_kernel
    s_load_dwordx2 s[4:5], s[0:1], 80
    s_load_dwordx2 s[6:7], s[0:1], 16
    s_load_dwordx2 s[28:29], s[0:1], 0
    s_load_dwordx2 s[30:31], s[0:1], 32
    v_lshrrev_b32 v1, 6, v0
    v_and_b32 v2, 63, v0
    s_nop 0
    v_readfirstlane_b32 s3, v1
    s_lshr_b32 s20, s2, 4
    s_and_b32 s21, s2, 15
    s_lshl_b32 s24, s3, 12
    s_mov_b32 s25, 0
    s_lshl_b32 s26, s21, 7
    s_waitcnt lgkmcnt(0)
    s_add_u32 s8, s4, 8388608
    s_addc_u32 s9, s5, 0
    s_mov_b32 s10, 4194304
    s_mov_b32 s11, 0x00020000
    s_mov_b32 s12, s6
    s_mov_b32 s13, s7
    s_mov_b32 s14, 2097152
    s_mov_b32 s15, 0x00020000
    s_mov_b32 s16, s4
    s_mov_b32 s17, s5
    s_mov_b32 s18, 29360128
    s_mov_b32 s19, 0x00020000
    v_mov_b32 v32, 0
    v_mov_b32 v33, 0
    v_mov_b32 v34, 0
    v_mov_b32 v35, 0
    v_mov_b32 v36, 0
    v_mov_b32 v37, 0
    v_mov_b32 v38, 0
    v_mov_b32 v39, 0
    v_mov_b32 v40, 0
    v_mov_b32 v41, 0
    v_mov_b32 v42, 0
    v_mov_b32 v43, 0
    v_mov_b32 v44, 0
    v_mov_b32 v45, 0
    v_mov_b32 v46, 0
    v_mov_b32 v47, 0
    v_mov_b32 v48, 0
    v_mov_b32 v49, 0
    v_mov_b32 v50, 0
    v_mov_b32 v51, 0
    v_mov_b32 v52, 0
    v_mov_b32 v53, 0
    v_mov_b32 v54, 0
    v_mov_b32 v55, 0
    v_mov_b32 v56, 0
    v_mov_b32 v57, 0
    v_mov_b32 v58, 0
    v_mov_b32 v59, 0
    v_mov_b32 v60, 0
    v_mov_b32 v61, 0
    v_mov_b32 v62, 0
    v_mov_b32 v63, 0
    v_lshrrev_b32 v101, 4, v2
    v_add_u32 v101, 0, v101
    v_and_b32 v101, 7, v101
    v_and_b32 v102, 7, v2
    v_xor_b32 v101, v101, v102
    v_lshlrev_b32 v101, 4, v101
    v_lshrrev_b32 v102, 3, v2
    v_add_u32 v102, 0, v102
    v_lshlrev_b32 v102, 11, v102
    v_add_u32 v96, v101, v102
    v_lshrrev_b32 v101, 4, v2
    v_add_u32 v101, 4, v101
    v_and_b32 v101, 7, v101
    v_and_b32 v102, 7, v2
    v_xor_b32 v101, v101, v102
    v_lshlrev_b32 v101, 4, v101
    v_lshrrev_b32 v102, 3, v2
    v_add_u32 v102, 8, v102
    v_lshlrev_b32 v102, 11, v102
    v_add_u32 v97, v101, v102
    v_lshrrev_b32 v101, 4, v2
    v_add_u32 v101, 8, v101
    v_and_b32 v101, 7, v101
    v_and_b32 v102, 7, v2
    v_xor_b32 v101, v101, v102
    v_lshlrev_b32 v101, 4, v101
    v_lshrrev_b32 v102, 3, v2
    v_add_u32 v102, 16, v102
    v_lshlrev_b32 v102, 11, v102
    v_add_u32 v98, v101, v102
    v_lshrrev_b32 v101, 4, v2
    v_add_u32 v101, 12, v101
    v_and_b32 v101, 7, v101
    v_and_b32 v102, 7, v2
    v_xor_b32 v101, v101, v102
    v_lshlrev_b32 v101, 4, v101
    v_lshrrev_b32 v102, 3, v2
    v_add_u32 v102, 24, v102
    v_lshlrev_b32 v102, 11, v102
    v_add_u32 v99, v101, v102
    v_lshrrev_b32 v101, 4, v2
    v_and_b32 v101, 1, v101
    v_lshlrev_b32 v101, 2, v101
    v_and_b32 v102, 7, v2
    v_xor_b32 v101, v101, v102
    v_lshlrev_b32 v101, 4, v101
    v_lshrrev_b32 v102, 3, v2
    s_mov_b32 s40, 2048
    v_mul_lo_u32 v102, v102, s40
    v_add_u32 v100, v101, v102
    s_lshl_b32 s41, s20, 18
    s_lshl_b32 s43, s3, 16
    s_add_u32 s41, s41, s43
    s_mul_i32 s43, s3, 2
    s_add_u32 s43, s43, 0
    s_lshr_b32 s44, s43, 3
    s_and_b32 s43, s43, 7
    s_lshl_b32 s47, s44, 13
    s_lshl_b32 s45, s43, 10
    s_add_u32 s47, s47, s45
    s_add_u32 s47, s47, 16384
    s_mul_i32 s45, s43, 16384
    s_mul_i32 s44, s44, 0
    s_add_u32 s45, s45, s44
    s_add_u32 s45, s45, s26
    s_mul_i32 s43, s3, 2
    s_add_u32 s43, s43, 1
    s_lshr_b32 s44, s43, 3
    s_and_b32 s43, s43, 7
    s_lshl_b32 s48, s44, 13
    s_lshl_b32 s46, s43, 10
    s_add_u32 s48, s48, s46
    s_add_u32 s48, s48, 16384
    s_mul_i32 s46, s43, 16384
    s_mul_i32 s44, s44, 0
    s_add_u32 s46, s46, s44
    s_add_u32 s46, s46, s26
    s_lshl_b32 s49, s3, 12
    v_lshrrev_b32 v101, 5, v2
    v_add_u32 v101, 0, v101
    v_lshrrev_b32 v102, 1, v2
    v_and_b32 v102, 7, v102
    v_xor_b32 v101, v101, v102
    v_lshlrev_b32 v101, 4, v101
    v_and_b32 v102, 31, v2
    v_lshlrev_b32 v102, 7, v102
    v_add_u32 v101, v101, v102
    v_add_u32 v104, s24, v101
    v_add_u32 v108, 24576, v104
    v_add_u32 v112, 49152, v104
    v_add_u32 v116, 73728, v104
    v_lshrrev_b32 v101, 5, v2
    v_add_u32 v101, 2, v101
    v_lshrrev_b32 v102, 1, v2
    v_and_b32 v102, 7, v102
    v_xor_b32 v101, v101, v102
    v_lshlrev_b32 v101, 4, v101
    v_and_b32 v102, 31, v2
    v_lshlrev_b32 v102, 7, v102
    v_add_u32 v101, v101, v102
    v_add_u32 v105, s24, v101
    v_add_u32 v109, 24576, v105
    v_add_u32 v113, 49152, v105
    v_add_u32 v117, 73728, v105
    v_lshrrev_b32 v101, 5, v2
    v_add_u32 v101, 4, v101
    v_lshrrev_b32 v102, 1, v2
    v_and_b32 v102, 7, v102
    v_xor_b32 v101, v101, v102
    v_lshlrev_b32 v101, 4, v101
    v_and_b32 v102, 31, v2
    v_lshlrev_b32 v102, 7, v102
    v_add_u32 v101, v101, v102
    v_add_u32 v106, s24, v101
    v_add_u32 v110, 24576, v106
    v_add_u32 v114, 49152, v106
    v_add_u32 v118, 73728, v106
    v_lshrrev_b32 v101, 5, v2
    v_add_u32 v101, 6, v101
    v_lshrrev_b32 v102, 1, v2
    v_and_b32 v102, 7, v102
    v_xor_b32 v101, v101, v102
    v_lshlrev_b32 v101, 4, v101
    v_and_b32 v102, 31, v2
    v_lshlrev_b32 v102, 7, v102
    v_add_u32 v101, v101, v102
    v_add_u32 v107, s24, v101
    v_add_u32 v111, 24576, v107
    v_add_u32 v115, 49152, v107
    v_add_u32 v119, 73728, v107
    v_lshrrev_b32 v101, 5, v2
    v_lshlrev_b32 v101, 3, v101
    v_lshrrev_b32 v102, 2, v2
    v_and_b32 v102, 3, v102
    v_add_u32 v101, v101, v102
    v_lshlrev_b32 v120, 7, v101
    v_lshrrev_b32 v101, 4, v2
    v_and_b32 v101, 1, v101
    v_lshlrev_b32 v101, 1, v101
    v_lshrrev_b32 v102, 1, v2
    v_and_b32 v102, 1, v102
    v_add_u32 v101, v101, v102
    v_add_u32 v101, s25, v101
    v_lshrrev_b32 v102, 3, v2
    v_and_b32 v102, 1, v102
    v_lshlrev_b32 v102, 2, v102
    v_xor_b32 v101, v101, v102
    v_lshlrev_b32 v101, 4, v101
    v_add_u32 v120, v120, v101
    v_and_b32 v101, 1, v2
    v_lshlrev_b32 v101, 3, v101
    v_add_u32 v120, v120, v101
    v_add_u32 v120, 16384, v120
    v_add_u32 v121, 24576, v120
    v_add_u32 v122, 49152, v120
    v_add_u32 v123, 73728, v120
    v_xor_b32 v134, 64, v120
    v_xor_b32 v135, 64, v121
    v_xor_b32 v136, 64, v122
    v_xor_b32 v137, 64, v123
    s_mov_b32 s52, 0
    s_mov_b32 s53, 0
    s_add_u32 s50, s49, 0
    s_mov_b32 m0, s50
    s_add_u32 s51, s41, s52
    buffer_load_dwordx4 v96, s[8:11], s51 offen lds
    s_add_u32 s50, s49, 1024
    s_mov_b32 m0, s50
    s_add_u32 s51, s41, s52
    buffer_load_dwordx4 v97, s[8:11], s51 offen lds
    s_add_u32 s50, s49, 2048
    s_mov_b32 m0, s50
    s_add_u32 s51, s41, s52
    buffer_load_dwordx4 v98, s[8:11], s51 offen lds
    s_add_u32 s50, s49, 3072
    s_mov_b32 m0, s50
    s_add_u32 s51, s41, s52
    buffer_load_dwordx4 v99, s[8:11], s51 offen lds
    s_add_u32 s50, s47, 0
    s_mov_b32 m0, s50
    s_add_u32 s51, s45, s53
    buffer_load_dwordx4 v100, s[12:15], s51 offen lds
    s_add_u32 s50, s48, 0
    s_mov_b32 m0, s50
    s_add_u32 s51, s46, s53
    buffer_load_dwordx4 v100, s[12:15], s51 offen lds
    s_add_u32 s52, s52, 128
    s_add_u32 s53, s53, 131072
    s_add_u32 s50, s49, 24576
    s_mov_b32 m0, s50
    s_add_u32 s51, s41, s52
    buffer_load_dwordx4 v96, s[8:11], s51 offen lds
    s_add_u32 s50, s49, 25600
    s_mov_b32 m0, s50
    s_add_u32 s51, s41, s52
    buffer_load_dwordx4 v97, s[8:11], s51 offen lds
    s_add_u32 s50, s49, 26624
    s_mov_b32 m0, s50
    s_add_u32 s51, s41, s52
    buffer_load_dwordx4 v98, s[8:11], s51 offen lds
    s_add_u32 s50, s49, 27648
    s_mov_b32 m0, s50
    s_add_u32 s51, s41, s52
    buffer_load_dwordx4 v99, s[8:11], s51 offen lds
    s_add_u32 s50, s47, 24576
    s_mov_b32 m0, s50
    s_add_u32 s51, s45, s53
    buffer_load_dwordx4 v100, s[12:15], s51 offen lds
    s_add_u32 s50, s48, 24576
    s_mov_b32 m0, s50
    s_add_u32 s51, s46, s53
    buffer_load_dwordx4 v100, s[12:15], s51 offen lds
    s_add_u32 s52, s52, 128
    s_add_u32 s53, s53, 131072
    s_add_u32 s50, s49, 49152
    s_mov_b32 m0, s50
    s_add_u32 s51, s41, s52
    buffer_load_dwordx4 v96, s[8:11], s51 offen lds
    s_add_u32 s50, s49, 50176
    s_mov_b32 m0, s50
    s_add_u32 s51, s41, s52
    buffer_load_dwordx4 v97, s[8:11], s51 offen lds
    s_add_u32 s50, s49, 51200
    s_mov_b32 m0, s50
    s_add_u32 s51, s41, s52
    buffer_load_dwordx4 v98, s[8:11], s51 offen lds
    s_add_u32 s50, s49, 52224
    s_mov_b32 m0, s50
    s_add_u32 s51, s41, s52
    buffer_load_dwordx4 v99, s[8:11], s51 offen lds
    s_add_u32 s50, s47, 49152
    s_mov_b32 m0, s50
    s_add_u32 s51, s45, s53
    buffer_load_dwordx4 v100, s[12:15], s51 offen lds
    s_add_u32 s50, s48, 49152
    s_mov_b32 m0, s50
    s_add_u32 s51, s46, s53
    buffer_load_dwordx4 v100, s[12:15], s51 offen lds
    s_add_u32 s52, s52, 128
    s_add_u32 s53, s53, 131072
    s_waitcnt vmcnt(12)
    s_barrier
    s_mov_b32 s54, 0
L_gl_k2a_kernel:
    s_add_u32 s50, s49, 73728
    s_mov_b32 m0, s50
    s_add_u32 s51, s41, s52
    buffer_load_dwordx4 v96, s[8:11], s51 offen lds
    s_add_u32 s50, s49, 74752
    s_mov_b32 m0, s50
    s_add_u32 s51, s41, s52
    buffer_load_dwordx4 v97, s[8:11], s51 offen lds
    s_add_u32 s50, s49, 75776
    s_mov_b32 m0, s50
    s_add_u32 s51, s41, s52
    buffer_load_dwordx4 v98, s[8:11], s51 offen lds
    s_add_u32 s50, s49, 76800
    s_mov_b32 m0, s50
    s_add_u32 s51, s41, s52
    buffer_load_dwordx4 v99, s[8:11], s51 offen lds
    s_add_u32 s50, s47, 73728
    s_mov_b32 m0, s50
    s_add_u32 s51, s45, s53
    buffer_load_dwordx4 v100, s[12:15], s51 offen lds
    s_add_u32 s50, s48, 73728
    s_mov_b32 m0, s50
    s_add_u32 s51, s46, s53
    buffer_load_dwordx4 v100, s[12:15], s51 offen lds
    s_add_u32 s52, s52, 128
    s_add_u32 s53, s53, 131072
    ds_read_b128 v[64:67], v104 offset:0
    ds_read_b64_tr_b16 v[68:69], v120 offset:0
    ds_read_b64_tr_b16 v[70:71], v120 offset:512
    ds_read_b64_tr_b16 v[72:73], v134 offset:0
    ds_read_b64_tr_b16 v[74:75], v134 offset:512
    ds_read_b128 v[76:79], v105 offset:0
    ds_read_b64_tr_b16 v[80:81], v120 offset:2048
    ds_read_b64_tr_b16 v[82:83], v120 offset:2560
    ds_read_b64_tr_b16 v[84:85], v134 offset:2048
    ds_read_b64_tr_b16 v[86:87], v134 offset:2560
    s_waitcnt lgkmcnt(5)
    v_mfma_f32_32x32x16_bf16 v[32:47], v[68:71], v[64:67], v[32:47]
    v_mfma_f32_32x32x16_bf16 v[48:63], v[72:75], v[64:67], v[48:63]
    ds_read_b128 v[64:67], v106 offset:0
    ds_read_b64_tr_b16 v[68:69], v120 offset:4096
    ds_read_b64_tr_b16 v[70:71], v120 offset:4608
    ds_read_b64_tr_b16 v[72:73], v134 offset:4096
    ds_read_b64_tr_b16 v[74:75], v134 offset:4608
    s_waitcnt lgkmcnt(5)
    v_mfma_f32_32x32x16_bf16 v[32:47], v[80:83], v[76:79], v[32:47]
    v_mfma_f32_32x32x16_bf16 v[48:63], v[84:87], v[76:79], v[48:63]
    ds_read_b128 v[76:79], v107 offset:0
    ds_read_b64_tr_b16 v[80:81], v120 offset:6144
    ds_read_b64_tr_b16 v[82:83], v120 offset:6656
    ds_read_b64_tr_b16 v[84:85], v134 offset:6144
    ds_read_b64_tr_b16 v[86:87], v134 offset:6656
    s_waitcnt lgkmcnt(5)
    v_mfma_f32_32x32x16_bf16 v[32:47], v[68:71], v[64:67], v[32:47]
    v_mfma_f32_32x32x16_bf16 v[48:63], v[72:75], v[64:67], v[48:63]
    s_waitcnt lgkmcnt(0)
    v_mfma_f32_32x32x16_bf16 v[32:47], v[80:83], v[76:79], v[32:47]
    v_mfma_f32_32x32x16_bf16 v[48:63], v[84:87], v[76:79], v[48:63]
    s_waitcnt vmcnt(12)
    s_barrier
    s_add_u32 s50, s49, 0
    s_mov_b32 m0, s50
    s_add_u32 s51, s41, s52
    buffer_load_dwordx4 v96, s[8:11], s51 offen lds
    s_add_u32 s50, s49, 1024
    s_mov_b32 m0, s50
    s_add_u32 s51, s41, s52
    buffer_load_dwordx4 v97, s[8:11], s51 offen lds
    s_add_u32 s50, s49, 2048
    s_mov_b32 m0, s50
    s_add_u32 s51, s41, s52
    buffer_load_dwordx4 v98, s[8:11], s51 offen lds
    s_add_u32 s50, s49, 3072
    s_mov_b32 m0, s50
    s_add_u32 s51, s41, s52
    buffer_load_dwordx4 v99, s[8:11], s51 offen lds
    s_add_u32 s50, s47, 0
    s_mov_b32 m0, s50
    s_add_u32 s51, s45, s53
    buffer_load_dwordx4 v100, s[12:15], s51 offen lds
    s_add_u32 s50, s48, 0
    s_mov_b32 m0, s50
    s_add_u32 s51, s46, s53
    buffer_load_dwordx4 v100, s[12:15], s51 offen lds
    s_add_u32 s52, s52, 128
    s_add_u32 s53, s53, 131072
    ds_read_b128 v[64:67], v108 offset:0
    ds_read_b64_tr_b16 v[68:69], v121 offset:0
    ds_read_b64_tr_b16 v[70:71], v121 offset:512
    ds_read_b64_tr_b16 v[72:73], v135 offset:0
    ds_read_b64_tr_b16 v[74:75], v135 offset:512
    ds_read_b128 v[76:79], v109 offset:0
    ds_read_b64_tr_b16 v[80:81], v121 offset:2048
    ds_read_b64_tr_b16 v[82:83], v121 offset:2560
    ds_read_b64_tr_b16 v[84:85], v135 offset:2048
    ds_read_b64_tr_b16 v[86:87], v135 offset:2560
    s_waitcnt lgkmcnt(5)
    v_mfma_f32_32x32x16_bf16 v[32:47], v[68:71], v[64:67], v[32:47]
    v_mfma_f32_32x32x16_bf16 v[48:63], v[72:75], v[64:67], v[48:63]
    ds_read_b128 v[64:67], v110 offset:0
    ds_read_b64_tr_b16 v[68:69], v121 offset:4096
    ds_read_b64_tr_b16 v[70:71], v121 offset:4608
    ds_read_b64_tr_b16 v[72:73], v135 offset:4096
    ds_read_b64_tr_b16 v[74:75], v135 offset:4608
    s_waitcnt lgkmcnt(5)
    v_mfma_f32_32x32x16_bf16 v[32:47], v[80:83], v[76:79], v[32:47]
    v_mfma_f32_32x32x16_bf16 v[48:63], v[84:87], v[76:79], v[48:63]
    ds_read_b128 v[76:79], v111 offset:0
    ds_read_b64_tr_b16 v[80:81], v121 offset:6144
    ds_read_b64_tr_b16 v[82:83], v121 offset:6656
    ds_read_b64_tr_b16 v[84:85], v135 offset:6144
    ds_read_b64_tr_b16 v[86:87], v135 offset:6656
    s_waitcnt lgkmcnt(5)
    v_mfma_f32_32x32x16_bf16 v[32:47], v[68:71], v[64:67], v[32:47]
    v_mfma_f32_32x32x16_bf16 v[48:63], v[72:75], v[64:67], v[48:63]
    s_waitcnt lgkmcnt(0)
    v_mfma_f32_32x32x16_bf16 v[32:47], v[80:83], v[76:79], v[32:47]
    v_mfma_f32_32x32x16_bf16 v[48:63], v[84:87], v[76:79], v[48:63]
    s_waitcnt vmcnt(12)
    s_barrier
    s_add_u32 s50, s49, 24576
    s_mov_b32 m0, s50
    s_add_u32 s51, s41, s52
    buffer_load_dwordx4 v96, s[8:11], s51 offen lds
    s_add_u32 s50, s49, 25600
    s_mov_b32 m0, s50
    s_add_u32 s51, s41, s52
    buffer_load_dwordx4 v97, s[8:11], s51 offen lds
    s_add_u32 s50, s49, 26624
    s_mov_b32 m0, s50
    s_add_u32 s51, s41, s52
    buffer_load_dwordx4 v98, s[8:11], s51 offen lds
    s_add_u32 s50, s49, 27648
    s_mov_b32 m0, s50
    s_add_u32 s51, s41, s52
    buffer_load_dwordx4 v99, s[8:11], s51 offen lds
    s_add_u32 s50, s47, 24576
    s_mov_b32 m0, s50
    s_add_u32 s51, s45, s53
    buffer_load_dwordx4 v100, s[12:15], s51 offen lds
    s_add_u32 s50, s48, 24576
    s_mov_b32 m0, s50
    s_add_u32 s51, s46, s53
    buffer_load_dwordx4 v100, s[12:15], s51 offen lds
    s_add_u32 s52, s52, 128
    s_add_u32 s53, s53, 131072
    ds_read_b128 v[64:67], v112 offset:0
    ds_read_b64_tr_b16 v[68:69], v122 offset:0
    ds_read_b64_tr_b16 v[70:71], v122 offset:512
    ds_read_b64_tr_b16 v[72:73], v136 offset:0
    ds_read_b64_tr_b16 v[74:75], v136 offset:512
    ds_read_b128 v[76:79], v113 offset:0
    ds_read_b64_tr_b16 v[80:81], v122 offset:2048
    ds_read_b64_tr_b16 v[82:83], v122 offset:2560
    ds_read_b64_tr_b16 v[84:85], v136 offset:2048
    ds_read_b64_tr_b16 v[86:87], v136 offset:2560
    s_waitcnt lgkmcnt(5)
    v_mfma_f32_32x32x16_bf16 v[32:47], v[68:71], v[64:67], v[32:47]
    v_mfma_f32_32x32x16_bf16 v[48:63], v[72:75], v[64:67], v[48:63]
    ds_read_b128 v[64:67], v114 offset:0
    ds_read_b64_tr_b16 v[68:69], v122 offset:4096
    ds_read_b64_tr_b16 v[70:71], v122 offset:4608
    ds_read_b64_tr_b16 v[72:73], v136 offset:4096
    ds_read_b64_tr_b16 v[74:75], v136 offset:4608
    s_waitcnt lgkmcnt(5)
    v_mfma_f32_32x32x16_bf16 v[32:47], v[80:83], v[76:79], v[32:47]
    v_mfma_f32_32x32x16_bf16 v[48:63], v[84:87], v[76:79], v[48:63]
    ds_read_b128 v[76:79], v115 offset:0
    ds_read_b64_tr_b16 v[80:81], v122 offset:6144
    ds_read_b64_tr_b16 v[82:83], v122 offset:6656
    ds_read_b64_tr_b16 v[84:85], v136 offset:6144
    ds_read_b64_tr_b16 v[86:87], v136 offset:6656
    s_waitcnt lgkmcnt(5)
    v_mfma_f32_32x32x16_bf16 v[32:47], v[68:71], v[64:67], v[32:47]
    v_mfma_f32_32x32x16_bf16 v[48:63], v[72:75], v[64:67], v[48:63]
    s_waitcnt lgkmcnt(0)
    v_mfma_f32_32x32x16_bf16 v[32:47], v[80:83], v[76:79], v[32:47]
    v_mfma_f32_32x32x16_bf16 v[48:63], v[84:87], v[76:79], v[48:63]
    s_waitcnt vmcnt(12)
    s_barrier
    s_add_u32 s50, s49, 49152
    s_mov_b32 m0, s50
    s_add_u32 s51, s41, s52
    buffer_load_dwordx4 v96, s[8:11], s51 offen lds
    s_add_u32 s50, s49, 50176
    s_mov_b32 m0, s50
    s_add_u32 s51, s41, s52
    buffer_load_dwordx4 v97, s[8:11], s51 offen lds
    s_add_u32 s50, s49, 51200
    s_mov_b32 m0, s50
    s_add_u32 s51, s41, s52
    buffer_load_dwordx4 v98, s[8:11], s51 offen lds
    s_add_u32 s50, s49, 52224
    s_mov_b32 m0, s50
    s_add_u32 s51, s41, s52
    buffer_load_dwordx4 v99, s[8:11], s51 offen lds
    s_add_u32 s50, s47, 49152
    s_mov_b32 m0, s50
    s_add_u32 s51, s45, s53
    buffer_load_dwordx4 v100, s[12:15], s51 offen lds
    s_add_u32 s50, s48, 49152
    s_mov_b32 m0, s50
    s_add_u32 s51, s46, s53
    buffer_load_dwordx4 v100, s[12:15], s51 offen lds
    s_add_u32 s52, s52, 128
    s_add_u32 s53, s53, 131072
    ds_read_b128 v[64:67], v116 offset:0
    ds_read_b64_tr_b16 v[68:69], v123 offset:0
    ds_read_b64_tr_b16 v[70:71], v123 offset:512
    ds_read_b64_tr_b16 v[72:73], v137 offset:0
    ds_read_b64_tr_b16 v[74:75], v137 offset:512
    ds_read_b128 v[76:79], v117 offset:0
    ds_read_b64_tr_b16 v[80:81], v123 offset:2048
    ds_read_b64_tr_b16 v[82:83], v123 offset:2560
    ds_read_b64_tr_b16 v[84:85], v137 offset:2048
    ds_read_b64_tr_b16 v[86:87], v137 offset:2560
    s_waitcnt lgkmcnt(5)
    v_mfma_f32_32x32x16_bf16 v[32:47], v[68:71], v[64:67], v[32:47]
    v_mfma_f32_32x32x16_bf16 v[48:63], v[72:75], v[64:67], v[48:63]
    ds_read_b128 v[64:67], v118 offset:0
    ds_read_b64_tr_b16 v[68:69], v123 offset:4096
    ds_read_b64_tr_b16 v[70:71], v123 offset:4608
    ds_read_b64_tr_b16 v[72:73], v137 offset:4096
    ds_read_b64_tr_b16 v[74:75], v137 offset:4608
    s_waitcnt lgkmcnt(5)
    v_mfma_f32_32x32x16_bf16 v[32:47], v[80:83], v[76:79], v[32:47]
    v_mfma_f32_32x32x16_bf16 v[48:63], v[84:87], v[76:79], v[48:63]
    ds_read_b128 v[76:79], v119 offset:0
    ds_read_b64_tr_b16 v[80:81], v123 offset:6144
    ds_read_b64_tr_b16 v[82:83], v123 offset:6656
    ds_read_b64_tr_b16 v[84:85], v137 offset:6144
    ds_read_b64_tr_b16 v[86:87], v137 offset:6656
    s_waitcnt lgkmcnt(5)
    v_mfma_f32_32x32x16_bf16 v[32:47], v[68:71], v[64:67], v[32:47]
    v_mfma_f32_32x32x16_bf16 v[48:63], v[72:75], v[64:67], v[48:63]
    s_waitcnt lgkmcnt(0)
    v_mfma_f32_32x32x16_bf16 v[32:47], v[80:83], v[76:79], v[32:47]
    v_mfma_f32_32x32x16_bf16 v[48:63], v[84:87], v[76:79], v[48:63]
    s_waitcnt vmcnt(12)
    s_barrier
    s_add_u32 s54, s54, 1
    s_cmp_lt_u32 s54, 3
    s_cbranch_scc1 L_gl_k2a_kernel
    s_add_u32 s50, s49, 73728
    s_mov_b32 m0, s50
    s_add_u32 s51, s41, s52
    buffer_load_dwordx4 v96, s[8:11], s51 offen lds
    s_add_u32 s50, s49, 74752
    s_mov_b32 m0, s50
    s_add_u32 s51, s41, s52
    buffer_load_dwordx4 v97, s[8:11], s51 offen lds
    s_add_u32 s50, s49, 75776
    s_mov_b32 m0, s50
    s_add_u32 s51, s41, s52
    buffer_load_dwordx4 v98, s[8:11], s51 offen lds
    s_add_u32 s50, s49, 76800
    s_mov_b32 m0, s50
    s_add_u32 s51, s41, s52
    buffer_load_dwordx4 v99, s[8:11], s51 offen lds
    s_add_u32 s50, s47, 73728
    s_mov_b32 m0, s50
    s_add_u32 s51, s45, s53
    buffer_load_dwordx4 v100, s[12:15], s51 offen lds
    s_add_u32 s50, s48, 73728
    s_mov_b32 m0, s50
    s_add_u32 s51, s46, s53
    buffer_load_dwordx4 v100, s[12:15], s51 offen lds
    s_add_u32 s52, s52, 128
    s_add_u32 s53, s53, 131072
    ds_read_b128 v[64:67], v104 offset:0
    ds_read_b64_tr_b16 v[68:69], v120 offset:0
    ds_read_b64_tr_b16 v[70:71], v120 offset:512
    ds_read_b64_tr_b16 v[72:73], v134 offset:0
    ds_read_b64_tr_b16 v[74:75], v134 offset:512
    ds_read_b128 v[76:79], v105 offset:0
    ds_read_b64_tr_b16 v[80:81], v120 offset:2048
    ds_read_b64_tr_b16 v[82:83], v120 offset:2560
    ds_read_b64_tr_b16 v[84:85], v134 offset:2048
    ds_read_b64_tr_b16 v[86:87], v134 offset:2560
    s_waitcnt lgkmcnt(5)
    v_mfma_f32_32x32x16_bf16 v[32:47], v[68:71], v[64:67], v[32:47]
    v_mfma_f32_32x32x16_bf16 v[48:63], v[72:75], v[64:67], v[48:63]
    ds_read_b128 v[64:67], v106 offset:0
    ds_read_b64_tr_b16 v[68:69], v120 offset:4096
    ds_read_b64_tr_b16 v[70:71], v120 offset:4608
    ds_read_b64_tr_b16 v[72:73], v134 offset:4096
    ds_read_b64_tr_b16 v[74:75], v134 offset:4608
    s_waitcnt lgkmcnt(5)
    v_mfma_f32_32x32x16_bf16 v[32:47], v[80:83], v[76:79], v[32:47]
    v_mfma_f32_32x32x16_bf16 v[48:63], v[84:87], v[76:79], v[48:63]
    ds_read_b128 v[76:79], v107 offset:0
    ds_read_b64_tr_b16 v[80:81], v120 offset:6144
    ds_read_b64_tr_b16 v[82:83], v120 offset:6656
    ds_read_b64_tr_b16 v[84:85], v134 offset:6144
    ds_read_b64_tr_b16 v[86:87], v134 offset:6656
    s_waitcnt lgkmcnt(5)
    v_mfma_f32_32x32x16_bf16 v[32:47], v[68:71], v[64:67], v[32:47]
    v_mfma_f32_32x32x16_bf16 v[48:63], v[72:75], v[64:67], v[48:63]
    s_waitcnt lgkmcnt(0)
    v_mfma_f32_32x32x16_bf16 v[32:47], v[80:83], v[76:79], v[32:47]
    v_mfma_f32_32x32x16_bf16 v[48:63], v[84:87], v[76:79], v[48:63]
    s_waitcnt vmcnt(12)
    s_barrier
    ds_read_b128 v[64:67], v108 offset:0
    ds_read_b64_tr_b16 v[68:69], v121 offset:0
    ds_read_b64_tr_b16 v[70:71], v121 offset:512
    ds_read_b64_tr_b16 v[72:73], v135 offset:0
    ds_read_b64_tr_b16 v[74:75], v135 offset:512
    ds_read_b128 v[76:79], v109 offset:0
    ds_read_b64_tr_b16 v[80:81], v121 offset:2048
    ds_read_b64_tr_b16 v[82:83], v121 offset:2560
    ds_read_b64_tr_b16 v[84:85], v135 offset:2048
    ds_read_b64_tr_b16 v[86:87], v135 offset:2560
    s_waitcnt lgkmcnt(5)
    v_mfma_f32_32x32x16_bf16 v[32:47], v[68:71], v[64:67], v[32:47]
    v_mfma_f32_32x32x16_bf16 v[48:63], v[72:75], v[64:67], v[48:63]
    ds_read_b128 v[64:67], v110 offset:0
    ds_read_b64_tr_b16 v[68:69], v121 offset:4096
    ds_read_b64_tr_b16 v[70:71], v121 offset:4608
    ds_read_b64_tr_b16 v[72:73], v135 offset:4096
    ds_read_b64_tr_b16 v[74:75], v135 offset:4608
    s_waitcnt lgkmcnt(5)
    v_mfma_f32_32x32x16_bf16 v[32:47], v[80:83], v[76:79], v[32:47]
    v_mfma_f32_32x32x16_bf16 v[48:63], v[84:87], v[76:79], v[48:63]
    ds_read_b128 v[76:79], v111 offset:0
    ds_read_b64_tr_b16 v[80:81], v121 offset:6144
    ds_read_b64_tr_b16 v[82:83], v121 offset:6656
    ds_read_b64_tr_b16 v[84:85], v135 offset:6144
    ds_read_b64_tr_b16 v[86:87], v135 offset:6656
    s_waitcnt lgkmcnt(5)
    v_mfma_f32_32x32x16_bf16 v[32:47], v[68:71], v[64:67], v[32:47]
    v_mfma_f32_32x32x16_bf16 v[48:63], v[72:75], v[64:67], v[48:63]
    s_waitcnt lgkmcnt(0)
    v_mfma_f32_32x32x16_bf16 v[32:47], v[80:83], v[76:79], v[32:47]
    v_mfma_f32_32x32x16_bf16 v[48:63], v[84:87], v[76:79], v[48:63]
    s_waitcnt vmcnt(6)
    s_barrier
    ds_read_b128 v[64:67], v112 offset:0
    ds_read_b64_tr_b16 v[68:69], v122 offset:0
    ds_read_b64_tr_b16 v[70:71], v122 offset:512
    ds_read_b64_tr_b16 v[72:73], v136 offset:0
    ds_read_b64_tr_b16 v[74:75], v136 offset:512
    ds_read_b128 v[76:79], v113 offset:0
    ds_read_b64_tr_b16 v[80:81], v122 offset:2048
    ds_read_b64_tr_b16 v[82:83], v122 offset:2560
    ds_read_b64_tr_b16 v[84:85], v136 offset:2048
    ds_read_b64_tr_b16 v[86:87], v136 offset:2560
    s_waitcnt lgkmcnt(5)
    v_mfma_f32_32x32x16_bf16 v[32:47], v[68:71], v[64:67], v[32:47]
    v_mfma_f32_32x32x16_bf16 v[48:63], v[72:75], v[64:67], v[48:63]
    ds_read_b128 v[64:67], v114 offset:0
    ds_read_b64_tr_b16 v[68:69], v122 offset:4096
    ds_read_b64_tr_b16 v[70:71], v122 offset:4608
    ds_read_b64_tr_b16 v[72:73], v136 offset:4096
    ds_read_b64_tr_b16 v[74:75], v136 offset:4608
    s_waitcnt lgkmcnt(5)
    v_mfma_f32_32x32x16_bf16 v[32:47], v[80:83], v[76:79], v[32:47]
    v_mfma_f32_32x32x16_bf16 v[48:63], v[84:87], v[76:79], v[48:63]
    ds_read_b128 v[76:79], v115 offset:0
    ds_read_b64_tr_b16 v[80:81], v122 offset:6144
    ds_read_b64_tr_b16 v[82:83], v122 offset:6656
    ds_read_b64_tr_b16 v[84:85], v136 offset:6144
    ds_read_b64_tr_b16 v[86:87], v136 offset:6656
    s_waitcnt lgkmcnt(5)
    v_mfma_f32_32x32x16_bf16 v[32:47], v[68:71], v[64:67], v[32:47]
    v_mfma_f32_32x32x16_bf16 v[48:63], v[72:75], v[64:67], v[48:63]
    s_waitcnt lgkmcnt(0)
    v_mfma_f32_32x32x16_bf16 v[32:47], v[80:83], v[76:79], v[32:47]
    v_mfma_f32_32x32x16_bf16 v[48:63], v[84:87], v[76:79], v[48:63]
    s_waitcnt vmcnt(0)
    s_barrier
    ds_read_b128 v[64:67], v116 offset:0
    ds_read_b64_tr_b16 v[68:69], v123 offset:0
    ds_read_b64_tr_b16 v[70:71], v123 offset:512
    ds_read_b64_tr_b16 v[72:73], v137 offset:0
    ds_read_b64_tr_b16 v[74:75], v137 offset:512
    ds_read_b128 v[76:79], v117 offset:0
    ds_read_b64_tr_b16 v[80:81], v123 offset:2048
    ds_read_b64_tr_b16 v[82:83], v123 offset:2560
    ds_read_b64_tr_b16 v[84:85], v137 offset:2048
    ds_read_b64_tr_b16 v[86:87], v137 offset:2560
    s_waitcnt lgkmcnt(5)
    v_mfma_f32_32x32x16_bf16 v[32:47], v[68:71], v[64:67], v[32:47]
    v_mfma_f32_32x32x16_bf16 v[48:63], v[72:75], v[64:67], v[48:63]
    ds_read_b128 v[64:67], v118 offset:0
    ds_read_b64_tr_b16 v[68:69], v123 offset:4096
    ds_read_b64_tr_b16 v[70:71], v123 offset:4608
    ds_read_b64_tr_b16 v[72:73], v137 offset:4096
    ds_read_b64_tr_b16 v[74:75], v137 offset:4608
    s_waitcnt lgkmcnt(5)
    v_mfma_f32_32x32x16_bf16 v[32:47], v[80:83], v[76:79], v[32:47]
    v_mfma_f32_32x32x16_bf16 v[48:63], v[84:87], v[76:79], v[48:63]
    ds_read_b128 v[76:79], v119 offset:0
    ds_read_b64_tr_b16 v[80:81], v123 offset:6144
    ds_read_b64_tr_b16 v[82:83], v123 offset:6656
    ds_read_b64_tr_b16 v[84:85], v137 offset:6144
    ds_read_b64_tr_b16 v[86:87], v137 offset:6656
    s_waitcnt lgkmcnt(5)
    v_mfma_f32_32x32x16_bf16 v[32:47], v[68:71], v[64:67], v[32:47]
    v_mfma_f32_32x32x16_bf16 v[48:63], v[72:75], v[64:67], v[48:63]
    s_waitcnt lgkmcnt(0)
    v_mfma_f32_32x32x16_bf16 v[32:47], v[80:83], v[76:79], v[32:47]
    v_mfma_f32_32x32x16_bf16 v[48:63], v[84:87], v[76:79], v[48:63]
    s_mov_b32 s8, s28
    s_mov_b32 s9, s29
    s_mov_b32 s10, 4194304
    s_mov_b32 s11, 0x00020000
    s_mov_b32 s12, s30
    s_mov_b32 s13, s31
    s_mov_b32 s14, 2048
    s_mov_b32 s15, 0x00020000
    v_and_b32 v96, 31, v2
    v_lshlrev_b32 v96, 11, v96
    v_lshrrev_b32 v97, 5, v2
    v_lshlrev_b32 v97, 4, v97
    v_add_u32 v96, v96, v97
    s_lshl_b32 s27, s20, 18
    s_lshl_b32 s28, s3, 16
    s_add_u32 s27, s27, s28
    s_add_u32 s27, s27, s26
    s_add_u32 s28, s27, 12582912
    buffer_load_dwordx4 v[112:115], v96, s[8:11], s27 offen offset:0
    buffer_load_dwordx4 v[128:131], v97, s[12:15], s26 offen offset:0
    buffer_load_dwordx4 v[116:119], v96, s[8:11], s27 offen offset:32
    buffer_load_dwordx4 v[132:135], v97, s[12:15], s26 offen offset:32
    buffer_load_dwordx4 v[120:123], v96, s[8:11], s27 offen offset:64
    buffer_load_dwordx4 v[136:139], v97, s[12:15], s26 offen offset:64
    buffer_load_dwordx4 v[124:127], v96, s[8:11], s27 offen offset:96
    buffer_load_dwordx4 v[140:143], v97, s[12:15], s26 offen offset:96
    s_nop 15
    s_nop 3
    v_cvt_pk_bf16_f32 v144, v32, v33
    v_cvt_pk_bf16_f32 v145, v34, v35
    v_cvt_pk_bf16_f32 v146, v36, v37
    v_cvt_pk_bf16_f32 v147, v38, v39
    v_cvt_pk_bf16_f32 v148, v40, v41
    v_cvt_pk_bf16_f32 v149, v42, v43
    v_cvt_pk_bf16_f32 v150, v44, v45
    v_cvt_pk_bf16_f32 v151, v46, v47
    s_nop 1
    v_permlane32_swap_b32 v144, v146
    v_permlane32_swap_b32 v145, v147
    v_permlane32_swap_b32 v148, v150
    v_permlane32_swap_b32 v149, v151
    v_cvt_pk_bf16_f32 v152, v48, v49
    v_cvt_pk_bf16_f32 v153, v50, v51
    v_cvt_pk_bf16_f32 v154, v52, v53
    v_cvt_pk_bf16_f32 v155, v54, v55
    v_cvt_pk_bf16_f32 v156, v56, v57
    v_cvt_pk_bf16_f32 v157, v58, v59
    v_cvt_pk_bf16_f32 v158, v60, v61
    v_cvt_pk_bf16_f32 v159, v62, v63
    s_nop 1
    v_permlane32_swap_b32 v152, v154
    v_permlane32_swap_b32 v153, v155
    v_permlane32_swap_b32 v156, v158
    v_permlane32_swap_b32 v157, v159
    v_mov_b32 v160, 0
    v_mov_b32 v161, 0
    v_mov_b32 v162, 0
    s_waitcnt vmcnt(0)
    v_lshlrev_b32 v164, 16, v144
    v_and_b32 v165, 0xffff0000, v144
    v_lshlrev_b32 v166, 16, v112
    v_and_b32 v167, 0xffff0000, v112
    v_add_f32 v164, v164, v166
    v_add_f32 v165, v165, v167
    v_cvt_pk_bf16_f32 v168, v164, v165
    v_lshlrev_b32 v164, 16, v168
    v_and_b32 v165, 0xffff0000, v168
    v_cvt_pk_bf16_f32 v144, v164, v165
    v_lshlrev_b32 v166, 16, v128
    v_and_b32 v167, 0xffff0000, v128
    v_add_f32 v160, v160, v164
    v_add_f32 v160, v160, v165
    v_fmac_f32 v161, v164, v164
    v_fmac_f32 v161, v165, v165
    v_fmac_f32 v162, v164, v166
    v_fmac_f32 v162, v165, v167
    v_lshlrev_b32 v164, 16, v145
    v_and_b32 v165, 0xffff0000, v145
    v_lshlrev_b32 v166, 16, v113
    v_and_b32 v167, 0xffff0000, v113
    v_add_f32 v164, v164, v166
    v_add_f32 v165, v165, v167
    v_cvt_pk_bf16_f32 v168, v164, v165
    v_lshlrev_b32 v164, 16, v168
    v_and_b32 v165, 0xffff0000, v168
    v_cvt_pk_bf16_f32 v145, v164, v165
    v_lshlrev_b32 v166, 16, v129
    v_and_b32 v167, 0xffff0000, v129
    v_add_f32 v160, v160, v164
    v_add_f32 v160, v160, v165
    v_fmac_f32 v161, v164, v164
    v_fmac_f32 v161, v165, v165
    v_fmac_f32 v162, v164, v166
    v_fmac_f32 v162, v165, v167
    v_lshlrev_b32 v164, 16, v146
    v_and_b32 v165, 0xffff0000, v146
    v_lshlrev_b32 v166, 16, v114
    v_and_b32 v167, 0xffff0000, v114
    v_add_f32 v164, v164, v166
    v_add_f32 v165, v165, v167
    v_cvt_pk_bf16_f32 v168, v164, v165
    v_lshlrev_b32 v164, 16, v168
    v_and_b32 v165, 0xffff0000, v168
    v_cvt_pk_bf16_f32 v146, v164, v165
    v_lshlrev_b32 v166, 16, v130
    v_and_b32 v167, 0xffff0000, v130
    v_add_f32 v160, v160, v164
    v_add_f32 v160, v160, v165
    v_fmac_f32 v161, v164, v164
    v_fmac_f32 v161, v165, v165
    v_fmac_f32 v162, v164, v166
    v_fmac_f32 v162, v165, v167
    v_lshlrev_b32 v164, 16, v147
    v_and_b32 v165, 0xffff0000, v147
    v_lshlrev_b32 v166, 16, v115
    v_and_b32 v167, 0xffff0000, v115
    v_add_f32 v164, v164, v166
    v_add_f32 v165, v165, v167
    v_cvt_pk_bf16_f32 v168, v164, v165
    v_lshlrev_b32 v164, 16, v168
    v_and_b32 v165, 0xffff0000, v168
    v_cvt_pk_bf16_f32 v147, v164, v165
    v_lshlrev_b32 v166, 16, v131
    v_and_b32 v167, 0xffff0000, v131
    v_add_f32 v160, v160, v164
    v_add_f32 v160, v160, v165
    v_fmac_f32 v161, v164, v164
    v_fmac_f32 v161, v165, v165
    v_fmac_f32 v162, v164, v166
    v_fmac_f32 v162, v165, v167
    buffer_store_dwordx4 v[144:147], v96, s[16:19], s28 offen offset:0
    v_lshlrev_b32 v164, 16, v148
    v_and_b32 v165, 0xffff0000, v148
    v_lshlrev_b32 v166, 16, v116
    v_and_b32 v167, 0xffff0000, v116
    v_add_f32 v164, v164, v166
    v_add_f32 v165, v165, v167
    v_cvt_pk_bf16_f32 v168, v164, v165
    v_lshlrev_b32 v164, 16, v168
    v_and_b32 v165, 0xffff0000, v168
    v_cvt_pk_bf16_f32 v148, v164, v165
    v_lshlrev_b32 v166, 16, v132
    v_and_b32 v167, 0xffff0000, v132
    v_add_f32 v160, v160, v164
    v_add_f32 v160, v160, v165
    v_fmac_f32 v161, v164, v164
    v_fmac_f32 v161, v165, v165
    v_fmac_f32 v162, v164, v166
    v_fmac_f32 v162, v165, v167
    v_lshlrev_b32 v164, 16, v149
    v_and_b32 v165, 0xffff0000, v149
    v_lshlrev_b32 v166, 16, v117
    v_and_b32 v167, 0xffff0000, v117
    v_add_f32 v164, v164, v166
    v_add_f32 v165, v165, v167
    v_cvt_pk_bf16_f32 v168, v164, v165
    v_lshlrev_b32 v164, 16, v168
    v_and_b32 v165, 0xffff0000, v168
    v_cvt_pk_bf16_f32 v149, v164, v165
    v_lshlrev_b32 v166, 16, v133
    v_and_b32 v167, 0xffff0000, v133
    v_add_f32 v160, v160, v164
    v_add_f32 v160, v160, v165
    v_fmac_f32 v161, v164, v164
    v_fmac_f32 v161, v165, v165
    v_fmac_f32 v162, v164, v166
    v_fmac_f32 v162, v165, v167
    v_lshlrev_b32 v164, 16, v150
    v_and_b32 v165, 0xffff0000, v150
    v_lshlrev_b32 v166, 16, v118
    v_and_b32 v167, 0xffff0000, v118
    v_add_f32 v164, v164, v166
    v_add_f32 v165, v165, v167
    v_cvt_pk_bf16_f32 v168, v164, v165
    v_lshlrev_b32 v164, 16, v168
    v_and_b32 v165, 0xffff0000, v168
    v_cvt_pk_bf16_f32 v150, v164, v165
    v_lshlrev_b32 v166, 16, v134
    v_and_b32 v167, 0xffff0000, v134
    v_add_f32 v160, v160, v164
    v_add_f32 v160, v160, v165
    v_fmac_f32 v161, v164, v164
    v_fmac_f32 v161, v165, v165
    v_fmac_f32 v162, v164, v166
    v_fmac_f32 v162, v165, v167
    v_lshlrev_b32 v164, 16, v151
    v_and_b32 v165, 0xffff0000, v151
    v_lshlrev_b32 v166, 16, v119
    v_and_b32 v167, 0xffff0000, v119
    v_add_f32 v164, v164, v166
    v_add_f32 v165, v165, v167
    v_cvt_pk_bf16_f32 v168, v164, v165
    v_lshlrev_b32 v164, 16, v168
    v_and_b32 v165, 0xffff0000, v168
    v_cvt_pk_bf16_f32 v151, v164, v165
    v_lshlrev_b32 v166, 16, v135
    v_and_b32 v167, 0xffff0000, v135
    v_add_f32 v160, v160, v164
    v_add_f32 v160, v160, v165
    v_fmac_f32 v161, v164, v164
    v_fmac_f32 v161, v165, v165
    v_fmac_f32 v162, v164, v166
    v_fmac_f32 v162, v165, v167
    buffer_store_dwordx4 v[148:151], v96, s[16:19], s28 offen offset:32
    v_lshlrev_b32 v164, 16, v152
    v_and_b32 v165, 0xffff0000, v152
    v_lshlrev_b32 v166, 16, v120
    v_and_b32 v167, 0xffff0000, v120
    v_add_f32 v164, v164, v166
    v_add_f32 v165, v165, v167
    v_cvt_pk_bf16_f32 v168, v164, v165
    v_lshlrev_b32 v164, 16, v168
    v_and_b32 v165, 0xffff0000, v168
    v_cvt_pk_bf16_f32 v152, v164, v165
    v_lshlrev_b32 v166, 16, v136
    v_and_b32 v167, 0xffff0000, v136
    v_add_f32 v160, v160, v164
    v_add_f32 v160, v160, v165
    v_fmac_f32 v161, v164, v164
    v_fmac_f32 v161, v165, v165
    v_fmac_f32 v162, v164, v166
    v_fmac_f32 v162, v165, v167
    v_lshlrev_b32 v164, 16, v153
    v_and_b32 v165, 0xffff0000, v153
    v_lshlrev_b32 v166, 16, v121
    v_and_b32 v167, 0xffff0000, v121
    v_add_f32 v164, v164, v166
    v_add_f32 v165, v165, v167
    v_cvt_pk_bf16_f32 v168, v164, v165
    v_lshlrev_b32 v164, 16, v168
    v_and_b32 v165, 0xffff0000, v168
    v_cvt_pk_bf16_f32 v153, v164, v165
    v_lshlrev_b32 v166, 16, v137
    v_and_b32 v167, 0xffff0000, v137
    v_add_f32 v160, v160, v164
    v_add_f32 v160, v160, v165
    v_fmac_f32 v161, v164, v164
    v_fmac_f32 v161, v165, v165
    v_fmac_f32 v162, v164, v166
    v_fmac_f32 v162, v165, v167
    v_lshlrev_b32 v164, 16, v154
    v_and_b32 v165, 0xffff0000, v154
    v_lshlrev_b32 v166, 16, v122
    v_and_b32 v167, 0xffff0000, v122
    v_add_f32 v164, v164, v166
    v_add_f32 v165, v165, v167
    v_cvt_pk_bf16_f32 v168, v164, v165
    v_lshlrev_b32 v164, 16, v168
    v_and_b32 v165, 0xffff0000, v168
    v_cvt_pk_bf16_f32 v154, v164, v165
    v_lshlrev_b32 v166, 16, v138
    v_and_b32 v167, 0xffff0000, v138
    v_add_f32 v160, v160, v164
    v_add_f32 v160, v160, v165
    v_fmac_f32 v161, v164, v164
    v_fmac_f32 v161, v165, v165
    v_fmac_f32 v162, v164, v166
    v_fmac_f32 v162, v165, v167
    v_lshlrev_b32 v164, 16, v155
    v_and_b32 v165, 0xffff0000, v155
    v_lshlrev_b32 v166, 16, v123
    v_and_b32 v167, 0xffff0000, v123
    v_add_f32 v164, v164, v166
    v_add_f32 v165, v165, v167
    v_cvt_pk_bf16_f32 v168, v164, v165
    v_lshlrev_b32 v164, 16, v168
    v_and_b32 v165, 0xffff0000, v168
    v_cvt_pk_bf16_f32 v155, v164, v165
    v_lshlrev_b32 v166, 16, v139
    v_and_b32 v167, 0xffff0000, v139
    v_add_f32 v160, v160, v164
    v_add_f32 v160, v160, v165
    v_fmac_f32 v161, v164, v164
    v_fmac_f32 v161, v165, v165
    v_fmac_f32 v162, v164, v166
    v_fmac_f32 v162, v165, v167
    buffer_store_dwordx4 v[152:155], v96, s[16:19], s28 offen offset:64
    v_lshlrev_b32 v164, 16, v156
    v_and_b32 v165, 0xffff0000, v156
    v_lshlrev_b32 v166, 16, v124
    v_and_b32 v167, 0xffff0000, v124
    v_add_f32 v164, v164, v166
    v_add_f32 v165, v165, v167
    v_cvt_pk_bf16_f32 v168, v164, v165
    v_lshlrev_b32 v164, 16, v168
    v_and_b32 v165, 0xffff0000, v168
    v_cvt_pk_bf16_f32 v156, v164, v165
    v_lshlrev_b32 v166, 16, v140
    v_and_b32 v167, 0xffff0000, v140
    v_add_f32 v160, v160, v164
    v_add_f32 v160, v160, v165
    v_fmac_f32 v161, v164, v164
    v_fmac_f32 v161, v165, v165
    v_fmac_f32 v162, v164, v166
    v_fmac_f32 v162, v165, v167
    v_lshlrev_b32 v164, 16, v157
    v_and_b32 v165, 0xffff0000, v157
    v_lshlrev_b32 v166, 16, v125
    v_and_b32 v167, 0xffff0000, v125
    v_add_f32 v164, v164, v166
    v_add_f32 v165, v165, v167
    v_cvt_pk_bf16_f32 v168, v164, v165
    v_lshlrev_b32 v164, 16, v168
    v_and_b32 v165, 0xffff0000, v168
    v_cvt_pk_bf16_f32 v157, v164, v165
    v_lshlrev_b32 v166, 16, v141
    v_and_b32 v167, 0xffff0000, v141
    v_add_f32 v160, v160, v164
    v_add_f32 v160, v160, v165
    v_fmac_f32 v161, v164, v164
    v_fmac_f32 v161, v165, v165
    v_fmac_f32 v162, v164, v166
    v_fmac_f32 v162, v165, v167
    v_lshlrev_b32 v164, 16, v158
    v_and_b32 v165, 0xffff0000, v158
    v_lshlrev_b32 v166, 16, v126
    v_and_b32 v167, 0xffff0000, v126
    v_add_f32 v164, v164, v166
    v_add_f32 v165, v165, v167
    v_cvt_pk_bf16_f32 v168, v164, v165
    v_lshlrev_b32 v164, 16, v168
    v_and_b32 v165, 0xffff0000, v168
    v_cvt_pk_bf16_f32 v158, v164, v165
    v_lshlrev_b32 v166, 16, v142
    v_and_b32 v167, 0xffff0000, v142
    v_add_f32 v160, v160, v164
    v_add_f32 v160, v160, v165
    v_fmac_f32 v161, v164, v164
    v_fmac_f32 v161, v165, v165
    v_fmac_f32 v162, v164, v166
    v_fmac_f32 v162, v165, v167
    v_lshlrev_b32 v164, 16, v159
    v_and_b32 v165, 0xffff0000, v159
    v_lshlrev_b32 v166, 16, v127
    v_and_b32 v167, 0xffff0000, v127
    v_add_f32 v164, v164, v166
    v_add_f32 v165, v165, v167
    v_cvt_pk_bf16_f32 v168, v164, v165
    v_lshlrev_b32 v164, 16, v168
    v_and_b32 v165, 0xffff0000, v168
    v_cvt_pk_bf16_f32 v159, v164, v165
    v_lshlrev_b32 v166, 16, v143
    v_and_b32 v167, 0xffff0000, v143
    v_add_f32 v160, v160, v164
    v_add_f32 v160, v160, v165
    v_fmac_f32 v161, v164, v164
    v_fmac_f32 v161, v165, v165
    v_fmac_f32 v162, v164, v166
    v_fmac_f32 v162, v165, v167
    buffer_store_dwordx4 v[156:159], v96, s[16:19], s28 offen offset:96
    v_mov_b32 v164, v160
    v_mov_b32 v165, v160
    s_nop 1
    v_permlane32_swap_b32 v164, v165
    v_add_f32 v160, v164, v165
    v_mov_b32 v164, v161
    v_mov_b32 v165, v161
    s_nop 1
    v_permlane32_swap_b32 v164, v165
    v_add_f32 v161, v164, v165
    v_mov_b32 v164, v162
    v_mov_b32 v165, v162
    s_nop 1
    v_permlane32_swap_b32 v164, v165
    v_add_f32 v162, v164, v165
    v_and_b32 v96, 31, v2
    v_lshlrev_b32 v96, 2, v96
    s_lshl_b32 s27, s20, 9
    s_lshl_b32 s28, s3, 7
    s_add_u32 s27, s27, s28
    s_add_u32 s27, s27, 24117248
    s_mov_b64 exec, 0xffffffff
    buffer_atomic_add_f32 v160, v96, s[16:19], s27 offen
    s_add_u32 s27, s27, 8192
    buffer_atomic_add_f32 v161, v96, s[16:19], s27 offen
    s_add_u32 s27, s27, 8192
    buffer_atomic_add_f32 v162, v96, s[16:19], s27 offen
    s_endpgm
L_end_k2a_kernel:
    s_endpgm
.text
.globl k3a_kernel
.p2align 8
.type k3a_kernel,@function
k3a_kernel:
    s_cmp_ge_u32 s2, 224
    s_cbranch_scc1 L_end_k3a_kernel
    s_load_dwordx2 s[4:5], s[0:1], 80
    s_load_dwordx2 s[6:7], s[0:1], 40
    s_load_dwordx2 s[28:29], s[0:1], 48
    v_lshrrev_b32 v1, 6, v0
    v_and_b32 v2, 63, v0
    s_nop 0
    v_readfirstlane_b32 s3, v1
    s_mul_hi_u32 s20, s2, 0x924924a
    s_mul_i32 s21, s20, 28
    s_sub_u32 s21, s2, s21
    s_waitcnt lgkmcnt(0)
    s_mov_b32 s16, s4
    s_mov_b32 s17, s5
    s_mov_b32 s18, 29360128
    s_mov_b32 s19, 0x00020000
    s_mov_b32 s8, s6
    s_mov_b32 s9, s7
    s_mov_b32 s10, 7340032
    s_mov_b32 s11, 0x00020000
    s_mov_b32 s12, s28
    s_mov_b32 s13, s29
    s_mov_b32 s14, 7340032
    s_mov_b32 s15, 0x00020000
    v_lshlrev_b32 v4, 2, v0
    s_mov_b32 s22, 24117248
    buffer_load_dword v32, v4, s[16:19], s22 offen
    s_mov_b32 s22, 24118272
    buffer_load_dword v33, v4, s[16:19], s22 offen
    s_mov_b32 s22, 24119296
    buffer_load_dword v34, v4, s[16:19], s22 offen
    s_mov_b32 s22, 24120320
    buffer_load_dword v35, v4, s[16:19], s22 offen
    s_mov_b32 s22, 24121344
    buffer_load_dword v36, v4, s[16:19], s22 offen
    s_mov_b32 s22, 24122368
    buffer_load_dword v37, v4, s[16:19], s22 offen
    s_mov_b32 s22, 24123392
    buffer_load_dword v38, v4, s[16:19], s22 offen
    s_mov_b32 s22, 24124416
    buffer_load_dword v39, v4, s[16:19], s22 offen
    s_mov_b32 s22, 24125440
    buffer_load_dword v40, v4, s[16:19], s22 offen
    s_mov_b32 s22, 24126464
    buffer_load_dword v41, v4, s[16:19], s22 offen
    s_mov_b32 s22, 24127488
    buffer_load_dword v42, v4, s[16:19], s22 offen
    s_mov_b32 s22, 24128512
    buffer_load_dword v43, v4, s[16:19], s22 offen
    s_mov_b32 s22, 24129536
    buffer_load_dword v44, v4, s[16:19], s22 offen
    s_mov_b32 s22, 24130560
    buffer_load_dword v45, v4, s[16:19], s22 offen
    s_mov_b32 s22, 24131584
    buffer_load_dword v46, v4, s[16:19], s22 offen
    s_mov_b32 s22, 24132608
    buffer_load_dword v47, v4, s[16:19], s22 offen
    s_mov_b32 s22, 24133632
    buffer_load_dword v48, v4, s[16:19], s22 offen
    s_mov_b32 s22, 24134656
    buffer_load_dword v49, v4, s[16:19], s22 offen
    s_mov_b32 s22, 24135680
    buffer_load_dword v50, v4, s[16:19], s22 offen
    s_mov_b32 s22, 24136704
    buffer_load_dword v51, v4, s[16:19], s22 offen
    s_mov_b32 s22, 24137728
    buffer_load_dword v52, v4, s[16:19], s22 offen
    s_mov_b32 s22, 24138752
    buffer_load_dword v53, v4, s[16:19], s22 offen
    s_mov_b32 s22, 24139776
    buffer_load_dword v54, v4, s[16:19], s22 offen
    s_mov_b32 s22, 24140800
    buffer_load_dword v55, v4, s[16:19], s22 offen
    v_mov_b32 v5, 0
    s_mov_b32 s22, 24182784
    buffer_load_dword v56, v5, s[16:19], s22 offen
    v_lshrrev_b32 v6, 4, v2
    v_lshlrev_b32 v7, 2, v6
    v_and_b32 v8, 15, v2
    v_xor_b32 v7, v7, v8
    v_lshlrev_b32 v7, 4, v7
    s_mov_b32 s22, 7168
    v_mul_lo_u32 v6, v6, s22
    v_add_u32 v6, v6, v7
    s_mul_i32 s22, s20, 917504
    s_lshl_b32 s23, s21, 8
    s_add_u32 s22, s22, s23
    s_mul_i32 s23, s3, 229376
    s_add_u32 s22, s22, s23
    s_lshl_b32 s23, s3, 13
    s_add_u32 s24, s23, 0
    s_mov_b32 m0, s24
    s_add_u32 s25, s22, 0
    buffer_load_dwordx4 v6, s[8:11], s25 offen lds
    s_add_u32 s24, s23, 1024
    s_mov_b32 m0, s24
    s_add_u32 s25, s22, 28672
    buffer_load_dwordx4 v6, s[8:11], s25 offen lds
    s_add_u32 s24, s23, 2048
    s_mov_b32 m0, s24
    s_add_u32 s25, s22, 57344
    buffer_load_dwordx4 v6, s[8:11], s25 offen lds
    s_add_u32 s24, s23, 3072
    s_mov_b32 m0, s24
    s_add_u32 s25, s22, 86016
    buffer_load_dwordx4 v6, s[8:11], s25 offen lds
    s_add_u32 s24, s23, 4096
    s_mov_b32 m0, s24
    s_add_u32 s25, s22, 114688
    buffer_load_dwordx4 v6, s[8:11], s25 offen lds
    s_add_u32 s24, s23, 5120
    s_mov_b32 m0, s24
    s_add_u32 s25, s22, 143360
    buffer_load_dwordx4 v6, s[8:11], s25 offen lds
    s_add_u32 s24, s23, 6144
    s_mov_b32 m0, s24
    s_add_u32 s25, s22, 172032
    buffer_load_dwordx4 v6, s[8:11], s25 offen lds
    s_add_u32 s24, s23, 7168
    s_mov_b32 m0, s24
    s_add_u32 s25, s22, 200704
    buffer_load_dwordx4 v6, s[8:11], s25 offen lds
    s_add_u32 s24, s23, 32768
    s_mov_b32 m0, s24
    s_add_u32 s25, s22, 0
    buffer_load_dwordx4 v6, s[12:15], s25 offen lds
    s_add_u32 s24, s23, 33792
    s_mov_b32 m0, s24
    s_add_u32 s25, s22, 28672
    buffer_load_dwordx4 v6, s[12:15], s25 offen lds
    s_add_u32 s24, s23, 34816
    s_mov_b32 m0, s24
    s_add_u32 s25, s22, 57344
    buffer_load_dwordx4 v6, s[12:15], s25 offen lds
    s_add_u32 s24, s23, 35840
    s_mov_b32 m0, s24
    s_add_u32 s25, s22, 86016
    buffer_load_dwordx4 v6, s[12:15], s25 offen lds
    s_add_u32 s24, s23, 36864
    s_mov_b32 m0, s24
    s_add_u32 s25, s22, 114688
    buffer_load_dwordx4 v6, s[12:15], s25 offen lds
    s_add_u32 s24, s23, 37888
    s_mov_b32 m0, s24
    s_add_u32 s25, s22, 143360
    buffer_load_dwordx4 v6, s[12:15], s25 offen lds
    s_add_u32 s24, s23, 38912
    s_mov_b32 m0, s24
    s_add_u32 s25, s22, 172032
    buffer_load_dwordx4 v6, s[12:15], s25 offen lds
    s_add_u32 s24, s23, 39936
    s_mov_b32 m0, s24
    s_add_u32 s25, s22, 200704
    buffer_load_dwordx4 v6, s[12:15], s25 offen lds
    s_waitcnt vmcnt(16)
    v_mul_f32 v32, 0x3a800000, v32
    v_mul_f32 v40, 0x3a800000, v40
    v_fma_f32 v40, -v32, v32, v40
    v_max_f32 v40, 0, v40
    v_cvt_pk_bf16_f32 v60, v32, v32
    v_lshlrev_b32 v32, 16, v60
    v_cvt_pk_bf16_f32 v60, v40, v40
    v_lshlrev_b32 v40, 16, v60
    v_add_f32 v40, 0x3727c5ac, v40
    v_cvt_pk_bf16_f32 v60, v40, v40
    v_lshlrev_b32 v40, 16, v60
    v_sqrt_f32 v40, v40
    s_nop 0
    v_cvt_pk_bf16_f32 v60, v40, v40
    v_lshlrev_b32 v40, 16, v60
    v_rcp_f32 v40, v40
    v_fma_f32 v48, -v32, v56, v48
    v_mul_f32 v48, v48, v40
    v_cvt_pk_bf16_f32 v60, v48, v48
    v_lshlrev_b32 v48, 16, v60
    v_not_b32 v60, v48
    v_or_b32 v61, 0x80000000, v48
    v_cmp_gt_i32 vcc, 0, v48
    s_nop 1
    v_cndmask_b32 v60, v61, v60, vcc
    v_and_b32 v60, 0xffff0000, v60
    v_sub_u32 v61, 65535, v0
    v_or_b32 v32, v60, v61
    v_mul_f32 v33, 0x3a800000, v33
    v_mul_f32 v41, 0x3a800000, v41
    v_fma_f32 v41, -v33, v33, v41
    v_max_f32 v41, 0, v41
    v_cvt_pk_bf16_f32 v60, v33, v33
    v_lshlrev_b32 v33, 16, v60
    v_cvt_pk_bf16_f32 v60, v41, v41
    v_lshlrev_b32 v41, 16, v60
    v_add_f32 v41, 0x3727c5ac, v41
    v_cvt_pk_bf16_f32 v60, v41, v41
    v_lshlrev_b32 v41, 16, v60
    v_sqrt_f32 v41, v41
    s_nop 0
    v_cvt_pk_bf16_f32 v60, v41, v41
    v_lshlrev_b32 v41, 16, v60
    v_rcp_f32 v41, v41
    v_fma_f32 v49, -v33, v56, v49
    v_mul_f32 v49, v49, v41
    v_cvt_pk_bf16_f32 v60, v49, v49
    v_lshlrev_b32 v49, 16, v60
    v_not_b32 v60, v49
    v_or_b32 v61, 0x80000000, v49
    v_cmp_gt_i32 vcc, 0, v49
    s_nop 1
    v_cndmask_b32 v60, v61, v60, vcc
    v_and_b32 v60, 0xffff0000, v60
    v_sub_u32 v61, 65279, v0
    v_or_b32 v33, v60, v61
    v_mul_f32 v34, 0x3a800000, v34
    v_mul_f32 v42, 0x3a800000, v42
    v_fma_f32 v42, -v34, v34, v42
    v_max_f32 v42, 0, v42
    v_cvt_pk_bf16_f32 v60, v34, v34
    v_lshlrev_b32 v34, 16, v60
    v_cvt_pk_bf16_f32 v60, v42, v42
    v_lshlrev_b32 v42, 16, v60
    v_add_f32 v42, 0x3727c5ac, v42
    v_cvt_pk_bf16_f32 v60, v42, v42
    v_lshlrev_b32 v42, 16, v60
    v_sqrt_f32 v42, v42
    s_nop 0
    v_cvt_pk_bf16_f32 v60, v42, v42
    v_lshlrev_b32 v42, 16, v60
    v_rcp_f32 v42, v42
    v_fma_f32 v50, -v34, v56, v50
    v_mul_f32 v50, v50, v42
    v_cvt_pk_bf16_f32 v60, v50, v50
    v_lshlrev_b32 v50, 16, v60
    v_not_b32 v60, v50
    v_or_b32 v61, 0x80000000, v50
    v_cmp_gt_i32 vcc, 0, v50
    s_nop 1
    v_cndmask_b32 v60, v61, v60, vcc
    v_and_b32 v60, 0xffff0000, v60
    v_sub_u32 v61, 65023, v0
    v_or_b32 v34, v60, v61
    v_mul_f32 v35, 0x3a800000, v35
    v_mul_f32 v43, 0x3a800000, v43
    v_fma_f32 v43, -v35, v35, v43
    v_max_f32 v43, 0, v43
    v_cvt_pk_bf16_f32 v60, v35, v35
    v_lshlrev_b32 v35, 16, v60
    v_cvt_pk_bf16_f32 v60, v43, v43
    v_lshlrev_b32 v43, 16, v60
    v_add_f32 v43, 0x3727c5ac, v43
    v_cvt_pk_bf16_f32 v60, v43, v43
    v_lshlrev_b32 v43, 16, v60
    v_sqrt_f32 v43, v43
    s_nop 0
    v_cvt_pk_bf16_f32 v60, v43, v43
    v_lshlrev_b32 v43, 16, v60
    v_rcp_f32 v43, v43
    v_fma_f32 v51, -v35, v56, v51
    v_mul_f32 v51, v51, v43
    v_cvt_pk_bf16_f32 v60, v51, v51
    v_lshlrev_b32 v51, 16, v60
    v_not_b32 v60, v51
    v_or_b32 v61, 0x80000000, v51
    v_cmp_gt_i32 vcc, 0, v51
    s_nop 1
    v_cndmask_b32 v60, v61, v60, vcc
    v_and_b32 v60, 0xffff0000, v60
    v_sub_u32 v61, 64767, v0
    v_or_b32 v35, v60, v61
    v_mul_f32 v36, 0x3a800000, v36
    v_mul_f32 v44, 0x3a800000, v44
    v_fma_f32 v44, -v36, v36, v44
    v_max_f32 v44, 0, v44
    v_cvt_pk_bf16_f32 v60, v36, v36
    v_lshlrev_b32 v36, 16, v60
    v_cvt_pk_bf16_f32 v60, v44, v44
    v_lshlrev_b32 v44, 16, v60
    v_add_f32 v44, 0x3727c5ac, v44
    v_cvt_pk_bf16_f32 v60, v44, v44
    v_lshlrev_b32 v44, 16, v60
    v_sqrt_f32 v44, v44
    s_nop 0
    v_cvt_pk_bf16_f32 v60, v44, v44
    v_lshlrev_b32 v44, 16, v60
    v_rcp_f32 v44, v44
    v_fma_f32 v52, -v36, v56, v52
    v_mul_f32 v52, v52, v44
    v_cvt_pk_bf16_f32 v60, v52, v52
    v_lshlrev_b32 v52, 16, v60
    v_not_b32 v60, v52
    v_or_b32 v61, 0x80000000, v52
    v_cmp_gt_i32 vcc, 0, v52
    s_nop 1
    v_cndmask_b32 v60, v61, v60, vcc
    v_and_b32 v60, 0xffff0000, v60
    v_sub_u32 v61, 64511, v0
    v_or_b32 v36, v60, v61
    v_mul_f32 v37, 0x3a800000, v37
    v_mul_f32 v45, 0x3a800000, v45
    v_fma_f32 v45, -v37, v37, v45
    v_max_f32 v45, 0, v45
    v_cvt_pk_bf16_f32 v60, v37, v37
    v_lshlrev_b32 v37, 16, v60
    v_cvt_pk_bf16_f32 v60, v45, v45
    v_lshlrev_b32 v45, 16, v60
    v_add_f32 v45, 0x3727c5ac, v45
    v_cvt_pk_bf16_f32 v60, v45, v45
    v_lshlrev_b32 v45, 16, v60
    v_sqrt_f32 v45, v45
    s_nop 0
    v_cvt_pk_bf16_f32 v60, v45, v45
    v_lshlrev_b32 v45, 16, v60
    v_rcp_f32 v45, v45
    v_fma_f32 v53, -v37, v56, v53
    v_mul_f32 v53, v53, v45
    v_cvt_pk_bf16_f32 v60, v53, v53
    v_lshlrev_b32 v53, 16, v60
    v_not_b32 v60, v53
    v_or_b32 v61, 0x80000000, v53
    v_cmp_gt_i32 vcc, 0, v53
    s_nop 1
    v_cndmask_b32 v60, v61, v60, vcc
    v_and_b32 v60, 0xffff0000, v60
    v_sub_u32 v61, 64255, v0
    v_or_b32 v37, v60, v61
    v_mul_f32 v38, 0x3a800000, v38
    v_mul_f32 v46, 0x3a800000, v46
    v_fma_f32 v46, -v38, v38, v46
    v_max_f32 v46, 0, v46
    v_cvt_pk_bf16_f32 v60, v38, v38
    v_lshlrev_b32 v38, 16, v60
    v_cvt_pk_bf16_f32 v60, v46, v46
    v_lshlrev_b32 v46, 16, v60
    v_add_f32 v46, 0x3727c5ac, v46
    v_cvt_pk_bf16_f32 v60, v46, v46
    v_lshlrev_b32 v46, 16, v60
    v_sqrt_f32 v46, v46
    s_nop 0
    v_cvt_pk_bf16_f32 v60, v46, v46
    v_lshlrev_b32 v46, 16, v60
    v_rcp_f32 v46, v46
    v_fma_f32 v54, -v38, v56, v54
    v_mul_f32 v54, v54, v46
    v_cvt_pk_bf16_f32 v60, v54, v54
    v_lshlrev_b32 v54, 16, v60
    v_not_b32 v60, v54
    v_or_b32 v61, 0x80000000, v54
    v_cmp_gt_i32 vcc, 0, v54
    s_nop 1
    v_cndmask_b32 v60, v61, v60, vcc
    v_and_b32 v60, 0xffff0000, v60
    v_sub_u32 v61, 63999, v0
    v_or_b32 v38, v60, v61
    v_mul_f32 v39, 0x3a800000, v39
    v_mul_f32 v47, 0x3a800000, v47
    v_fma_f32 v47, -v39, v39, v47
    v_max_f32 v47, 0, v47
    v_cvt_pk_bf16_f32 v60, v39, v39
    v_lshlrev_b32 v39, 16, v60
    v_cvt_pk_bf16_f32 v60, v47, v47
    v_lshlrev_b32 v47, 16, v60
    v_add_f32 v47, 0x3727c5ac, v47
    v_cvt_pk_bf16_f32 v60, v47, v47
    v_lshlrev_b32 v47, 16, v60
    v_sqrt_f32 v47, v47
    s_nop 0
    v_cvt_pk_bf16_f32 v60, v47, v47
    v_lshlrev_b32 v47, 16, v60
    v_rcp_f32 v47, v47
    v_fma_f32 v55, -v39, v56, v55
    v_mul_f32 v55, v55, v47
    v_cvt_pk_bf16_f32 v60, v55, v55
    v_lshlrev_b32 v55, 16, v60
    v_not_b32 v60, v55
    v_or_b32 v61, 0x80000000, v55
    v_cmp_gt_i32 vcc, 0, v55
    s_nop 1
    v_cndmask_b32 v60, v61, v60, vcc
    v_and_b32 v60, 0xffff0000, v60
    v_sub_u32 v61, 63743, v0
    v_or_b32 v39, v60, v61
    v_max_u32 v60, v32, v33
    v_max_u32 v60, v60, v34
    v_max_u32 v60, v60, v35
    v_max_u32 v60, v60, v36
    v_max_u32 v60, v60, v37
    v_max_u32 v60, v60, v38
    v_max_u32 v60, v60, v39
    s_nop 1
    v_max_u32_dpp v60, v60, v60 quad_perm:[1,0,3,2] row_mask:0xf bank_mask:0xf
    s_nop 1
    v_max_u32_dpp v60, v60, v60 quad_perm:[2,3,0,1] row_mask:0xf bank_mask:0xf
    s_nop 1
    v_max_u32_dpp v60, v60, v60 row_half_mirror row_mask:0xf bank_mask:0xf
    s_nop 1
    v_max_u32_dpp v60, v60, v60 row_mirror row_mask:0xf bank_mask:0xf
    s_nop 1
    v_readlane_b32 s70, v60, 0
    v_readlane_b32 s71, v60, 16
    v_readlane_b32 s72, v60, 32
    v_readlane_b32 s73, v60, 48
    s_nop 3
    s_max_u32 s70, s70, s71
    s_max_u32 s72, s72, s73
    s_max_u32 s70, s70, s72
    s_mov_b32 s60, s70
    v_cmp_eq_u32 vcc, s70, v32
    s_nop 1
    v_cndmask_b32 v32, v32, 0, vcc
    v_cmp_eq_u32 vcc, s70, v33
    s_nop 1
    v_cndmask_b32 v33, v33, 0, vcc
    v_cmp_eq_u32 vcc, s70, v34
    s_nop 1
    v_cndmask_b32 v34, v34, 0, vcc
    v_cmp_eq_u32 vcc, s70, v35
    s_nop 1
    v_cndmask_b32 v35, v35, 0, vcc
    v_cmp_eq_u32 vcc, s70, v36
    s_nop 1
    v_cndmask_b32 v36, v36, 0, vcc
    v_cmp_eq_u32 vcc, s70, v37
    s_nop 1
    v_cndmask_b32 v37, v37, 0, vcc
    v_cmp_eq_u32 vcc, s70, v38
    s_nop 1
    v_cndmask_b32 v38, v38, 0, vcc
    v_cmp_eq_u32 vcc, s70, v39
    s_nop 1
    v_cndmask_b32 v39, v39, 0, vcc
    v_max_u32 v60, v32, v33
    v_max_u32 v60, v60, v34
    v_max_u32 v60, v60, v35
    v_max_u32 v60, v60, v36
    v_max_u32 v60, v60, v37
    v_max_u32 v60, v60, v38
    v_max_u32 v60, v60, v39
    s_nop 1
    v_max_u32_dpp v60, v60, v60 quad_perm:[1,0,3,2] row_mask:0xf bank_mask:0xf
    s_nop 1
    v_max_u32_dpp v60, v60, v60 quad_perm:[2,3,0,1] row_mask:0xf bank_mask:0xf
    s_nop 1
    v_max_u32_dpp v60, v60, v60 row_half_mirror row_mask:0xf bank_mask:0xf
    s_nop 1
    v_max_u32_dpp v60, v60, v60 row_mirror row_mask:0xf bank_mask:0xf
    s_nop 1
    v_readlane_b32 s70, v60, 0
    v_readlane_b32 s71, v60, 16
    v_readlane_b32 s72, v60, 32
    v_readlane_b32 s73, v60, 48
    s_nop 3
    s_max_u32 s70, s70, s71
    s_max_u32 s72, s72, s73
    s_max_u32 s70, s70, s72
    s_mov_b32 s61, s70
    v_cmp_eq_u32 vcc, s70, v32
    s_nop 1
    v_cndmask_b32 v32, v32, 0, vcc
    v_cmp_eq_u32 vcc, s70, v33
    s_nop 1
    v_cndmask_b32 v33, v33, 0, vcc
    v_cmp_eq_u32 vcc, s70, v34
    s_nop 1
    v_cndmask_b32 v34, v34, 0, vcc
    v_cmp_eq_u32 vcc, s70, v35
    s_nop 1
    v_cndmask_b32 v35, v35, 0, vcc
    v_cmp_eq_u32 vcc, s70, v36
    s_nop 1
    v_cndmask_b32 v36, v36, 0, vcc
    v_cmp_eq_u32 vcc, s70, v37
    s_nop 1
    v_cndmask_b32 v37, v37, 0, vcc
    v_cmp_eq_u32 vcc, s70, v38
    s_nop 1
    v_cndmask_b32 v38, v38, 0, vcc
    v_cmp_eq_u32 vcc, s70, v39
    s_nop 1
    v_cndmask_b32 v39, v39, 0, vcc
    v_max_u32 v60, v32, v33
    v_max_u32 v60, v60, v34
    v_max_u32 v60, v60, v35
    v_max_u32 v60, v60, v36
    v_max_u32 v60, v60, v37
    v_max_u32 v60, v60, v38
    v_max_u32 v60, v60, v39
    s_nop 1
    v_max_u32_dpp v60, v60, v60 quad_perm:[1,0,3,2] row_mask:0xf bank_mask:0xf
    s_nop 1
    v_max_u32_dpp v60, v60, v60 quad_perm:[2,3,0,1] row_mask:0xf bank_mask:0xf
    s_nop 1
    v_max_u32_dpp v60, v60, v60 row_half_mirror row_mask:0xf bank_mask:0xf
    s_nop 1
    v_max_u32_dpp v60, v60, v60 row_mirror row_mask:0xf bank_mask:0xf
    s_nop 1
    v_readlane_b32 s70, v60, 0
    v_readlane_b32 s71, v60, 16
    v_readlane_b32 s72, v60, 32
    v_readlane_b32 s73, v60, 48
    s_nop 3
    s_max_u32 s70, s70, s71
    s_max_u32 s72, s72, s73
    s_max_u32 s70, s70, s72
    s_mov_b32 s62, s70
    v_cmp_eq_u32 vcc, s70, v32
    s_nop 1
    v_cndmask_b32 v32, v32, 0, vcc
    v_cmp_eq_u32 vcc, s70, v33
    s_nop 1
    v_cndmask_b32 v33, v33, 0, vcc
    v_cmp_eq_u32 vcc, s70, v34
    s_nop 1
    v_cndmask_b32 v34, v34, 0, vcc
    v_cmp_eq_u32 vcc, s70, v35
    s_nop 1
    v_cndmask_b32 v35, v35, 0, vcc
    v_cmp_eq_u32 vcc, s70, v36
    s_nop 1
    v_cndmask_b32 v36, v36, 0, vcc
    v_cmp_eq_u32 vcc, s70, v37
    s_nop 1
    v_cndmask_b32 v37, v37, 0, vcc
    v_cmp_eq_u32 vcc, s70, v38
    s_nop 1
    v_cndmask_b32 v38, v38, 0, vcc
    v_cmp_eq_u32 vcc, s70, v39
    s_nop 1
    v_cndmask_b32 v39, v39, 0, vcc
    v_max_u32 v60, v32, v33
    v_max_u32 v60, v60, v34
    v_max_u32 v60, v60, v35
    v_max_u32 v60, v60, v36
    v_max_u32 v60, v60, v37
    v_max_u32 v60, v60, v38
    v_max_u32 v60, v60, v39
    s_nop 1
    v_max_u32_dpp v60, v60, v60 quad_perm:[1,0,3,2] row_mask:0xf bank_mask:0xf
    s_nop 1
    v_max_u32_dpp v60, v60, v60 quad_perm:[2,3,0,1] row_mask:0xf bank_mask:0xf
    s_nop 1
    v_max_u32_dpp v60, v60, v60 row_half_mirror row_mask:0xf bank_mask:0xf
    s_nop 1
    v_max_u32_dpp v60, v60, v60 row_mirror row_mask:0xf bank_mask:0xf
    s_nop 1
    v_readlane_b32 s70, v60, 0
    v_readlane_b32 s71, v60, 16
    v_readlane_b32 s72, v60, 32
    v_readlane_b32 s73, v60, 48
    s_nop 3
    s_max_u32 s70, s70, s71
    s_max_u32 s72, s72, s73
    s_max_u32 s70, s70, s72
    s_mov_b32 s63, s70
    v_cmp_eq_u32 vcc, s70, v32
    s_nop 1
    v_cndmask_b32 v32, v32, 0, vcc
    v_cmp_eq_u32 vcc, s70, v33
    s_nop 1
    v_cndmask_b32 v33, v33, 0, vcc
    v_cmp_eq_u32 vcc, s70, v34
    s_nop 1
    v_cndmask_b32 v34, v34, 0, vcc
    v_cmp_eq_u32 vcc, s70, v35
    s_nop 1
    v_cndmask_b32 v35, v35, 0, vcc
    v_cmp_eq_u32 vcc, s70, v36
    s_nop 1
    v_cndmask_b32 v36, v36, 0, vcc
    v_cmp_eq_u32 vcc, s70, v37
    s_nop 1
    v_cndmask_b32 v37, v37, 0, vcc
    v_cmp_eq_u32 vcc, s70, v38
    s_nop 1
    v_cndmask_b32 v38, v38, 0, vcc
    v_cmp_eq_u32 vcc, s70, v39
    s_nop 1
    v_cndmask_b32 v39, v39, 0, vcc
    v_max_u32 v60, v32, v33
    v_max_u32 v60, v60, v34
    v_max_u32 v60, v60, v35
    v_max_u32 v60, v60, v36
    v_max_u32 v60, v60, v37
    v_max_u32 v60, v60, v38
    v_max_u32 v60, v60, v39
    s_nop 1
    v_max_u32_dpp v60, v60, v60 quad_perm:[1,0,3,2] row_mask:0xf bank_mask:0xf
    s_nop 1
    v_max_u32_dpp v60, v60, v60 quad_perm:[2,3,0,1] row_mask:0xf bank_mask:0xf
    s_nop 1
    v_max_u32_dpp v60, v60, v60 row_half_mirror row_mask:0xf bank_mask:0xf
    s_nop 1
    v_max_u32_dpp v60, v60, v60 row_mirror row_mask:0xf bank_mask:0xf
    s_nop 1
    v_readlane_b32 s70, v60, 0
    v_readlane_b32 s71, v60, 16
    v_readlane_b32 s72, v60, 32
    v_readlane_b32 s73, v60, 48
    s_nop 3
    s_max_u32 s70, s70, s71
    s_max_u32 s72, s72, s73
    s_max_u32 s70, s70, s72
    s_mov_b32 s64, s70
    v_cmp_eq_u32 vcc, s70, v32
    s_nop 1
    v_cndmask_b32 v32, v32, 0, vcc
    v_cmp_eq_u32 vcc, s70, v33
    s_nop 1
    v_cndmask_b32 v33, v33, 0, vcc
    v_cmp_eq_u32 vcc, s70, v34
    s_nop 1
    v_cndmask_b32 v34, v34, 0, vcc
    v_cmp_eq_u32 vcc, s70, v35
    s_nop 1
    v_cndmask_b32 v35, v35, 0, vcc
    v_cmp_eq_u32 vcc, s70, v36
    s_nop 1
    v_cndmask_b32 v36, v36, 0, vcc
    v_cmp_eq_u32 vcc, s70, v37
    s_nop 1
    v_cndmask_b32 v37, v37, 0, vcc
    v_cmp_eq_u32 vcc, s70, v38
    s_nop 1
    v_cndmask_b32 v38, v38, 0, vcc
    v_cmp_eq_u32 vcc, s70, v39
    s_nop 1
    v_cndmask_b32 v39, v39, 0, vcc
    v_max_u32 v60, v32, v33
    v_max_u32 v60, v60, v34
    v_max_u32 v60, v60, v35
    v_max_u32 v60, v60, v36
    v_max_u32 v60, v60, v37
    v_max_u32 v60, v60, v38
    v_max_u32 v60, v60, v39
    s_nop 1
    v_max_u32_dpp v60, v60, v60 quad_perm:[1,0,3,2] row_mask:0xf bank_mask:0xf
    s_nop 1
    v_max_u32_dpp v60, v60, v60 quad_perm:[2,3,0,1] row_mask:0xf bank_mask:0xf
    s_nop 1
    v_max_u32_dpp v60, v60, v60 row_half_mirror row_mask:0xf bank_mask:0xf
    s_nop 1
    v_max_u32_dpp v60, v60, v60 row_mirror row_mask:0xf bank_mask:0xf
    s_nop 1
    v_readlane_b32 s70, v60, 0
    v_readlane_b32 s71, v60, 16
    v_readlane_b32 s72, v60, 32
    v_readlane_b32 s73, v60, 48
    s_nop 3
    s_max_u32 s70, s70, s71
    s_max_u32 s72, s72, s73
    s_max_u32 s70, s70, s72
    s_mov_b32 s65, s70
    v_cmp_eq_u32 vcc, s70, v32
    s_nop 1
    v_cndmask_b32 v32, v32, 0, vcc
    v_cmp_eq_u32 vcc, s70, v33
    s_nop 1
    v_cndmask_b32 v33, v33, 0, vcc
    v_cmp_eq_u32 vcc, s70, v34
    s_nop 1
    v_cndmask_b32 v34, v34, 0, vcc
    v_cmp_eq_u32 vcc, s70, v35
    s_nop 1
    v_cndmask_b32 v35, v35, 0, vcc
    v_cmp_eq_u32 vcc, s70, v36
    s_nop 1
    v_cndmask_b32 v36, v36, 0, vcc
    v_cmp_eq_u32 vcc, s70, v37
    s_nop 1
    v_cndmask_b32 v37, v37, 0, vcc
    v_cmp_eq_u32 vcc, s70, v38
    s_nop 1
    v_cndmask_b32 v38, v38, 0, vcc
    v_cmp_eq_u32 vcc, s70, v39
    s_nop 1
    v_cndmask_b32 v39, v39, 0, vcc
    v_max_u32 v60, v32, v33
    v_max_u32 v60, v60, v34
    v_max_u32 v60, v60, v35
    v_max_u32 v60, v60, v36
    v_max_u32 v60, v60, v37
    v_max_u32 v60, v60, v38
    v_max_u32 v60, v60, v39
    s_nop 1
    v_max_u32_dpp v60, v60, v60 quad_perm:[1,0,3,2] row_mask:0xf bank_mask:0xf
    s_nop 1
    v_max_u32_dpp v60, v60, v60 quad_perm:[2,3,0,1] row_mask:0xf bank_mask:0xf
    s_nop 1
    v_max_u32_dpp v60, v60, v60 row_half_mirror row_mask:0xf bank_mask:0xf
    s_nop 1
    v_max_u32_dpp v60, v60, v60 row_mirror row_mask:0xf bank_mask:0xf
    s_nop 1
    v_readlane_b32 s70, v60, 0
    v_readlane_b32 s71, v60, 16
    v_readlane_b32 s72, v60, 32
    v_readlane_b32 s73, v60, 48
    s_nop 3
    s_max_u32 s70, s70, s71
    s_max_u32 s72, s72, s73
    s_max_u32 s70, s70, s72
    s_mov_b32 s66, s70
    v_cmp_eq_u32 vcc, s70, v32
    s_nop 1
    v_cndmask_b32 v32, v32, 0, vcc
    v_cmp_eq_u32 vcc, s70, v33
    s_nop 1
    v_cndmask_b32 v33, v33, 0, vcc
    v_cmp_eq_u32 vcc, s70, v34
    s_nop 1
    v_cndmask_b32 v34, v34, 0, vcc
    v_cmp_eq_u32 vcc, s70, v35
    s_nop 1
    v_cndmask_b32 v35, v35, 0, vcc
    v_cmp_eq_u32 vcc, s70, v36
    s_nop 1
    v_cndmask_b32 v36, v36, 0, vcc
    v_cmp_eq_u32 vcc, s70, v37
    s_nop 1
    v_cndmask_b32 v37, v37, 0, vcc
    v_cmp_eq_u32 vcc, s70, v38
    s_nop 1
    v_cndmask_b32 v38, v38, 0, vcc
    v_cmp_eq_u32 vcc, s70, v39
    s_nop 1
    v_cndmask_b32 v39, v39, 0, vcc
    v_max_u32 v60, v32, v33
    v_max_u32 v60, v60, v34
    v_max_u32 v60, v60, v35
    v_max_u32 v60, v60, v36
    v_max_u32 v60, v60, v37
    v_max_u32 v60, v60, v38
    v_max_u32 v60, v60, v39
    s_nop 1
    v_max_u32_dpp v60, v60, v60 quad_perm:[1,0,3,2] row_mask:0xf bank_mask:0xf
    s_nop 1
    v_max_u32_dpp v60, v60, v60 quad_perm:[2,3,0,1] row_mask:0xf bank_mask:0xf
    s_nop 1
    v_max_u32_dpp v60, v60, v60 row_half_mirror row_mask:0xf bank_mask:0xf
    s_nop 1
    v_max_u32_dpp v60, v60, v60 row_mirror row_mask:0xf bank_mask:0xf
    s_nop 1
    v_readlane_b32 s70, v60, 0
    v_readlane_b32 s71, v60, 16
    v_readlane_b32 s72, v60, 32
    v_readlane_b32 s73, v60, 48
    s_nop 3
    s_max_u32 s70, s70, s71
    s_max_u32 s72, s72, s73
    s_max_u32 s70, s70, s72
    s_mov_b32 s67, s70
    v_cmp_eq_u32 vcc, s70, v32
    s_nop 1
    v_cndmask_b32 v32, v32, 0, vcc
    v_cmp_eq_u32 vcc, s70, v33
    s_nop 1
    v_cndmask_b32 v33, v33, 0, vcc
    v_cmp_eq_u32 vcc, s70, v34
    s_nop 1
    v_cndmask_b32 v34, v34, 0, vcc
    v_cmp_eq_u32 vcc, s70, v35
    s_nop 1
    v_cndmask_b32 v35, v35, 0, vcc
    v_cmp_eq_u32 vcc, s70, v36
    s_nop 1
    v_cndmask_b32 v36, v36, 0, vcc
    v_cmp_eq_u32 vcc, s70, v37
    s_nop 1
    v_cndmask_b32 v37, v37, 0, vcc
    v_cmp_eq_u32 vcc, s70, v38
    s_nop 1
    v_cndmask_b32 v38, v38, 0, vcc
    v_cmp_eq_u32 vcc, s70, v39
    s_nop 1
    v_cndmask_b32 v39, v39, 0, vcc
    v_mov_b32 v60, 0
    v_writelane_b32 v60, s60, 0
    v_writelane_b32 v60, s61, 1
    v_writelane_b32 v60, s62, 2
    v_writelane_b32 v60, s63, 3
    v_writelane_b32 v60, s64, 4
    v_writelane_b32 v60, s65, 5
    v_writelane_b32 v60, s66, 6
    v_writelane_b32 v60, s67, 7
    v_lshlrev_b32 v61, 2, v2
    s_lshl_b32 s24, s3, 5
    v_add_u32 v61, s24, v61
    v_add_u32 v61, 73728, v61
    s_mov_b64 exec, 0xff
    ds_write_b32 v61, v60
    s_mov_b64 exec, -1
    s_waitcnt lgkmcnt(0)
    s_barrier
    v_lshlrev_b32 v61, 2, v2
    v_and_b32 v61, 127, v61
    v_add_u32 v61, 73728, v61
    ds_read_b32 v62, v61
    s_waitcnt lgkmcnt(0)
    v_cmp_gt_u32 vcc, 32, v2
    s_nop 1
    v_cndmask_b32 v62, 0, v62, vcc
    v_mov_b32 v60, v62
    s_nop 1
    v_max_u32_dpp v60, v60, v60 quad_perm:[1,0,3,2] row_mask:0xf bank_mask:0xf
    s_nop 1
    v_max_u32_dpp v60, v60, v60 quad_perm:[2,3,0,1] row_mask:0xf bank_mask:0xf
    s_nop 1
    v_max_u32_dpp v60, v60, v60 row_half_mirror row_mask:0xf bank_mask:0xf
    s_nop 1
    v_max_u32_dpp v60, v60, v60 row_mirror row_mask:0xf bank_mask:0xf
    s_nop 1
    v_readlane_b32 s70, v60, 0
    v_readlane_b32 s71, v60, 16
    v_readlane_b32 s72, v60, 32
    v_readlane_b32 s73, v60, 48
    s_nop 3
    s_max_u32 s70, s70, s71
    s_max_u32 s72, s72, s73
    s_max_u32 s70, s70, s72
    s_mov_b32 s60, s70
    v_cmp_eq_u32 vcc, s70, v62
    s_nop 1
    v_cndmask_b32 v62, v62, 0, vcc
    v_mov_b32 v60, v62
    s_nop 1
    v_max_u32_dpp v60, v60, v60 quad_perm:[1,0,3,2] row_mask:0xf bank_mask:0xf
    s_nop 1
    v_max_u32_dpp v60, v60, v60 quad_perm:[2,3,0,1] row_mask:0xf bank_mask:0xf
    s_nop 1
    v_max_u32_dpp v60, v60, v60 row_half_mirror row_mask:0xf bank_mask:0xf
    s_nop 1
    v_max_u32_dpp v60, v60, v60 row_mirror row_mask:0xf bank_mask:0xf
    s_nop 1
    v_readlane_b32 s70, v60, 0
    v_readlane_b32 s71, v60, 16
    v_readlane_b32 s72, v60, 32
    v_readlane_b32 s73, v60, 48
    s_nop 3
    s_max_u32 s70, s70, s71
    s_max_u32 s72, s72, s73
    s_max_u32 s70, s70, s72
    s_mov_b32 s61, s70
    v_cmp_eq_u32 vcc, s70, v62
    s_nop 1
    v_cndmask_b32 v62, v62, 0, vcc
    v_mov_b32 v60, v62
    s_nop 1
    v_max_u32_dpp v60, v60, v60 quad_perm:[1,0,3,2] row_mask:0xf bank_mask:0xf
    s_nop 1
    v_max_u32_dpp v60, v60, v60 quad_perm:[2,3,0,1] row_mask:0xf bank_mask:0xf
    s_nop 1
    v_max_u32_dpp v60, v60, v60 row_half_mirror row_mask:0xf bank_mask:0xf
    s_nop 1
    v_max_u32_dpp v60, v60, v60 row_mirror row_mask:0xf bank_mask:0xf
    s_nop 1
    v_readlane_b32 s70, v60, 0
    v_readlane_b32 s71, v60, 16
    v_readlane_b32 s72, v60, 32
    v_readlane_b32 s73, v60, 48
    s_nop 3
    s_max_u32 s70, s70, s71
    s_max_u32 s72, s72, s73
    s_max_u32 s70, s70, s72
    s_mov_b32 s62, s70
    v_cmp_eq_u32 vcc, s70, v62
    s_nop 1
    v_cndmask_b32 v62, v62, 0, vcc
    v_mov_b32 v60, v62
    s_nop 1
    v_max_u32_dpp v60, v60, v60 quad_perm:[1,0,3,2] row_mask:0xf bank_mask:0xf
    s_nop 1
    v_max_u32_dpp v60, v60, v60 quad_perm:[2,3,0,1] row_mask:0xf bank_mask:0xf
    s_nop 1
    v_max_u32_dpp v60, v60, v60 row_half_mirror row_mask:0xf bank_mask:0xf
    s_nop 1
    v_max_u32_dpp v60, v60, v60 row_mirror row_mask:0xf bank_mask:0xf
    s_nop 1
    v_readlane_b32 s70, v60, 0
    v_readlane_b32 s71, v60, 16
    v_readlane_b32 s72, v60, 32
    v_readlane_b32 s73, v60, 48
    s_nop 3
    s_max_u32 s70, s70, s71
    s_max_u32 s72, s72, s73
    s_max_u32 s70, s70, s72
    s_mov_b32 s63, s70
    v_cmp_eq_u32 vcc, s70, v62
    s_nop 1
    v_cndmask_b32 v62, v62, 0, vcc
    v_mov_b32 v60, v62
    s_nop 1
    v_max_u32_dpp v60, v60, v60 quad_perm:[1,0,3,2] row_mask:0xf bank_mask:0xf
    s_nop 1
    v_max_u32_dpp v60, v60, v60 quad_perm:[2,3,0,1] row_mask:0xf bank_mask:0xf
    s_nop 1
    v_max_u32_dpp v60, v60, v60 row_half_mirror row_mask:0xf bank_mask:0xf
    s_nop 1
    v_max_u32_dpp v60, v60, v60 row_mirror row_mask:0xf bank_mask:0xf
    s_nop 1
    v_readlane_b32 s70, v60, 0
    v_readlane_b32 s71, v60, 16
    v_readlane_b32 s72, v60, 32
    v_readlane_b32 s73, v60, 48
    s_nop 3
    s_max_u32 s70, s70, s71
    s_max_u32 s72, s72, s73
    s_max_u32 s70, s70, s72
    s_mov_b32 s64, s70
    v_cmp_eq_u32 vcc, s70, v62
    s_nop 1
    v_cndmask_b32 v62, v62, 0, vcc
    v_mov_b32 v60, v62
    s_nop 1
    v_max_u32_dpp v60, v60, v60 quad_perm:[1,0,3,2] row_mask:0xf bank_mask:0xf
    s_nop 1
    v_max_u32_dpp v60, v60, v60 quad_perm:[2,3,0,1] row_mask:0xf bank_mask:0xf
    s_nop 1
    v_max_u32_dpp v60, v60, v60 row_half_mirror row_mask:0xf bank_mask:0xf
    s_nop 1
    v_max_u32_dpp v60, v60, v60 row_mirror row_mask:0xf bank_mask:0xf
    s_nop 1
    v_readlane_b32 s70, v60, 0
    v_readlane_b32 s71, v60, 16
    v_readlane_b32 s72, v60, 32
    v_readlane_b32 s73, v60, 48
    s_nop 3
    s_max_u32 s70, s70, s71
    s_max_u32 s72, s72, s73
    s_max_u32 s70, s70, s72
    s_mov_b32 s65, s70
    v_cmp_eq_u32 vcc, s70, v62
    s_nop 1
    v_cndmask_b32 v62, v62, 0, vcc
    v_mov_b32 v60, v62
    s_nop 1
    v_max_u32_dpp v60, v60, v60 quad_perm:[1,0,3,2] row_mask:0xf bank_mask:0xf
    s_nop 1
    v_max_u32_dpp v60, v60, v60 quad_perm:[2,3,0,1] row_mask:0xf bank_mask:0xf
    s_nop 1
    v_max_u32_dpp v60, v60, v60 row_half_mirror row_mask:0xf bank_mask:0xf
    s_nop 1
    v_max_u32_dpp v60, v60, v60 row_mirror row_mask:0xf bank_mask:0xf
    s_nop 1
    v_readlane_b32 s70, v60, 0
    v_readlane_b32 s71, v60, 16
    v_readlane_b32 s72, v60, 32
    v_readlane_b32 s73, v60, 48
    s_nop 3
    s_max_u32 s70, s70, s71
    s_max_u32 s72, s72, s73
    s_max_u32 s70, s70, s72
    s_mov_b32 s66, s70
    v_cmp_eq_u32 vcc, s70, v62
    s_nop 1
    v_cndmask_b32 v62, v62, 0, vcc
    v_mov_b32 v60, v62
    s_nop 1
    v_max_u32_dpp v60, v60, v60 quad_perm:[1,0,3,2] row_mask:0xf bank_mask:0xf
    s_nop 1
    v_max_u32_dpp v60, v60, v60 quad_perm:[2,3,0,1] row_mask:0xf bank_mask:0xf
    s_nop 1
    v_max_u32_dpp v60, v60, v60 row_half_mirror row_mask:0xf bank_mask:0xf
    s_nop 1
    v_max_u32_dpp v60, v60, v60 row_mirror row_mask:0xf bank_mask:0xf
    s_nop 1
    v_readlane_b32 s70, v60, 0
    v_readlane_b32 s71, v60, 16
    v_readlane_b32 s72, v60, 32
    v_readlane_b32 s73, v60, 48
    s_nop 3
    s_max_u32 s70, s70, s71
    s_max_u32 s72, s72, s73
    s_max_u32 s70, s70, s72
    s_mov_b32 s67, s70
    v_cmp_eq_u32 vcc, s70, v62
    s_nop 1
    v_cndmask_b32 v62, v62, 0, vcc
    s_and_b32 s72, s60, 0xffff
    s_sub_u32 s72, 0xffff, s72
    s_and_b32 s73, s61, 0xffff
    s_sub_u32 s73, 0xffff, s73
    s_and_b32 s74, s62, 0xffff
    s_sub_u32 s74, 0xffff, s74
    s_and_b32 s75, s63, 0xffff
    s_sub_u32 s75, 0xffff, s75
    s_and_b32 s76, s64, 0xffff
    s_sub_u32 s76, 0xffff, s76
    s_and_b32 s77, s65, 0xffff
    s_sub_u32 s77, 0xffff, s77
    s_and_b32 s78, s66, 0xffff
    s_sub_u32 s78, 0xffff, s78
    s_and_b32 s79, s67, 0xffff
    s_sub_u32 s79, 0xffff, s79
    s_cmp_lg_u32 s2, 0
    s_cbranch_scc1 L_nosel_k3a_kernel
    s_cmp_lg_u32 s3, 0
    s_cbranch_scc1 L_nosel_k3a_kernel
    v_mov_b32 v60, 0
    v_mov_b32 v61, 0
    v_writelane_b32 v60, s72, 0
    v_writelane_b32 v61, s60, 0
    v_writelane_b32 v60, s73, 1
    v_writelane_b32 v61, s61, 1
    v_writelane_b32 v60, s74, 2
    v_writelane_b32 v61, s62, 2
    v_writelane_b32 v60, s75, 3
    v_writelane_b32 v61, s63, 3
    v_writelane_b32 v60, s76, 4
    v_writelane_b32 v61, s64, 4
    v_writelane_b32 v60, s77, 5
    v_writelane_b32 v61, s65, 5
    v_writelane_b32 v60, s78, 6
    v_writelane_b32 v61, s66, 6
    v_writelane_b32 v60, s79, 7
    v_writelane_b32 v61, s67, 7
    v_and_b32 v61, 0xffff0000, v61
    v_xor_b32 v62, 0x80000000, v61
    v_not_b32 v63, v61
    v_and_b32 v63, 0xffff0000, v63
    v_cmp_gt_i32 vcc, 0, v61
    s_nop 1
    v_cndmask_b32 v61, v63, v62, vcc
    v_mul_f32 v61, 0xbfb8aa3b, v61
    v_exp_f32 v61, v61
    s_nop 0
    v_add_f32 v61, 1.0, v61
    v_rcp_f32 v61, v61
    s_nop 0
    v_cvt_pk_bf16_f32 v62, v61, v61
    v_lshlrev_b32 v61, 16, v62
    v_lshlrev_b32 v62, 2, v2
    s_mov_b64 exec, 0xff
    s_mov_b32 s24, 24183808
    buffer_store_dword v60, v62, s[16:19], s24 offen
    buffer_store_dword v61, v62, s[16:19], s24 offen offset:32
    s_mov_b64 exec, -1
L_nosel_k3a_kernel:
    s_mov_b32 s24, s72
    s_mov_b32 s25, s73
    s_cmp_eq_u32 s3, 1
    s_cselect_b32 s24, s74, s24
    s_cselect_b32 s25, s75, s25
    s_cmp_eq_u32 s3, 2
    s_cselect_b32 s24, s76, s24
    s_cselect_b32 s25, s77, s25
    s_cmp_eq_u32 s3, 3
    s_cselect_b32 s24, s78, s24
    s_cselect_b32 s25, s79, s25
    v_mov_b32 v60, s24
    v_mov_b32 v61, s25
    v_cmp_gt_u32 vcc, 32, v2
    s_nop 1
    v_cndmask_b32 v60, v61, v60, vcc
    v_lshlrev_b32 v61, 2, v60
    s_mov_b32 s24, 24117248
    buffer_load_dword v32, v61, s[16:19], s24 offen
    s_mov_b32 s24, 24125440
    buffer_load_dword v33, v61, s[16:19], s24 offen
    v_lshlrev_b32 v61, 11, v60
    v_and_b32 v62, 31, v2
    v_lshlrev_b32 v62, 3, v62
    v_add_u32 v61, v61, v62
    s_lshl_b32 s24, s20, 8
    s_add_u32 s24, s24, 12582912
    buffer_load_dwordx2 v[34:35], v61, s[16:19], s24 offen
    s_waitcnt vmcnt(0)
    v_mul_f32 v32, 0x3a800000, v32
    v_mul_f32 v33, 0x3a800000, v33
    v_fma_f32 v33, -v32, v32, v33
    v_max_f32 v33, 0, v33
    v_cvt_pk_bf16_f32 v60, v32, v32
    v_lshlrev_b32 v32, 16, v60
    v_cvt_pk_bf16_f32 v60, v33, v33
    v_lshlrev_b32 v33, 16, v60
    v_add_f32 v33, 0x3727c5ac, v33
    v_cvt_pk_bf16_f32 v60, v33, v33
    v_lshlrev_b32 v33, 16, v60
    v_sqrt_f32 v33, v33
    s_nop 0
    v_cvt_pk_bf16_f32 v60, v33, v33
    v_lshlrev_b32 v33, 16, v60
    v_rcp_f32 v33, v33
    s_nop 0
    v_lshlrev_b32 v36, 16, v34
    v_and_b32 v37, 0xffff0000, v34
    v_lshlrev_b32 v38, 16, v35
    v_and_b32 v39, 0xffff0000, v35
    v_sub_f32 v36, v36, v32
    v_sub_f32 v37, v37, v32
    v_cvt_pk_bf16_f32 v60, v36, v37
    v_lshlrev_b32 v36, 16, v60
    v_and_b32 v37, 0xffff0000, v60
    v_mul_f32 v36, v36, v33
    v_mul_f32 v37, v37, v33
    v_sub_f32 v38, v38, v32
    v_sub_f32 v39, v39, v32
    v_cvt_pk_bf16_f32 v60, v38, v39
    v_lshlrev_b32 v38, 16, v60
    v_and_b32 v39, 0xffff0000, v60
    v_mul_f32 v38, v38, v33
    v_mul_f32 v39, v39, v33
    v_cvt_pk_bf16_f32 v34, v36, v37
    v_cvt_pk_bf16_f32 v35, v38, v39
    v_lshrrev_b32 v60, 5, v2
    s_lshl_b32 s24, s3, 1
    v_add_u32 v60, s24, v60
    v_lshlrev_b32 v60, 8, v60
    v_add_u32 v60, v60, v62
    v_add_u32 v60, 65536, v60
    ds_write_b64 v60, v[34:35]
    s_waitcnt lgkmcnt(0)
    s_barrier
    v_lshrrev_b32 v60, 5, v2
    v_lshlrev_b32 v60, 3, v60
    v_lshrrev_b32 v61, 2, v2
    v_and_b32 v61, 3, v61
    v_add_u32 v60, v60, v61
    v_lshlrev_b32 v60, 8, v60
    v_lshrrev_b32 v62, 4, v2
    v_and_b32 v62, 1, v62
    v_lshlrev_b32 v62, 1, v62
    v_lshrrev_b32 v63, 1, v2
    v_and_b32 v63, 1, v63
    v_add_u32 v62, v62, v63
    s_lshl_b32 s24, s3, 2
    v_add_u32 v62, s24, v62
    v_lshlrev_b32 v61, 2, v61
    v_xor_b32 v62, v62, v61
    v_lshlrev_b32 v62, 4, v62
    v_add_u32 v60, v60, v62
    v_and_b32 v62, 1, v2
    v_lshlrev_b32 v62, 3, v62
    v_add_u32 v60, v60, v62
    v_and_b32 v61, 31, v2
    v_lshlrev_b32 v61, 8, v61
    v_lshrrev_b32 v62, 5, v2
    v_lshlrev_b32 v62, 4, v62
    v_add_u32 v61, v61, v62
    v_add_u32 v61, 65536, v61
    v_add_u32 v63, 32768, v60
    v_mov_b32 v96, 0
    v_mov_b32 v97, 0
    v_mov_b32 v98, 0
    v_mov_b32 v99, 0
    v_mov_b32 v100, 0
    v_mov_b32 v101, 0
    v_mov_b32 v102, 0
    v_mov_b32 v103, 0
    v_mov_b32 v104, 0
    v_mov_b32 v105, 0
    v_mov_b32 v106, 0
    v_mov_b32 v107, 0
    v_mov_b32 v108, 0
    v_mov_b32 v109, 0
    v_mov_b32 v110, 0
    v_mov_b32 v111, 0
    v_mov_b32 v112, 0
    v_mov_b32 v113, 0
    v_mov_b32 v114, 0
    v_mov_b32 v115, 0
    v_mov_b32 v116, 0
    v_mov_b32 v117, 0
    v_mov_b32 v118, 0
    v_mov_b32 v119, 0
    v_mov_b32 v120, 0
    v_mov_b32 v121, 0
    v_mov_b32 v122, 0
    v_mov_b32 v123, 0
    v_mov_b32 v124, 0
    v_mov_b32 v125, 0
    v_mov_b32 v126, 0
    v_mov_b32 v127, 0
    ds_read_b128 v[64:67], v61 offset:0
    ds_read_b128 v[68:71], v61 offset:32
    ds_read_b128 v[72:75], v61 offset:64
    ds_read_b128 v[76:79], v61 offset:96
    ds_read_b128 v[80:83], v61 offset:128
    ds_read_b128 v[84:87], v61 offset:160
    ds_read_b128 v[88:91], v61 offset:192
    ds_read_b128 v[92:95], v61 offset:224
    ds_read_b64_tr_b16 v[128:129], v60 offset:0
    ds_read_b64_tr_b16 v[130:131], v60 offset:1024
    ds_read_b64_tr_b16 v[132:133], v60 offset:4096
    ds_read_b64_tr_b16 v[134:135], v60 offset:5120
    ds_read_b64_tr_b16 v[136:137], v60 offset:8192
    ds_read_b64_tr_b16 v[138:139], v60 offset:9216
    ds_read_b64_tr_b16 v[140:141], v60 offset:12288
    ds_read_b64_tr_b16 v[142:143], v60 offset:13312
    ds_read_b64_tr_b16 v[144:145], v60 offset:16384
    ds_read_b64_tr_b16 v[146:147], v60 offset:17408
    ds_read_b64_tr_b16 v[148:149], v60 offset:20480
    ds_read_b64_tr_b16 v[150:151], v60 offset:21504
    ds_read_b64_tr_b16 v[152:153], v60 offset:24576
    ds_read_b64_tr_b16 v[154:155], v60 offset:25600
    ds_read_b64_tr_b16 v[156:157], v60 offset:28672
    ds_read_b64_tr_b16 v[158:159], v60 offset:29696
    ds_read_b64_tr_b16 v[160:161], v63 offset:0
    ds_read_b64_tr_b16 v[162:163], v63 offset:1024
    ds_read_b64_tr_b16 v[164:165], v63 offset:4096
    ds_read_b64_tr_b16 v[166:167], v63 offset:5120
    ds_read_b64_tr_b16 v[168:169], v63 offset:8192
    ds_read_b64_tr_b16 v[170:171], v63 offset:9216
    ds_read_b64_tr_b16 v[172:173], v63 offset:12288
    ds_read_b64_tr_b16 v[174:175], v63 offset:13312
    ds_read_b64_tr_b16 v[176:177], v63 offset:16384
    ds_read_b64_tr_b16 v[178:179], v63 offset:17408
    ds_read_b64_tr_b16 v[180:181], v63 offset:20480
    ds_read_b64_tr_b16 v[182:183], v63 offset:21504
    ds_read_b64_tr_b16 v[184:185], v63 offset:24576
    ds_read_b64_tr_b16 v[186:187], v63 offset:25600
    ds_read_b64_tr_b16 v[188:189], v63 offset:28672
    ds_read_b64_tr_b16 v[190:191], v63 offset:29696
    s_waitcnt lgkmcnt(0)
    s_nop 1
    v_mfma_f32_32x32x16_bf16 v[96:111], v[128:131], v[64:67], v[96:111]
    v_mfma_f32_32x32x16_bf16 v[96:111], v[132:135], v[68:71], v[96:111]
    v_mfma_f32_32x32x16_bf16 v[96:111], v[136:139], v[72:75], v[96:111]
    v_mfma_f32_32x32x16_bf16 v[96:111], v[140:143], v[76:79], v[96:111]
    v_mfma_f32_32x32x16_bf16 v[96:111], v[144:147], v[80:83], v[96:111]
    v_mfma_f32_32x32x16_bf16 v[96:111], v[148:151], v[84:87], v[96:111]
    v_mfma_f32_32x32x16_bf16 v[96:111], v[152:155], v[88:91], v[96:111]
    v_mfma_f32_32x32x16_bf16 v[96:111], v[156:159], v[92:95], v[96:111]
    v_mfma_f32_32x32x16_bf16 v[112:127], v[160:163], v[64:67], v[112:127]
    v_mfma_f32_32x32x16_bf16 v[112:127], v[164:167], v[68:71], v[112:127]
    v_mfma_f32_32x32x16_bf16 v[112:127], v[168:171], v[72:75], v[112:127]
    v_mfma_f32_32x32x16_bf16 v[112:127], v[172:175], v[76:79], v[112:127]
    v_mfma_f32_32x32x16_bf16 v[112:127], v[176:179], v[80:83], v[112:127]
    v_mfma_f32_32x32x16_bf16 v[112:127], v[180:183], v[84:87], v[112:127]
    v_mfma_f32_32x32x16_bf16 v[112:127], v[184:187], v[88:91], v[112:127]
    v_mfma_f32_32x32x16_bf16 v[112:127], v[188:191], v[92:95], v[112:127]
    s_nop 15
    s_nop 3
    v_and_b32 v60, 31, v2
    v_cmp_gt_u32 vcc, 8, v60
    s_nop 1
    s_and_b64 exec, exec, vcc
    s_mov_b32 s24, 14336
    v_mul_lo_u32 v60, v60, s24
    v_lshrrev_b32 v61, 5, v2
    v_lshlrev_b32 v61, 4, v61
    v_add_u32 v60, v60, v61
    s_lshl_b32 s24, s20, 1
    s_add_u32 s24, s24, 0
    s_mul_i32 s24, s24, 114688
    s_lshl_b32 s25, s21, 9
    s_add_u32 s24, s24, s25
    s_lshl_b32 s25, s3, 7
    s_add_u32 s24, s24, s25
    s_add_u32 s24, s24, 25165824
    buffer_store_dwordx4 v[96:99], v60, s[16:19], s24 offen offset:0
    buffer_store_dwordx4 v[100:103], v60, s[16:19], s24 offen offset:32
    buffer_store_dwordx4 v[104:107], v60, s[16:19], s24 offen offset:64
    buffer_store_dwordx4 v[108:111], v60, s[16:19], s24 offen offset:96
    s_lshl_b32 s24, s20, 1
    s_add_u32 s24, s24, 1
    s_mul_i32 s24, s24, 114688
    s_lshl_b32 s25, s21, 9
    s_add_u32 s24, s24, s25
    s_lshl_b32 s25, s3, 7
    s_add_u32 s24, s24, s25
    s_add_u32 s24, s24, 25165824
    buffer_store_dwordx4 v[112:115], v60, s[16:19], s24 offen offset:0
    buffer_store_dwordx4 v[116:119], v60, s[16:19], s24 offen offset:32
    buffer_store_dwordx4 v[120:123], v60, s[16:19], s24 offen offset:64
    buffer_store_dwordx4 v[124:127], v60, s[16:19], s24 offen offset:96
    s_endpgm
L_end_k3a_kernel:
    s_endpgm
.text
.globl k4a_kernel
.p2align 8
.type k4a_kernel,@function
k4a_kernel:
    s_cmp_ge_u32 s2, 224
    s_cbranch_scc1 L_end_k4a_kernel
    s_load_dwordx2 s[4:5], s[0:1], 80
    s_load_dwordx2 s[6:7], s[0:1], 56
    v_lshrrev_b32 v1, 6, v0
    v_and_b32 v2, 63, v0
    s_nop 0
    v_readfirstlane_b32 s3, v1
    s_lshr_b32 s20, s2, 4
    s_and_b32 s21, s2, 15
    s_waitcnt lgkmcnt(0)
    s_mov_b32 s16, s4
    s_mov_b32 s17, s5
    s_mov_b32 s18, 29360128
    s_mov_b32 s19, 0x00020000
    s_mov_b32 s8, s6
    s_mov_b32 s9, s7
    s_mov_b32 s10, 7340032
    s_mov_b32 s11, 0x00020000
    v_lshrrev_b32 v4, 5, v0
    s_mov_b32 s22, 14336
    v_mul_lo_u32 v4, v4, s22
    v_and_b32 v5, 31, v0
    v_lshlrev_b32 v5, 5, v5
    v_add_u32 v4, v4, v5
    s_lshl_b32 s22, s20, 10
    s_add_u32 s22, s22, 25165824
    s_add_u32 s23, s22, 0
    buffer_load_dwordx4 v[32:35], v4, s[16:19], s23 offen
    buffer_load_dwordx4 v[36:39], v4, s[16:19], s23 offen offset:16
    s_add_u32 s23, s22, 114688
    buffer_load_dwordx4 v[40:43], v4, s[16:19], s23 offen
    buffer_load_dwordx4 v[44:47], v4, s[16:19], s23 offen offset:16
    s_add_u32 s23, s22, 229376
    buffer_load_dwordx4 v[48:51], v4, s[16:19], s23 offen
    buffer_load_dwordx4 v[52:55], v4, s[16:19], s23 offen offset:16
    s_add_u32 s23, s22, 344064
    buffer_load_dwordx4 v[56:59], v4, s[16:19], s23 offen
    buffer_load_dwordx4 v[60:63], v4, s[16:19], s23 offen offset:16
    s_add_u32 s23, s22, 458752
    buffer_load_dwordx4 v[64:67], v4, s[16:19], s23 offen
    buffer_load_dwordx4 v[68:71], v4, s[16:19], s23 offen offset:16
    s_add_u32 s23, s22, 573440
    buffer_load_dwordx4 v[72:75], v4, s[16:19], s23 offen
    buffer_load_dwordx4 v[76:79], v4, s[16:19], s23 offen offset:16
    s_add_u32 s23, s22, 688128
    buffer_load_dwordx4 v[80:83], v4, s[16:19], s23 offen
    buffer_load_dwordx4 v[84:87], v4, s[16:19], s23 offen offset:16
    s_add_u32 s23, s22, 802816
    buffer_load_dwordx4 v[88:91], v4, s[16:19], s23 offen
    buffer_load_dwordx4 v[92:95], v4, s[16:19], s23 offen offset:16
    s_add_u32 s23, s22, 917504
    buffer_load_dwordx4 v[96:99], v4, s[16:19], s23 offen
    buffer_load_dwordx4 v[100:103], v4, s[16:19], s23 offen offset:16
    s_add_u32 s23, s22, 1032192
    buffer_load_dwordx4 v[104:107], v4, s[16:19], s23 offen
    buffer_load_dwordx4 v[108:111], v4, s[16:19], s23 offen offset:16
    s_add_u32 s23, s22, 1146880
    buffer_load_dwordx4 v[112:115], v4, s[16:19], s23 offen
    buffer_load_dwordx4 v[116:119], v4, s[16:19], s23 offen offset:16
    s_add_u32 s23, s22, 1261568
    buffer_load_dwordx4 v[120:123], v4, s[16:19], s23 offen
    buffer_load_dwordx4 v[124:127], v4, s[16:19], s23 offen offset:16
    s_add_u32 s23, s22, 1376256
    buffer_load_dwordx4 v[128:131], v4, s[16:19], s23 offen
    buffer_load_dwordx4 v[132:135], v4, s[16:19], s23 offen offset:16
    s_add_u32 s23, s22, 1490944
    buffer_load_dwordx4 v[136:139], v4, s[16:19], s23 offen
    buffer_load_dwordx4 v[140:143], v4, s[16:19], s23 offen offset:16
    s_add_u32 s23, s22, 1605632
    buffer_load_dwordx4 v[144:147], v4, s[16:19], s23 offen
    buffer_load_dwordx4 v[148:151], v4, s[16:19], s23 offen offset:16
    s_add_u32 s23, s22, 1720320
    buffer_load_dwordx4 v[152:155], v4, s[16:19], s23 offen
    buffer_load_dwordx4 v[156:159], v4, s[16:19], s23 offen offset:16
    v_lshrrev_b32 v6, 4, v2
    v_and_b32 v6, 1, v6
    v_lshlrev_b32 v6, 2, v6
    v_and_b32 v7, 7, v2
    v_xor_b32 v6, v6, v7
    v_lshlrev_b32 v6, 4, v6
    v_lshrrev_b32 v7, 3, v2
    v_lshlrev_b32 v7, 11, v7
    v_add_u32 v6, v6, v7
    s_lshl_b32 s22, s20, 19
    s_lshl_b32 s23, s21, 7
    s_add_u32 s22, s22, s23
    s_lshl_b32 s23, s3, 17
    s_add_u32 s22, s22, s23
    s_lshl_b32 s23, s3, 13
    s_add_u32 s24, s23, 0
    s_mov_b32 m0, s24
    s_add_u32 s25, s22, 0
    buffer_load_dwordx4 v6, s[8:11], s25 offen lds
    s_add_u32 s24, s23, 1024
    s_mov_b32 m0, s24
    s_add_u32 s25, s22, 16384
    buffer_load_dwordx4 v6, s[8:11], s25 offen lds
    s_add_u32 s24, s23, 2048
    s_mov_b32 m0, s24
    s_add_u32 s25, s22, 32768
    buffer_load_dwordx4 v6, s[8:11], s25 offen lds
    s_add_u32 s24, s23, 3072
    s_mov_b32 m0, s24
    s_add_u32 s25, s22, 49152
    buffer_load_dwordx4 v6, s[8:11], s25 offen lds
    s_add_u32 s24, s23, 4096
    s_mov_b32 m0, s24
    s_add_u32 s25, s22, 65536
    buffer_load_dwordx4 v6, s[8:11], s25 offen lds
    s_add_u32 s24, s23, 5120
    s_mov_b32 m0, s24
    s_add_u32 s25, s22, 81920
    buffer_load_dwordx4 v6, s[8:11], s25 offen lds
    s_add_u32 s24, s23, 6144
    s_mov_b32 m0, s24
    s_add_u32 s25, s22, 98304
    buffer_load_dwordx4 v6, s[8:11], s25 offen lds
    s_add_u32 s24, s23, 7168
    s_mov_b32 m0, s24
    s_add_u32 s25, s22, 114688
    buffer_load_dwordx4 v6, s[8:11], s25 offen lds
    s_waitcnt vmcnt(8)
    v_add_f32 v32, v32, v48
    v_add_f32 v33, v33, v49
    v_add_f32 v34, v34, v50
    v_add_f32 v35, v35, v51
    v_add_f32 v36, v36, v52
    v_add_f32 v37, v37, v53
    v_add_f32 v38, v38, v54
    v_add_f32 v39, v39, v55
    v_add_f32 v40, v40, v56
    v_add_f32 v41, v41, v57
    v_add_f32 v42, v42, v58
    v_add_f32 v43, v43, v59
    v_add_f32 v44, v44, v60
    v_add_f32 v45, v45, v61
    v_add_f32 v46, v46, v62
    v_add_f32 v47, v47, v63
    v_add_f32 v32, v32, v64
    v_add_f32 v33, v33, v65
    v_add_f32 v34, v34, v66
    v_add_f32 v35, v35, v67
    v_add_f32 v36, v36, v68
    v_add_f32 v37, v37, v69
    v_add_f32 v38, v38, v70
    v_add_f32 v39, v39, v71
    v_add_f32 v40, v40, v72
    v_add_f32 v41, v41, v73
    v_add_f32 v42, v42, v74
    v_add_f32 v43, v43, v75
    v_add_f32 v44, v44, v76
    v_add_f32 v45, v45, v77
    v_add_f32 v46, v46, v78
    v_add_f32 v47, v47, v79
    v_add_f32 v32, v32, v80
    v_add_f32 v33, v33, v81
    v_add_f32 v34, v34, v82
    v_add_f32 v35, v35, v83
    v_add_f32 v36, v36, v84
    v_add_f32 v37, v37, v85
    v_add_f32 v38, v38, v86
    v_add_f32 v39, v39, v87
    v_add_f32 v40, v40, v88
    v_add_f32 v41, v41, v89
    v_add_f32 v42, v42, v90
    v_add_f32 v43, v43, v91
    v_add_f32 v44, v44, v92
    v_add_f32 v45, v45, v93
    v_add_f32 v46, v46, v94
    v_add_f32 v47, v47, v95
    v_add_f32 v32, v32, v96
    v_add_f32 v33, v33, v97
    v_add_f32 v34, v34, v98
    v_add_f32 v35, v35, v99
    v_add_f32 v36, v36, v100
    v_add_f32 v37, v37, v101
    v_add_f32 v38, v38, v102
    v_add_f32 v39, v39, v103
    v_add_f32 v40, v40, v104
    v_add_f32 v41, v41, v105
    v_add_f32 v42, v42, v106
    v_add_f32 v43, v43, v107
    v_add_f32 v44, v44, v108
    v_add_f32 v45, v45, v109
    v_add_f32 v46, v46, v110
    v_add_f32 v47, v47, v111
    v_add_f32 v32, v32, v112
    v_add_f32 v33, v33, v113
    v_add_f32 v34, v34, v114
    v_add_f32 v35, v35, v115
    v_add_f32 v36, v36, v116
    v_add_f32 v37, v37, v117
    v_add_f32 v38, v38, v118
    v_add_f32 v39, v39, v119
    v_add_f32 v40, v40, v120
    v_add_f32 v41, v41, v121
    v_add_f32 v42, v42, v122
    v_add_f32 v43, v43, v123
    v_add_f32 v44, v44, v124
    v_add_f32 v45, v45, v125
    v_add_f32 v46, v46, v126
    v_add_f32 v47, v47, v127
    v_add_f32 v32, v32, v128
    v_add_f32 v33, v33, v129
    v_add_f32 v34, v34, v130
    v_add_f32 v35, v35, v131
    v_add_f32 v36, v36, v132
    v_add_f32 v37, v37, v133
    v_add_f32 v38, v38, v134
    v_add_f32 v39, v39, v135
    v_add_f32 v40, v40, v136
    v_add_f32 v41, v41, v137
    v_add_f32 v42, v42, v138
    v_add_f32 v43, v43, v139
    v_add_f32 v44, v44, v140
    v_add_f32 v45, v45, v141
    v_add_f32 v46, v46, v142
    v_add_f32 v47, v47, v143
    v_add_f32 v32, v32, v144
    v_add_f32 v33, v33, v145
    v_add_f32 v34, v34, v146
    v_add_f32 v35, v35, v147
    v_add_f32 v36, v36, v148
    v_add_f32 v37, v37, v149
    v_add_f32 v38, v38, v150
    v_add_f32 v39, v39, v151
    v_add_f32 v40, v40, v152
    v_add_f32 v41, v41, v153
    v_add_f32 v42, v42, v154
    v_add_f32 v43, v43, v155
    v_add_f32 v44, v44, v156
    v_add_f32 v45, v45, v157
    v_add_f32 v46, v46, v158
    v_add_f32 v47, v47, v159
    v_cvt_pk_bf16_f32 v60, v32, v33
    v_lshlrev_b32 v32, 16, v60
    v_and_b32 v33, 0xffff0000, v60
    v_cvt_pk_bf16_f32 v60, v40, v41
    v_lshlrev_b32 v40, 16, v60
    v_and_b32 v41, 0xffff0000, v60
    v_mul_f32 v61, 0xbfb8aa3b, v32
    v_mul_f32 v62, 0xbfb8aa3b, v33
    v_exp_f32 v61, v61
    v_exp_f32 v62, v62
    s_nop 0
    v_add_f32 v61, 1.0, v61
    v_add_f32 v62, 1.0, v62
    v_rcp_f32 v61, v61
    v_rcp_f32 v62, v62
    s_nop 0
    v_mul_f32 v32, v32, v61
    v_mul_f32 v33, v33, v62
    v_cvt_pk_bf16_f32 v60, v32, v33
    v_lshlrev_b32 v32, 16, v60
    v_and_b32 v33, 0xffff0000, v60
    v_mul_f32 v32, v32, v40
    v_mul_f32 v33, v33, v41
    v_cvt_pk_bf16_f32 v48, v32, v33
    v_cvt_pk_bf16_f32 v60, v34, v35
    v_lshlrev_b32 v34, 16, v60
    v_and_b32 v35, 0xffff0000, v60
    v_cvt_pk_bf16_f32 v60, v42, v43
    v_lshlrev_b32 v42, 16, v60
    v_and_b32 v43, 0xffff0000, v60
    v_mul_f32 v61, 0xbfb8aa3b, v34
    v_mul_f32 v62, 0xbfb8aa3b, v35
    v_exp_f32 v61, v61
    v_exp_f32 v62, v62
    s_nop 0
    v_add_f32 v61, 1.0, v61
    v_add_f32 v62, 1.0, v62
    v_rcp_f32 v61, v61
    v_rcp_f32 v62, v62
    s_nop 0
    v_mul_f32 v34, v34, v61
    v_mul_f32 v35, v35, v62
    v_cvt_pk_bf16_f32 v60, v34, v35
    v_lshlrev_b32 v34, 16, v60
    v_and_b32 v35, 0xffff0000, v60
    v_mul_f32 v34, v34, v42
    v_mul_f32 v35, v35, v43
    v_cvt_pk_bf16_f32 v49, v34, v35
    v_cvt_pk_bf16_f32 v60, v36, v37
    v_lshlrev_b32 v36, 16, v60
    v_and_b32 v37, 0xffff0000, v60
    v_cvt_pk_bf16_f32 v60, v44, v45
    v_lshlrev_b32 v44, 16, v60
    v_and_b32 v45, 0xffff0000, v60
    v_mul_f32 v61, 0xbfb8aa3b, v36
    v_mul_f32 v62, 0xbfb8aa3b, v37
    v_exp_f32 v61, v61
    v_exp_f32 v62, v62
    s_nop 0
    v_add_f32 v61, 1.0, v61
    v_add_f32 v62, 1.0, v62
    v_rcp_f32 v61, v61
    v_rcp_f32 v62, v62
    s_nop 0
    v_mul_f32 v36, v36, v61
    v_mul_f32 v37, v37, v62
    v_cvt_pk_bf16_f32 v60, v36, v37
    v_lshlrev_b32 v36, 16, v60
    v_and_b32 v37, 0xffff0000, v60
    v_mul_f32 v36, v36, v44
    v_mul_f32 v37, v37, v45
    v_cvt_pk_bf16_f32 v50, v36, v37
    v_cvt_pk_bf16_f32 v60, v38, v39
    v_lshlrev_b32 v38, 16, v60
    v_and_b32 v39, 0xffff0000, v60
    v_cvt_pk_bf16_f32 v60, v46, v47
    v_lshlrev_b32 v46, 16, v60
    v_and_b32 v47, 0xffff0000, v60
    v_mul_f32 v61, 0xbfb8aa3b, v38
    v_mul_f32 v62, 0xbfb8aa3b, v39
    v_exp_f32 v61, v61
    v_exp_f32 v62, v62
    s_nop 0
    v_add_f32 v61, 1.0, v61
    v_add_f32 v62, 1.0, v62
    v_rcp_f32 v61, v61
    v_rcp_f32 v62, v62
    s_nop 0
    v_mul_f32 v38, v38, v61
    v_mul_f32 v39, v39, v62
    v_cvt_pk_bf16_f32 v60, v38, v39
    v_lshlrev_b32 v38, 16, v60
    v_and_b32 v39, 0xffff0000, v60
    v_mul_f32 v38, v38, v46
    v_mul_f32 v39, v39, v47
    v_cvt_pk_bf16_f32 v51, v38, v39
    v_lshrrev_b32 v4, 5, v0
    v_lshlrev_b32 v4, 9, v4
    v_and_b32 v5, 31, v0
    v_lshlrev_b32 v5, 4, v5
    v_add_u32 v4, v4, v5
    v_add_u32 v4, 32768, v4
    ds_write_b128 v4, v[48:51]
    s_waitcnt vmcnt(0) lgkmcnt(0)
    s_barrier
    v_lshrrev_b32 v60, 4, v2
    v_lshlrev_b32 v60, 3, v60
    v_lshrrev_b32 v61, 2, v2
    v_and_b32 v61, 3, v61
    v_add_u32 v60, v60, v61
    v_lshlrev_b32 v60, 7, v60
    v_lshrrev_b32 v62, 1, v2
    v_and_b32 v62, 1, v62
    s_lshl_b32 s24, s3, 1
    v_add_u32 v62, s24, v62
    v_lshrrev_b32 v63, 1, v61
    v_and_b32 v63, 1, v63
    v_lshlrev_b32 v63, 2, v63
    v_xor_b32 v62, v62, v63
    v_lshlrev_b32 v62, 4, v62
    v_add_u32 v60, v60, v62
    v_and_b32 v62, 1, v2
    v_lshlrev_b32 v62, 3, v62
    v_add_u32 v60, v60, v62
    v_and_b32 v61, 15, v2
    v_lshlrev_b32 v61, 9, v61
    v_lshrrev_b32 v62, 4, v2
    v_lshlrev_b32 v62, 4, v62
    v_add_u32 v61, v61, v62
    v_add_u32 v61, 32768, v61
    v_mov_b32 v96, 0
    v_mov_b32 v97, 0
    v_mov_b32 v98, 0
    v_mov_b32 v99, 0
    ds_read_b128 v[64:67], v61 offset:0
    ds_read_b64_tr_b16 v[128:129], v60 offset:0
    ds_read_b64_tr_b16 v[130:131], v60 offset:512
    ds_read_b128 v[68:71], v61 offset:64
    ds_read_b64_tr_b16 v[132:133], v60 offset:4096
    ds_read_b64_tr_b16 v[134:135], v60 offset:4608
    ds_read_b128 v[72:75], v61 offset:128
    ds_read_b64_tr_b16 v[136:137], v60 offset:8192
    ds_read_b64_tr_b16 v[138:139], v60 offset:8704
    ds_read_b128 v[76:79], v61 offset:192
    ds_read_b64_tr_b16 v[140:141], v60 offset:12288
    ds_read_b64_tr_b16 v[142:143], v60 offset:12800
    ds_read_b128 v[80:83], v61 offset:256
    ds_read_b64_tr_b16 v[144:145], v60 offset:16384
    ds_read_b64_tr_b16 v[146:147], v60 offset:16896
    ds_read_b128 v[84:87], v61 offset:320
    ds_read_b64_tr_b16 v[148:149], v60 offset:20480
    ds_read_b64_tr_b16 v[150:151], v60 offset:20992
    ds_read_b128 v[88:91], v61 offset:384
    ds_read_b64_tr_b16 v[152:153], v60 offset:24576
    ds_read_b64_tr_b16 v[154:155], v60 offset:25088
    ds_read_b128 v[92:95], v61 offset:448
    ds_read_b64_tr_b16 v[156:157], v60 offset:28672
    ds_read_b64_tr_b16 v[158:159], v60 offset:29184
    s_waitcnt lgkmcnt(0)
    s_nop 1
    v_mfma_f32_16x16x32_bf16 v[96:99], v[128:131], v[64:67], v[96:99]
    v_mfma_f32_16x16x32_bf16 v[96:99], v[132:135], v[68:71], v[96:99]
    v_mfma_f32_16x16x32_bf16 v[96:99], v[136:139], v[72:75], v[96:99]
    v_mfma_f32_16x16x32_bf16 v[96:99], v[140:143], v[76:79], v[96:99]
    v_mfma_f32_16x16x32_bf16 v[96:99], v[144:147], v[80:83], v[96:99]
    v_mfma_f32_16x16x32_bf16 v[96:99], v[148:151], v[84:87], v[96:99]
    v_mfma_f32_16x16x32_bf16 v[96:99], v[152:155], v[88:91], v[96:99]
    v_mfma_f32_16x16x32_bf16 v[96:99], v[156:159], v[92:95], v[96:99]
    s_nop 15
    v_and_b32 v60, 15, v2
    v_cmp_gt_u32 vcc, 8, v60
    s_nop 1
    s_and_b64 exec, exec, vcc
    v_lshlrev_b32 v60, 12, v60
    v_lshrrev_b32 v61, 4, v2
    v_lshlrev_b32 v61, 4, v61
    v_add_u32 v60, v60, v61
    s_lshl_b32 s24, s20, 15
    s_lshl_b32 s25, s21, 8
    s_add_u32 s24, s24, s25
    s_lshl_b32 s25, s3, 6
    s_add_u32 s24, s24, s25
    s_add_u32 s24, s24, 27262976
    buffer_store_dwordx4 v[96:99], v60, s[16:19], s24 offen
    s_endpgm
L_end_k4a_kernel:
    s_endpgm
.text
.globl k5a_kernel
.p2align 8
.type k5a_kernel,@function
k5a_kernel:
    s_cmp_ge_u32 s2, 512
    s_cbranch_scc1 L_end_k5a_kernel
    s_load_dwordx2 s[4:5], s[0:1], 80
    v_lshrrev_b32 v1, 6, v0
    v_and_b32 v2, 63, v0
    s_nop 0
    v_readfirstlane_b32 s3, v1
    s_lshl_b32 s20, s2, 2
    s_add_u32 s20, s20, s3
    s_lshl_b32 s21, s20, 11
    v_lshlrev_b32 v3, 4, v2
    s_waitcnt lgkmcnt(0)
    s_add_u32 s8, s4, 12582912
    s_addc_u32 s9, s5, 0
    s_mov_b32 s10, 4194304
    s_mov_b32 s11, 0x00020000
    s_mov_b32 s12, s4
    s_mov_b32 s13, s5
    s_mov_b32 s14, 4194304
    s_mov_b32 s15, 0x00020000
    s_mov_b32 s16, s4
    s_mov_b32 s17, s5
    s_mov_b32 s18, 29360128
    s_mov_b32 s19, 0x00020000
    buffer_load_dwordx4 v[4:7], v3, s[8:11], s21 offen
    buffer_load_dwordx4 v[8:11], v3, s[8:11], s21 offen offset:1024
    s_lshl_b32 s22, s20, 2
    v_mov_b32 v12, 0
    s_add_u32 s23, s22, 24117248
    buffer_load_dword v13, v12, s[16:19], s23 offen
    s_add_u32 s23, s22, 24125440
    buffer_load_dword v14, v12, s[16:19], s23 offen
    s_add_u32 s24, s4, 24183808
    s_addc_u32 s25, s5, 0
    s_load_dwordx8 s[32:39], s[24:25], 0
    s_load_dwordx8 s[40:47], s[24:25], 32
    s_waitcnt vmcnt(0)
    v_lshlrev_b32 v16, 16, v4
    v_and_b32 v17, 0xffff0000, v4
    v_lshlrev_b32 v18, 16, v5
    v_and_b32 v19, 0xffff0000, v5
    v_lshlrev_b32 v20, 16, v6
    v_and_b32 v21, 0xffff0000, v6
    v_lshlrev_b32 v22, 16, v7
    v_and_b32 v23, 0xffff0000, v7
    v_lshlrev_b32 v24, 16, v8
    v_and_b32 v25, 0xffff0000, v8
    v_lshlrev_b32 v26, 16, v9
    v_and_b32 v27, 0xffff0000, v9
    v_lshlrev_b32 v28, 16, v10
    v_and_b32 v29, 0xffff0000, v10
    v_lshlrev_b32 v30, 16, v11
    v_and_b32 v31, 0xffff0000, v11
    v_mul_f32 v13, 0x3a800000, v13
    v_mul_f32 v14, 0x3a800000, v14
    v_fma_f32 v14, -v13, v13, v14
    v_max_f32 v14, 0, v14
    v_cvt_pk_bf16_f32 v15, v13, v13
    v_lshlrev_b32 v13, 16, v15
    v_cvt_pk_bf16_f32 v15, v14, v14
    v_lshlrev_b32 v14, 16, v15
    v_add_f32 v14, 0x3727c5ac, v14
    v_cvt_pk_bf16_f32 v15, v14, v14
    v_lshlrev_b32 v14, 16, v15
    v_sqrt_f32 v14, v14
    s_nop 0
    v_cvt_pk_bf16_f32 v15, v14, v14
    v_lshlrev_b32 v14, 16, v15
    v_rcp_f32 v14, v14
    s_nop 0
    v_sub_f32 v32, v16, v13
    v_sub_f32 v33, v17, v13
    v_cvt_pk_bf16_f32 v15, v32, v33
    v_lshlrev_b32 v32, 16, v15
    v_and_b32 v33, 0xffff0000, v15
    v_mul_f32 v32, v32, v14
    v_mul_f32 v33, v33, v14
    v_cvt_pk_bf16_f32 v15, v32, v33
    v_lshlrev_b32 v32, 16, v15
    v_and_b32 v33, 0xffff0000, v15
    v_sub_f32 v34, v18, v13
    v_sub_f32 v35, v19, v13
    v_cvt_pk_bf16_f32 v15, v34, v35
    v_lshlrev_b32 v34, 16, v15
    v_and_b32 v35, 0xffff0000, v15
    v_mul_f32 v34, v34, v14
    v_mul_f32 v35, v35, v14
    v_cvt_pk_bf16_f32 v15, v34, v35
    v_lshlrev_b32 v34, 16, v15
    v_and_b32 v35, 0xffff0000, v15
    v_sub_f32 v36, v20, v13
    v_sub_f32 v37, v21, v13
    v_cvt_pk_bf16_f32 v15, v36, v37
    v_lshlrev_b32 v36, 16, v15
    v_and_b32 v37, 0xffff0000, v15
    v_mul_f32 v36, v36, v14
    v_mul_f32 v37, v37, v14
    v_cvt_pk_bf16_f32 v15, v36, v37
    v_lshlrev_b32 v36, 16, v15
    v_and_b32 v37, 0xffff0000, v15
    v_sub_f32 v38, v22, v13
    v_sub_f32 v39, v23, v13
    v_cvt_pk_bf16_f32 v15, v38, v39
    v_lshlrev_b32 v38, 16, v15
    v_and_b32 v39, 0xffff0000, v15
    v_mul_f32 v38, v38, v14
    v_mul_f32 v39, v39, v14
    v_cvt_pk_bf16_f32 v15, v38, v39
    v_lshlrev_b32 v38, 16, v15
    v_and_b32 v39, 0xffff0000, v15
    v_sub_f32 v40, v24, v13
    v_sub_f32 v41, v25, v13
    v_cvt_pk_bf16_f32 v15, v40, v41
    v_lshlrev_b32 v40, 16, v15
    v_and_b32 v41, 0xffff0000, v15
    v_mul_f32 v40, v40, v14
    v_mul_f32 v41, v41, v14
    v_cvt_pk_bf16_f32 v15, v40, v41
    v_lshlrev_b32 v40, 16, v15
    v_and_b32 v41, 0xffff0000, v15
    v_sub_f32 v42, v26, v13
    v_sub_f32 v43, v27, v13
    v_cvt_pk_bf16_f32 v15, v42, v43
    v_lshlrev_b32 v42, 16, v15
    v_and_b32 v43, 0xffff0000, v15
    v_mul_f32 v42, v42, v14
    v_mul_f32 v43, v43, v14
    v_cvt_pk_bf16_f32 v15, v42, v43
    v_lshlrev_b32 v42, 16, v15
    v_and_b32 v43, 0xffff0000, v15
    v_sub_f32 v44, v28, v13
    v_sub_f32 v45, v29, v13
    v_cvt_pk_bf16_f32 v15, v44, v45
    v_lshlrev_b32 v44, 16, v15
    v_and_b32 v45, 0xffff0000, v15
    v_mul_f32 v44, v44, v14
    v_mul_f32 v45, v45, v14
    v_cvt_pk_bf16_f32 v15, v44, v45
    v_lshlrev_b32 v44, 16, v15
    v_and_b32 v45, 0xffff0000, v15
    v_sub_f32 v46, v30, v13
    v_sub_f32 v47, v31, v13
    v_cvt_pk_bf16_f32 v15, v46, v47
    v_lshlrev_b32 v46, 16, v15
    v_and_b32 v47, 0xffff0000, v15
    v_mul_f32 v46, v46, v14
    v_mul_f32 v47, v47, v14
    v_cvt_pk_bf16_f32 v15, v46, v47
    v_lshlrev_b32 v46, 16, v15
    v_and_b32 v47, 0xffff0000, v15
    s_waitcnt lgkmcnt(0)
    s_mov_b32 s26, -1
    s_cmp_eq_u32 s20, s32
    s_cselect_b32 s26, 0, s26
    s_cmp_eq_u32 s20, s33
    s_cselect_b32 s26, 1, s26
    s_cmp_eq_u32 s20, s34
    s_cselect_b32 s26, 2, s26
    s_cmp_eq_u32 s20, s35
    s_cselect_b32 s26, 3, s26
    s_cmp_eq_u32 s20, s36
    s_cselect_b32 s26, 4, s26
    s_cmp_eq_u32 s20, s37
    s_cselect_b32 s26, 5, s26
    s_cmp_eq_u32 s20, s38
    s_cselect_b32 s26, 6, s26
    s_cmp_eq_u32 s20, s39
    s_cselect_b32 s26, 7, s26
    s_cmp_eq_u32 s26, -1
    s_cbranch_scc1 L_nosel_k5a_kernel
    s_mov_b32 s27, s40
    s_cmp_eq_u32 s26, 1
    s_cselect_b32 s27, s41, s27
    s_cmp_eq_u32 s26, 2
    s_cselect_b32 s27, s42, s27
    s_cmp_eq_u32 s26, 3
    s_cselect_b32 s27, s43, s27
    s_cmp_eq_u32 s26, 4
    s_cselect_b32 s27, s44, s27
    s_cmp_eq_u32 s26, 5
    s_cselect_b32 s27, s45, s27
    s_cmp_eq_u32 s26, 6
    s_cselect_b32 s27, s46, s27
    s_cmp_eq_u32 s26, 7
    s_cselect_b32 s27, s47, s27
    v_lshlrev_b32 v64, 5, v2
    s_lshl_b32 s28, s26, 12
    s_add_u32 s28, s28, 27262976
    v_mov_b32 v48, 0
    v_mov_b32 v49, 0
    v_mov_b32 v50, 0
    v_mov_b32 v51, 0
    v_mov_b32 v52, 0
    v_mov_b32 v53, 0
    v_mov_b32 v54, 0
    v_mov_b32 v55, 0
    v_mov_b32 v56, 0
    v_mov_b32 v57, 0
    v_mov_b32 v58, 0
    v_mov_b32 v59, 0
    v_mov_b32 v60, 0
    v_mov_b32 v61, 0
    v_mov_b32 v62, 0
    v_mov_b32 v63, 0
    buffer_load_dwordx4 v[68:71], v64, s[16:19], s28 offen
    buffer_load_dwordx4 v[72:75], v64, s[16:19], s28 offen offset:16
    buffer_load_dwordx4 v[76:79], v64, s[16:19], s28 offen offset:2048
    buffer_load_dwordx4 v[80:83], v64, s[16:19], s28 offen offset:2064
    s_add_u32 s28, s28, 32768
    s_waitcnt vmcnt(0)
    v_add_f32 v48, v48, v68
    v_add_f32 v49, v49, v69
    v_add_f32 v50, v50, v70
    v_add_f32 v51, v51, v71
    v_add_f32 v52, v52, v72
    v_add_f32 v53, v53, v73
    v_add_f32 v54, v54, v74
    v_add_f32 v55, v55, v75
    v_add_f32 v56, v56, v76
    v_add_f32 v57, v57, v77
    v_add_f32 v58, v58, v78
    v_add_f32 v59, v59, v79
    v_add_f32 v60, v60, v80
    v_add_f32 v61, v61, v81
    v_add_f32 v62, v62, v82
    v_add_f32 v63, v63, v83
    buffer_load_dwordx4 v[68:71], v64, s[16:19], s28 offen
    buffer_load_dwordx4 v[72:75], v64, s[16:19], s28 offen offset:16
    buffer_load_dwordx4 v[76:79], v64, s[16:19], s28 offen offset:2048
    buffer_load_dwordx4 v[80:83], v64, s[16:19], s28 offen offset:2064
    s_add_u32 s28, s28, 32768
    s_waitcnt vmcnt(0)
    v_add_f32 v48, v48, v68
    v_add_f32 v49, v49, v69
    v_add_f32 v50, v50, v70
    v_add_f32 v51, v51, v71
    v_add_f32 v52, v52, v72
    v_add_f32 v53, v53, v73
    v_add_f32 v54, v54, v74
    v_add_f32 v55, v55, v75
    v_add_f32 v56, v56, v76
    v_add_f32 v57, v57, v77
    v_add_f32 v58, v58, v78
    v_add_f32 v59, v59, v79
    v_add_f32 v60, v60, v80
    v_add_f32 v61, v61, v81
    v_add_f32 v62, v62, v82
    v_add_f32 v63, v63, v83
    buffer_load_dwordx4 v[68:71], v64, s[16:19], s28 offen
    buffer_load_dwordx4 v[72:75], v64, s[16:19], s28 offen offset:16
    buffer_load_dwordx4 v[76:79], v64, s[16:19], s28 offen offset:2048
    buffer_load_dwordx4 v[80:83], v64, s[16:19], s28 offen offset:2064
    s_add_u32 s28, s28, 32768
    s_waitcnt vmcnt(0)
    v_add_f32 v48, v48, v68
    v_add_f32 v49, v49, v69
    v_add_f32 v50, v50, v70
    v_add_f32 v51, v51, v71
    v_add_f32 v52, v52, v72
    v_add_f32 v53, v53, v73
    v_add_f32 v54, v54, v74
    v_add_f32 v55, v55, v75
    v_add_f32 v56, v56, v76
    v_add_f32 v57, v57, v77
    v_add_f32 v58, v58, v78
    v_add_f32 v59, v59, v79
    v_add_f32 v60, v60, v80
    v_add_f32 v61, v61, v81
    v_add_f32 v62, v62, v82
    v_add_f32 v63, v63, v83
    buffer_load_dwordx4 v[68:71], v64, s[16:19], s28 offen
    buffer_load_dwordx4 v[72:75], v64, s[16:19], s28 offen offset:16
    buffer_load_dwordx4 v[76:79], v64, s[16:19], s28 offen offset:2048
    buffer_load_dwordx4 v[80:83], v64, s[16:19], s28 offen offset:2064
    s_add_u32 s28, s28, 32768
    s_waitcnt vmcnt(0)
    v_add_f32 v48, v48, v68
    v_add_f32 v49, v49, v69
    v_add_f32 v50, v50, v70
    v_add_f32 v51, v51, v71
    v_add_f32 v52, v52, v72
    v_add_f32 v53, v53, v73
    v_add_f32 v54, v54, v74
    v_add_f32 v55, v55, v75
    v_add_f32 v56, v56, v76
    v_add_f32 v57, v57, v77
    v_add_f32 v58, v58, v78
    v_add_f32 v59, v59, v79
    v_add_f32 v60, v60, v80
    v_add_f32 v61, v61, v81
    v_add_f32 v62, v62, v82
    v_add_f32 v63, v63, v83
    buffer_load_dwordx4 v[68:71], v64, s[16:19], s28 offen
    buffer_load_dwordx4 v[72:75], v64, s[16:19], s28 offen offset:16
    buffer_load_dwordx4 v[76:79], v64, s[16:19], s28 offen offset:2048
    buffer_load_dwordx4 v[80:83], v64, s[16:19], s28 offen offset:2064
    s_add_u32 s28, s28, 32768
    s_waitcnt vmcnt(0)
    v_add_f32 v48, v48, v68
    v_add_f32 v49, v49, v69
    v_add_f32 v50, v50, v70
    v_add_f32 v51, v51, v71
    v_add_f32 v52, v52, v72
    v_add_f32 v53, v53, v73
    v_add_f32 v54, v54, v74
    v_add_f32 v55, v55, v75
    v_add_f32 v56, v56, v76
    v_add_f32 v57, v57, v77
    v_add_f32 v58, v58, v78
    v_add_f32 v59, v59, v79
    v_add_f32 v60, v60, v80
    v_add_f32 v61, v61, v81
    v_add_f32 v62, v62, v82
    v_add_f32 v63, v63, v83
    buffer_load_dwordx4 v[68:71], v64, s[16:19], s28 offen
    buffer_load_dwordx4 v[72:75], v64, s[16:19], s28 offen offset:16
    buffer_load_dwordx4 v[76:79], v64, s[16:19], s28 offen offset:2048
    buffer_load_dwordx4 v[80:83], v64, s[16:19], s28 offen offset:2064
    s_add_u32 s28, s28, 32768
    s_waitcnt vmcnt(0)
    v_add_f32 v48, v48, v68
    v_add_f32 v49, v49, v69
    v_add_f32 v50, v50, v70
    v_add_f32 v51, v51, v71
    v_add_f32 v52, v52, v72
    v_add_f32 v53, v53, v73
    v_add_f32 v54, v54, v74
    v_add_f32 v55, v55, v75
    v_add_f32 v56, v56, v76
    v_add_f32 v57, v57, v77
    v_add_f32 v58, v58, v78
    v_add_f32 v59, v59, v79
    v_add_f32 v60, v60, v80
    v_add_f32 v61, v61, v81
    v_add_f32 v62, v62, v82
    v_add_f32 v63, v63, v83
    buffer_load_dwordx4 v[68:71], v64, s[16:19], s28 offen
    buffer_load_dwordx4 v[72:75], v64, s[16:19], s28 offen offset:16
    buffer_load_dwordx4 v[76:79], v64, s[16:19], s28 offen offset:2048
    buffer_load_dwordx4 v[80:83], v64, s[16:19], s28 offen offset:2064
    s_add_u32 s28, s28, 32768
    s_waitcnt vmcnt(0)
    v_add_f32 v48, v48, v68
    v_add_f32 v49, v49, v69
    v_add_f32 v50, v50, v70
    v_add_f32 v51, v51, v71
    v_add_f32 v52, v52, v72
    v_add_f32 v53, v53, v73
    v_add_f32 v54, v54, v74
    v_add_f32 v55, v55, v75
    v_add_f32 v56, v56, v76
    v_add_f32 v57, v57, v77
    v_add_f32 v58, v58, v78
    v_add_f32 v59, v59, v79
    v_add_f32 v60, v60, v80
    v_add_f32 v61, v61, v81
    v_add_f32 v62, v62, v82
    v_add_f32 v63, v63, v83
    buffer_load_dwordx4 v[68:71], v64, s[16:19], s28 offen
    buffer_load_dwordx4 v[72:75], v64, s[16:19], s28 offen offset:16
    buffer_load_dwordx4 v[76:79], v64, s[16:19], s28 offen offset:2048
    buffer_load_dwordx4 v[80:83], v64, s[16:19], s28 offen offset:2064
    s_add_u32 s28, s28, 32768
    s_waitcnt vmcnt(0)
    v_add_f32 v48, v48, v68
    v_add_f32 v49, v49, v69
    v_add_f32 v50, v50, v70
    v_add_f32 v51, v51, v71
    v_add_f32 v52, v52, v72
    v_add_f32 v53, v53, v73
    v_add_f32 v54, v54, v74
    v_add_f32 v55, v55, v75
    v_add_f32 v56, v56, v76
    v_add_f32 v57, v57, v77
    v_add_f32 v58, v58, v78
    v_add_f32 v59, v59, v79
    v_add_f32 v60, v60, v80
    v_add_f32 v61, v61, v81
    v_add_f32 v62, v62, v82
    v_add_f32 v63, v63, v83
    buffer_load_dwordx4 v[68:71], v64, s[16:19], s28 offen
    buffer_load_dwordx4 v[72:75], v64, s[16:19], s28 offen offset:16
    buffer_load_dwordx4 v[76:79], v64, s[16:19], s28 offen offset:2048
    buffer_load_dwordx4 v[80:83], v64, s[16:19], s28 offen offset:2064
    s_add_u32 s28, s28, 32768
    s_waitcnt vmcnt(0)
    v_add_f32 v48, v48, v68
    v_add_f32 v49, v49, v69
    v_add_f32 v50, v50, v70
    v_add_f32 v51, v51, v71
    v_add_f32 v52, v52, v72
    v_add_f32 v53, v53, v73
    v_add_f32 v54, v54, v74
    v_add_f32 v55, v55, v75
    v_add_f32 v56, v56, v76
    v_add_f32 v57, v57, v77
    v_add_f32 v58, v58, v78
    v_add_f32 v59, v59, v79
    v_add_f32 v60, v60, v80
    v_add_f32 v61, v61, v81
    v_add_f32 v62, v62, v82
    v_add_f32 v63, v63, v83
    buffer_load_dwordx4 v[68:71], v64, s[16:19], s28 offen
    buffer_load_dwordx4 v[72:75], v64, s[16:19], s28 offen offset:16
    buffer_load_dwordx4 v[76:79], v64, s[16:19], s28 offen offset:2048
    buffer_load_dwordx4 v[80:83], v64, s[16:19], s28 offen offset:2064
    s_add_u32 s28, s28, 32768
    s_waitcnt vmcnt(0)
    v_add_f32 v48, v48, v68
    v_add_f32 v49, v49, v69
    v_add_f32 v50, v50, v70
    v_add_f32 v51, v51, v71
    v_add_f32 v52, v52, v72
    v_add_f32 v53, v53, v73
    v_add_f32 v54, v54, v74
    v_add_f32 v55, v55, v75
    v_add_f32 v56, v56, v76
    v_add_f32 v57, v57, v77
    v_add_f32 v58, v58, v78
    v_add_f32 v59, v59, v79
    v_add_f32 v60, v60, v80
    v_add_f32 v61, v61, v81
    v_add_f32 v62, v62, v82
    v_add_f32 v63, v63, v83
    buffer_load_dwordx4 v[68:71], v64, s[16:19], s28 offen
    buffer_load_dwordx4 v[72:75], v64, s[16:19], s28 offen offset:16
    buffer_load_dwordx4 v[76:79], v64, s[16:19], s28 offen offset:2048
    buffer_load_dwordx4 v[80:83], v64, s[16:19], s28 offen offset:2064
    s_add_u32 s28, s28, 32768
    s_waitcnt vmcnt(0)
    v_add_f32 v48, v48, v68
    v_add_f32 v49, v49, v69
    v_add_f32 v50, v50, v70
    v_add_f32 v51, v51, v71
    v_add_f32 v52, v52, v72
    v_add_f32 v53, v53, v73
    v_add_f32 v54, v54, v74
    v_add_f32 v55, v55, v75
    v_add_f32 v56, v56, v76
    v_add_f32 v57, v57, v77
    v_add_f32 v58, v58, v78
    v_add_f32 v59, v59, v79
    v_add_f32 v60, v60, v80
    v_add_f32 v61, v61, v81
    v_add_f32 v62, v62, v82
    v_add_f32 v63, v63, v83
    buffer_load_dwordx4 v[68:71], v64, s[16:19], s28 offen
    buffer_load_dwordx4 v[72:75], v64, s[16:19], s28 offen offset:16
    buffer_load_dwordx4 v[76:79], v64, s[16:19], s28 offen offset:2048
    buffer_load_dwordx4 v[80:83], v64, s[16:19], s28 offen offset:2064
    s_add_u32 s28, s28, 32768
    s_waitcnt vmcnt(0)
    v_add_f32 v48, v48, v68
    v_add_f32 v49, v49, v69
    v_add_f32 v50, v50, v70
    v_add_f32 v51, v51, v71
    v_add_f32 v52, v52, v72
    v_add_f32 v53, v53, v73
    v_add_f32 v54, v54, v74
    v_add_f32 v55, v55, v75
    v_add_f32 v56, v56, v76
    v_add_f32 v57, v57, v77
    v_add_f32 v58, v58, v78
    v_add_f32 v59, v59, v79
    v_add_f32 v60, v60, v80
    v_add_f32 v61, v61, v81
    v_add_f32 v62, v62, v82
    v_add_f32 v63, v63, v83
    buffer_load_dwordx4 v[68:71], v64, s[16:19], s28 offen
    buffer_load_dwordx4 v[72:75], v64, s[16:19], s28 offen offset:16
    buffer_load_dwordx4 v[76:79], v64, s[16:19], s28 offen offset:2048
    buffer_load_dwordx4 v[80:83], v64, s[16:19], s28 offen offset:2064
    s_add_u32 s28, s28, 32768
    s_waitcnt vmcnt(0)
    v_add_f32 v48, v48, v68
    v_add_f32 v49, v49, v69
    v_add_f32 v50, v50, v70
    v_add_f32 v51, v51, v71
    v_add_f32 v52, v52, v72
    v_add_f32 v53, v53, v73
    v_add_f32 v54, v54, v74
    v_add_f32 v55, v55, v75
    v_add_f32 v56, v56, v76
    v_add_f32 v57, v57, v77
    v_add_f32 v58, v58, v78
    v_add_f32 v59, v59, v79
    v_add_f32 v60, v60, v80
    v_add_f32 v61, v61, v81
    v_add_f32 v62, v62, v82
    v_add_f32 v63, v63, v83
    buffer_load_dwordx4 v[68:71], v64, s[16:19], s28 offen
    buffer_load_dwordx4 v[72:75], v64, s[16:19], s28 offen offset:16
    buffer_load_dwordx4 v[76:79], v64, s[16:19], s28 offen offset:2048
    buffer_load_dwordx4 v[80:83], v64, s[16:19], s28 offen offset:2064
    s_add_u32 s28, s28, 32768
    s_waitcnt vmcnt(0)
    v_add_f32 v48, v48, v68
    v_add_f32 v49, v49, v69
    v_add_f32 v50, v50, v70
    v_add_f32 v51, v51, v71
    v_add_f32 v52, v52, v72
    v_add_f32 v53, v53, v73
    v_add_f32 v54, v54, v74
    v_add_f32 v55, v55, v75
    v_add_f32 v56, v56, v76
    v_add_f32 v57, v57, v77
    v_add_f32 v58, v58, v78
    v_add_f32 v59, v59, v79
    v_add_f32 v60, v60, v80
    v_add_f32 v61, v61, v81
    v_add_f32 v62, v62, v82
    v_add_f32 v63, v63, v83
    v_cvt_pk_bf16_f32 v15, v48, v49
    v_lshlrev_b32 v48, 16, v15
    v_and_b32 v49, 0xffff0000, v15
    v_mul_f32 v48, s27, v48
    v_mul_f32 v49, s27, v49
    v_cvt_pk_bf16_f32 v15, v48, v49
    v_lshlrev_b32 v48, 16, v15
    v_and_b32 v49, 0xffff0000, v15
    v_add_f32 v32, v32, v48
    v_add_f32 v33, v33, v49
    v_cvt_pk_bf16_f32 v15, v32, v33
    v_lshlrev_b32 v32, 16, v15
    v_and_b32 v33, 0xffff0000, v15
    v_cvt_pk_bf16_f32 v15, v50, v51
    v_lshlrev_b32 v50, 16, v15
    v_and_b32 v51, 0xffff0000, v15
    v_mul_f32 v50, s27, v50
    v_mul_f32 v51, s27, v51
    v_cvt_pk_bf16_f32 v15, v50, v51
    v_lshlrev_b32 v50, 16, v15
    v_and_b32 v51, 0xffff0000, v15
    v_add_f32 v34, v34, v50
    v_add_f32 v35, v35, v51
    v_cvt_pk_bf16_f32 v15, v34, v35
    v_lshlrev_b32 v34, 16, v15
    v_and_b32 v35, 0xffff0000, v15
    v_cvt_pk_bf16_f32 v15, v52, v53
    v_lshlrev_b32 v52, 16, v15
    v_and_b32 v53, 0xffff0000, v15
    v_mul_f32 v52, s27, v52
    v_mul_f32 v53, s27, v53
    v_cvt_pk_bf16_f32 v15, v52, v53
    v_lshlrev_b32 v52, 16, v15
    v_and_b32 v53, 0xffff0000, v15
    v_add_f32 v36, v36, v52
    v_add_f32 v37, v37, v53
    v_cvt_pk_bf16_f32 v15, v36, v37
    v_lshlrev_b32 v36, 16, v15
    v_and_b32 v37, 0xffff0000, v15
    v_cvt_pk_bf16_f32 v15, v54, v55
    v_lshlrev_b32 v54, 16, v15
    v_and_b32 v55, 0xffff0000, v15
    v_mul_f32 v54, s27, v54
    v_mul_f32 v55, s27, v55
    v_cvt_pk_bf16_f32 v15, v54, v55
    v_lshlrev_b32 v54, 16, v15
    v_and_b32 v55, 0xffff0000, v15
    v_add_f32 v38, v38, v54
    v_add_f32 v39, v39, v55
    v_cvt_pk_bf16_f32 v15, v38, v39
    v_lshlrev_b32 v38, 16, v15
    v_and_b32 v39, 0xffff0000, v15
    v_cvt_pk_bf16_f32 v15, v56, v57
    v_lshlrev_b32 v56, 16, v15
    v_and_b32 v57, 0xffff0000, v15
    v_mul_f32 v56, s27, v56
    v_mul_f32 v57, s27, v57
    v_cvt_pk_bf16_f32 v15, v56, v57
    v_lshlrev_b32 v56, 16, v15
    v_and_b32 v57, 0xffff0000, v15
    v_add_f32 v40, v40, v56
    v_add_f32 v41, v41, v57
    v_cvt_pk_bf16_f32 v15, v40, v41
    v_lshlrev_b32 v40, 16, v15
    v_and_b32 v41, 0xffff0000, v15
    v_cvt_pk_bf16_f32 v15, v58, v59
    v_lshlrev_b32 v58, 16, v15
    v_and_b32 v59, 0xffff0000, v15
    v_mul_f32 v58, s27, v58
    v_mul_f32 v59, s27, v59
    v_cvt_pk_bf16_f32 v15, v58, v59
    v_lshlrev_b32 v58, 16, v15
    v_and_b32 v59, 0xffff0000, v15
    v_add_f32 v42, v42, v58
    v_add_f32 v43, v43, v59
    v_cvt_pk_bf16_f32 v15, v42, v43
    v_lshlrev_b32 v42, 16, v15
    v_and_b32 v43, 0xffff0000, v15
    v_cvt_pk_bf16_f32 v15, v60, v61
    v_lshlrev_b32 v60, 16, v15
    v_and_b32 v61, 0xffff0000, v15
    v_mul_f32 v60, s27, v60
    v_mul_f32 v61, s27, v61
    v_cvt_pk_bf16_f32 v15, v60, v61
    v_lshlrev_b32 v60, 16, v15
    v_and_b32 v61, 0xffff0000, v15
    v_add_f32 v44, v44, v60
    v_add_f32 v45, v45, v61
    v_cvt_pk_bf16_f32 v15, v44, v45
    v_lshlrev_b32 v44, 16, v15
    v_and_b32 v45, 0xffff0000, v15
    v_cvt_pk_bf16_f32 v15, v62, v63
    v_lshlrev_b32 v62, 16, v15
    v_and_b32 v63, 0xffff0000, v15
    v_mul_f32 v62, s27, v62
    v_mul_f32 v63, s27, v63
    v_cvt_pk_bf16_f32 v15, v62, v63
    v_lshlrev_b32 v62, 16, v15
    v_and_b32 v63, 0xffff0000, v15
    v_add_f32 v46, v46, v62
    v_add_f32 v47, v47, v63
    v_cvt_pk_bf16_f32 v15, v46, v47
    v_lshlrev_b32 v46, 16, v15
    v_and_b32 v47, 0xffff0000, v15
L_nosel_k5a_kernel:
    v_add_f32 v16, v16, v32
    v_add_f32 v17, v17, v33
    v_cvt_pk_bf16_f32 v15, v16, v17
    v_lshlrev_b32 v16, 16, v15
    v_and_b32 v17, 0xffff0000, v15
    v_add_f32 v18, v18, v34
    v_add_f32 v19, v19, v35
    v_cvt_pk_bf16_f32 v15, v18, v19
    v_lshlrev_b32 v18, 16, v15
    v_and_b32 v19, 0xffff0000, v15
    v_add_f32 v20, v20, v36
    v_add_f32 v21, v21, v37
    v_cvt_pk_bf16_f32 v15, v20, v21
    v_lshlrev_b32 v20, 16, v15
    v_and_b32 v21, 0xffff0000, v15
    v_add_f32 v22, v22, v38
    v_add_f32 v23, v23, v39
    v_cvt_pk_bf16_f32 v15, v22, v23
    v_lshlrev_b32 v22, 16, v15
    v_and_b32 v23, 0xffff0000, v15
    v_add_f32 v24, v24, v40
    v_add_f32 v25, v25, v41
    v_cvt_pk_bf16_f32 v15, v24, v25
    v_lshlrev_b32 v24, 16, v15
    v_and_b32 v25, 0xffff0000, v15
    v_add_f32 v26, v26, v42
    v_add_f32 v27, v27, v43
    v_cvt_pk_bf16_f32 v15, v26, v27
    v_lshlrev_b32 v26, 16, v15
    v_and_b32 v27, 0xffff0000, v15
    v_add_f32 v28, v28, v44
    v_add_f32 v29, v29, v45
    v_cvt_pk_bf16_f32 v15, v28, v29
    v_lshlrev_b32 v28, 16, v15
    v_and_b32 v29, 0xffff0000, v15
    v_add_f32 v30, v30, v46
    v_add_f32 v31, v31, v47
    v_cvt_pk_bf16_f32 v15, v30, v31
    v_lshlrev_b32 v30, 16, v15
    v_and_b32 v31, 0xffff0000, v15
    v_cvt_pk_bf16_f32 v48, v16, v17
    v_cvt_pk_bf16_f32 v49, v18, v19
    v_cvt_pk_bf16_f32 v50, v20, v21
    v_cvt_pk_bf16_f32 v51, v22, v23
    v_cvt_pk_bf16_f32 v52, v24, v25
    v_cvt_pk_bf16_f32 v53, v26, v27
    v_cvt_pk_bf16_f32 v54, v28, v29
    v_cvt_pk_bf16_f32 v55, v30, v31
    s_add_u32 s8, s4, 16777216
    s_addc_u32 s9, s5, 0
    s_mov_b32 s10, 4194304
    s_mov_b32 s11, 0x00020000
    buffer_store_dwordx4 v[48:51], v3, s[8:11], s21 offen
    buffer_store_dwordx4 v[52:55], v3, s[8:11], s21 offen offset:1024
    v_add_f32 v32, v16, v17
    v_add_f32 v32, v32, v18
    v_add_f32 v32, v32, v19
    v_add_f32 v32, v32, v20
    v_add_f32 v32, v32, v21
    v_add_f32 v32, v32, v22
    v_add_f32 v32, v32, v23
    v_add_f32 v32, v32, v24
    v_add_f32 v32, v32, v25
    v_add_f32 v32, v32, v26
    v_add_f32 v32, v32, v27
    v_add_f32 v32, v32, v28
    v_add_f32 v32, v32, v29
    v_add_f32 v32, v32, v30
    v_add_f32 v32, v32, v31
    s_nop 1
    v_add_f32_dpp v32, v32, v32 quad_perm:[1,0,3,2] row_mask:0xf bank_mask:0xf
    s_nop 1
    v_add_f32_dpp v32, v32, v32 quad_perm:[2,3,0,1] row_mask:0xf bank_mask:0xf
    s_nop 1
    v_add_f32_dpp v32, v32, v32 row_half_mirror row_mask:0xf bank_mask:0xf
    s_nop 1
    v_add_f32_dpp v32, v32, v32 row_mirror row_mask:0xf bank_mask:0xf
    s_nop 1
    v_readlane_b32 s60, v32, 0
    v_readlane_b32 s61, v32, 16
    v_readlane_b32 s62, v32, 32
    v_readlane_b32 s63, v32, 48
    s_nop 1
    v_mov_b32 v32, s60
    v_add_f32 v32, s61, v32
    v_add_f32 v32, s62, v32
    v_add_f32 v32, s63, v32
    v_mul_f32 v32, 0x3a800000, v32
    v_sub_f32 v34, v16, v32
    v_mul_f32 v33, v34, v34
    v_sub_f32 v34, v17, v32
    v_fmac_f32 v33, v34, v34
    v_sub_f32 v34, v18, v32
    v_fmac_f32 v33, v34, v34
    v_sub_f32 v34, v19, v32
    v_fmac_f32 v33, v34, v34
    v_sub_f32 v34, v20, v32
    v_fmac_f32 v33, v34, v34
    v_sub_f32 v34, v21, v32
    v_fmac_f32 v33, v34, v34
    v_sub_f32 v34, v22, v32
    v_fmac_f32 v33, v34, v34
    v_sub_f32 v34, v23, v32
    v_fmac_f32 v33, v34, v34
    v_sub_f32 v34, v24, v32
    v_fmac_f32 v33, v34, v34
    v_sub_f32 v34, v25, v32
    v_fmac_f32 v33, v34, v34
    v_sub_f32 v34, v26, v32
    v_fmac_f32 v33, v34, v34
    v_sub_f32 v34, v27, v32
    v_fmac_f32 v33, v34, v34
    v_sub_f32 v34, v28, v32
    v_fmac_f32 v33, v34, v34
    v_sub_f32 v34, v29, v32
    v_fmac_f32 v33, v34, v34
    v_sub_f32 v34, v30, v32
    v_fmac_f32 v33, v34, v34
    v_sub_f32 v34, v31, v32
    v_fmac_f32 v33, v34, v34
    s_nop 1
    v_add_f32_dpp v33, v33, v33 quad_perm:[1,0,3,2] row_mask:0xf bank_mask:0xf
    s_nop 1
    v_add_f32_dpp v33, v33, v33 quad_perm:[2,3,0,1] row_mask:0xf bank_mask:0xf
    s_nop 1
    v_add_f32_dpp v33, v33, v33 row_half_mirror row_mask:0xf bank_mask:0xf
    s_nop 1
    v_add_f32_dpp v33, v33, v33 row_mirror row_mask:0xf bank_mask:0xf
    s_nop 1
    v_readlane_b32 s60, v33, 0
    v_readlane_b32 s61, v33, 16
    v_readlane_b32 s62, v33, 32
    v_readlane_b32 s63, v33, 48
    s_nop 1
    v_mov_b32 v33, s60
    v_add_f32 v33, s61, v33
    v_add_f32 v33, s62, v33
    v_add_f32 v33, s63, v33
    v_mul_f32 v33, 0x3a800000, v33
    v_cvt_pk_bf16_f32 v34, v32, v32
    v_lshlrev_b32 v32, 16, v34
    v_cvt_pk_bf16_f32 v34, v33, v33
    v_lshlrev_b32 v33, 16, v34
    v_add_f32 v33, 0x3727c5ac, v33
    v_cvt_pk_bf16_f32 v34, v33, v33
    v_lshlrev_b32 v33, 16, v34
    v_sqrt_f32 v33, v33
    s_nop 0
    v_cvt_pk_bf16_f32 v34, v33, v33
    v_lshlrev_b32 v33, 16, v34
    v_rcp_f32 v33, v33
    s_nop 0
    v_sub_f32 v16, v16, v32
    v_sub_f32 v17, v17, v32
    v_cvt_pk_bf16_f32 v34, v16, v17
    v_lshlrev_b32 v16, 16, v34
    v_and_b32 v17, 0xffff0000, v34
    v_mul_f32 v16, v16, v33
    v_mul_f32 v17, v17, v33
    v_cvt_pk_bf16_f32 v16, v16, v17
    v_sub_f32 v18, v18, v32
    v_sub_f32 v19, v19, v32
    v_cvt_pk_bf16_f32 v34, v18, v19
    v_lshlrev_b32 v18, 16, v34
    v_and_b32 v19, 0xffff0000, v34
    v_mul_f32 v18, v18, v33
    v_mul_f32 v19, v19, v33
    v_cvt_pk_bf16_f32 v18, v18, v19
    v_sub_f32 v20, v20, v32
    v_sub_f32 v21, v21, v32
    v_cvt_pk_bf16_f32 v34, v20, v21
    v_lshlrev_b32 v20, 16, v34
    v_and_b32 v21, 0xffff0000, v34
    v_mul_f32 v20, v20, v33
    v_mul_f32 v21, v21, v33
    v_cvt_pk_bf16_f32 v20, v20, v21
    v_sub_f32 v22, v22, v32
    v_sub_f32 v23, v23, v32
    v_cvt_pk_bf16_f32 v34, v22, v23
    v_lshlrev_b32 v22, 16, v34
    v_and_b32 v23, 0xffff0000, v34
    v_mul_f32 v22, v22, v33
    v_mul_f32 v23, v23, v33
    v_cvt_pk_bf16_f32 v22, v22, v23
    v_sub_f32 v24, v24, v32
    v_sub_f32 v25, v25, v32
    v_cvt_pk_bf16_f32 v34, v24, v25
    v_lshlrev_b32 v24, 16, v34
    v_and_b32 v25, 0xffff0000, v34
    v_mul_f32 v24, v24, v33
    v_mul_f32 v25, v25, v33
    v_cvt_pk_bf16_f32 v24, v24, v25
    v_sub_f32 v26, v26, v32
    v_sub_f32 v27, v27, v32
    v_cvt_pk_bf16_f32 v34, v26, v27
    v_lshlrev_b32 v26, 16, v34
    v_and_b32 v27, 0xffff0000, v34
    v_mul_f32 v26, v26, v33
    v_mul_f32 v27, v27, v33
    v_cvt_pk_bf16_f32 v26, v26, v27
    v_sub_f32 v28, v28, v32
    v_sub_f32 v29, v29, v32
    v_cvt_pk_bf16_f32 v34, v28, v29
    v_lshlrev_b32 v28, 16, v34
    v_and_b32 v29, 0xffff0000, v34
    v_mul_f32 v28, v28, v33
    v_mul_f32 v29, v29, v33
    v_cvt_pk_bf16_f32 v28, v28, v29
    v_sub_f32 v30, v30, v32
    v_sub_f32 v31, v31, v32
    v_cvt_pk_bf16_f32 v34, v30, v31
    v_lshlrev_b32 v30, 16, v34
    v_and_b32 v31, 0xffff0000, v34
    v_mul_f32 v30, v30, v33
    v_mul_f32 v31, v31, v33
    v_cvt_pk_bf16_f32 v30, v30, v31
    v_mov_b32 v36, v16
    v_mov_b32 v37, v18
    v_mov_b32 v38, v20
    v_mov_b32 v39, v22
    v_mov_b32 v40, v24
    v_mov_b32 v41, v26
    v_mov_b32 v42, v28
    v_mov_b32 v43, v30
    buffer_store_dwordx4 v[36:39], v3, s[12:15], s21 offen
    buffer_store_dwordx4 v[40:43], v3, s[12:15], s21 offen offset:1024
    s_endpgm
L_end_k5a_kernel:
    s_endpgm
.text
.globl k1b_kernel
.p2align 8
.type k1b_kernel,@function
k1b_kernel:
    s_cmp_ge_u32 s2, 256
    s_cbranch_scc1 L_end_k1b_kernel
    s_load_dwordx2 s[4:5], s[0:1], 80
    s_load_dwordx2 s[6:7], s[0:1], 8
    v_lshrrev_b32 v1, 6, v0
    v_and_b32 v2, 63, v0
    s_nop 0
    v_readfirstlane_b32 s3, v1
    s_lshr_b32 s20, s2, 4
    s_and_b32 s21, s2, 15
    s_lshr_b32 s22, s3, 1
    s_and_b32 s23, s3, 1
    s_lshl_b32 s24, s22, 13
    s_lshl_b32 s25, s23, 2
    s_lshl_b32 s26, s21, 7
    s_waitcnt lgkmcnt(0)
    s_mov_b32 s8, s4
    s_mov_b32 s9, s5
    s_mov_b32 s10, 4194304
    s_mov_b32 s11, 0x00020000
    s_mov_b32 s12, s6
    s_mov_b32 s13, s7
    s_mov_b32 s14, 6291456
    s_mov_b32 s15, 0x00020000
    s_mov_b32 s16, s4
    s_mov_b32 s17, s5
    s_mov_b32 s18, 29360128
    s_mov_b32 s19, 0x00020000
    v_mov_b32 v32, 0
    v_mov_b32 v33, 0
    v_mov_b32 v34, 0
    v_mov_b32 v35, 0
    v_mov_b32 v36, 0
    v_mov_b32 v37, 0
    v_mov_b32 v38, 0
    v_mov_b32 v39, 0
    v_mov_b32 v40, 0
    v_mov_b32 v41, 0
    v_mov_b32 v42, 0
    v_mov_b32 v43, 0
    v_mov_b32 v44, 0
    v_mov_b32 v45, 0
    v_mov_b32 v46, 0
    v_mov_b32 v47, 0
    v_mov_b32 v48, 0
    v_mov_b32 v49, 0
    v_mov_b32 v50, 0
    v_mov_b32 v51, 0
    v_mov_b32 v52, 0
    v_mov_b32 v53, 0
    v_mov_b32 v54, 0
    v_mov_b32 v55, 0
    v_mov_b32 v56, 0
    v_mov_b32 v57, 0
    v_mov_b32 v58, 0
    v_mov_b32 v59, 0
    v_mov_b32 v60, 0
    v_mov_b32 v61, 0
    v_mov_b32 v62, 0
    v_mov_b32 v63, 0
    v_mov_b32 v64, 0
    v_mov_b32 v65, 0
    v_mov_b32 v66, 0
    v_mov_b32 v67, 0
    v_mov_b32 v68, 0
    v_mov_b32 v69, 0
    v_mov_b32 v70, 0
    v_mov_b32 v71, 0
    v_mov_b32 v72, 0
    v_mov_b32 v73, 0
    v_mov_b32 v74, 0
    v_mov_b32 v75, 0
    v_mov_b32 v76, 0
    v_mov_b32 v77, 0
    v_mov_b32 v78, 0
    v_mov_b32 v79, 0
    v_mov_b32 v80, 0
    v_mov_b32 v81, 0
    v_mov_b32 v82, 0
    v_mov_b32 v83, 0
    v_mov_b32 v84, 0
    v_mov_b32 v85, 0
    v_mov_b32 v86, 0
    v_mov_b32 v87, 0
    v_mov_b32 v88, 0
    v_mov_b32 v89, 0
    v_mov_b32 v90, 0
    v_mov_b32 v91, 0
    v_mov_b32 v92, 0
    v_mov_b32 v93, 0
    v_mov_b32 v94, 0
    v_mov_b32 v95, 0
    v_mov_b32 v96, 0
    v_mov_b32 v97, 0
    v_mov_b32 v98, 0
    v_mov_b32 v99, 0
    v_mov_b32 v100, 0
    v_mov_b32 v101, 0
    v_mov_b32 v102, 0
    v_mov_b32 v103, 0
    v_mov_b32 v104, 0
    v_mov_b32 v105, 0
    v_mov_b32 v106, 0
    v_mov_b32 v107, 0
    v_mov_b32 v108, 0
    v_mov_b32 v109, 0
    v_mov_b32 v110, 0
    v_mov_b32 v111, 0
    v_mov_b32 v112, 0
    v_mov_b32 v113, 0
    v_mov_b32 v114, 0
    v_mov_b32 v115, 0
    v_mov_b32 v116, 0
    v_mov_b32 v117, 0
    v_mov_b32 v118, 0
    v_mov_b32 v119, 0
    v_mov_b32 v120, 0
    v_mov_b32 v121, 0
    v_mov_b32 v122, 0
    v_mov_b32 v123, 0
    v_mov_b32 v124, 0
    v_mov_b32 v125, 0
    v_mov_b32 v126, 0
    v_mov_b32 v127, 0
    v_lshrrev_b32 v181, 4, v2
    v_add_u32 v181, 0, v181
    v_and_b32 v181, 7, v181
    v_and_b32 v182, 7, v2
    v_xor_b32 v181, v181, v182
    v_lshlrev_b32 v181, 4, v181
    v_lshrrev_b32 v182, 3, v2
    v_add_u32 v182, 0, v182
    v_lshlrev_b32 v182, 11, v182
    v_add_u32 v176, v181, v182
    v_lshrrev_b32 v181, 4, v2
    v_add_u32 v181, 4, v181
    v_and_b32 v181, 7, v181
    v_and_b32 v182, 7, v2
    v_xor_b32 v181, v181, v182
    v_lshlrev_b32 v181, 4, v181
    v_lshrrev_b32 v182, 3, v2
    v_add_u32 v182, 8, v182
    v_lshlrev_b32 v182, 11, v182
    v_add_u32 v177, v181, v182
    v_lshrrev_b32 v181, 4, v2
    v_add_u32 v181, 8, v181
    v_and_b32 v181, 7, v181
    v_and_b32 v182, 7, v2
    v_xor_b32 v181, v181, v182
    v_lshlrev_b32 v181, 4, v181
    v_lshrrev_b32 v182, 3, v2
    v_add_u32 v182, 16, v182
    v_lshlrev_b32 v182, 11, v182
    v_add_u32 v178, v181, v182
    v_lshrrev_b32 v181, 4, v2
    v_add_u32 v181, 12, v181
    v_and_b32 v181, 7, v181
    v_and_b32 v182, 7, v2
    v_xor_b32 v181, v181, v182
    v_lshlrev_b32 v181, 4, v181
    v_lshrrev_b32 v182, 3, v2
    v_add_u32 v182, 24, v182
    v_lshlrev_b32 v182, 11, v182
    v_add_u32 v179, v181, v182
    v_lshrrev_b32 v181, 4, v2
    v_and_b32 v181, 1, v181
    v_lshlrev_b32 v181, 2, v181
    v_and_b32 v182, 7, v2
    v_xor_b32 v181, v181, v182
    v_lshlrev_b32 v181, 4, v181
    v_lshrrev_b32 v182, 3, v2
    s_mov_b32 s40, 6144
    v_mul_lo_u32 v182, v182, s40
    v_add_u32 v180, v181, v182
    s_lshl_b32 s41, s20, 18
    s_lshl_b32 s43, s3, 16
    s_add_u32 s41, s41, s43
    s_mul_i32 s43, s3, 6
    s_add_u32 s43, s43, 0
    s_lshr_b32 s44, s43, 3
    s_and_b32 s43, s43, 7
    s_lshl_b32 s51, s44, 13
    s_lshl_b32 s45, s43, 10
    s_add_u32 s51, s51, s45
    s_add_u32 s51, s51, 16384
    s_mul_i32 s45, s43, 49152
    s_mul_i32 s44, s44, 2048
    s_add_u32 s45, s45, s44
    s_add_u32 s45, s45, s26
    s_mul_i32 s43, s3, 6
    s_add_u32 s43, s43, 1
    s_lshr_b32 s44, s43, 3
    s_and_b32 s43, s43, 7
    s_lshl_b32 s52, s44, 13
    s_lshl_b32 s46, s43, 10
    s_add_u32 s52, s52, s46
    s_add_u32 s52, s52, 16384
    s_mul_i32 s46, s43, 49152
    s_mul_i32 s44, s44, 2048
    s_add_u32 s46, s46, s44
    s_add_u32 s46, s46, s26
    s_mul_i32 s43, s3, 6
    s_add_u32 s43, s43, 2
    s_lshr_b32 s44, s43, 3
    s_and_b32 s43, s43, 7
    s_lshl_b32 s53, s44, 13
    s_lshl_b32 s47, s43, 10
    s_add_u32 s53, s53, s47
    s_add_u32 s53, s53, 16384
    s_mul_i32 s47, s43, 49152
    s_mul_i32 s44, s44, 2048
    s_add_u32 s47, s47, s44
    s_add_u32 s47, s47, s26
    s_mul_i32 s43, s3, 6
    s_add_u32 s43, s43, 3
    s_lshr_b32 s44, s43, 3
    s_and_b32 s43, s43, 7
    s_lshl_b32 s54, s44, 13
    s_lshl_b32 s48, s43, 10
    s_add_u32 s54, s54, s48
    s_add_u32 s54, s54, 16384
    s_mul_i32 s48, s43, 49152
    s_mul_i32 s44, s44, 2048
    s_add_u32 s48, s48, s44
    s_add_u32 s48, s48, s26
    s_mul_i32 s43, s3, 6
    s_add_u32 s43, s43, 4
    s_lshr_b32 s44, s43, 3
    s_and_b32 s43, s43, 7
    s_lshl_b32 s55, s44, 13
    s_lshl_b32 s49, s43, 10
    s_add_u32 s55, s55, s49
    s_add_u32 s55, s55, 16384
    s_mul_i32 s49, s43, 49152
    s_mul_i32 s44, s44, 2048
    s_add_u32 s49, s49, s44
    s_add_u32 s49, s49, s26
    s_mul_i32 s43, s3, 6
    s_add_u32 s43, s43, 5
    s_lshr_b32 s44, s43, 3
    s_and_b32 s43, s43, 7
    s_lshl_b32 s56, s44, 13
    s_lshl_b32 s50, s43, 10
    s_add_u32 s56, s56, s50
    s_add_u32 s56, s56, 16384
    s_mul_i32 s50, s43, 49152
    s_mul_i32 s44, s44, 2048
    s_add_u32 s50, s50, s44
    s_add_u32 s50, s50, s26
    s_lshl_b32 s57, s3, 12
    v_lshrrev_b32 v181, 5, v2
    v_add_u32 v181, 0, v181
    v_lshrrev_b32 v182, 1, v2
    v_and_b32 v182, 7, v182
    v_xor_b32 v181, v181, v182
    v_lshlrev_b32 v181, 4, v181
    v_and_b32 v182, 31, v2
    v_lshlrev_b32 v182, 7, v182
    v_add_u32 v181, v181, v182
    v_add_u32 v184, s24, v181
    v_add_u32 v188, 40960, v184
    v_add_u32 v192, 81920, v184
    v_add_u32 v196, 122880, v184
    v_lshrrev_b32 v181, 5, v2
    v_add_u32 v181, 2, v181
    v_lshrrev_b32 v182, 1, v2
    v_and_b32 v182, 7, v182
    v_xor_b32 v181, v181, v182
    v_lshlrev_b32 v181, 4, v181
    v_and_b32 v182, 31, v2
    v_lshlrev_b32 v182, 7, v182
    v_add_u32 v181, v181, v182
    v_add_u32 v185, s24, v181
    v_add_u32 v189, 40960, v185
    v_add_u32 v193, 81920, v185
    v_add_u32 v197, 122880, v185
    v_lshrrev_b32 v181, 5, v2
    v_add_u32 v181, 4, v181
    v_lshrrev_b32 v182, 1, v2
    v_and_b32 v182, 7, v182
    v_xor_b32 v181, v181, v182
    v_lshlrev_b32 v181, 4, v181
    v_and_b32 v182, 31, v2
    v_lshlrev_b32 v182, 7, v182
    v_add_u32 v181, v181, v182
    v_add_u32 v186, s24, v181
    v_add_u32 v190, 40960, v186
    v_add_u32 v194, 81920, v186
    v_add_u32 v198, 122880, v186
    v_lshrrev_b32 v181, 5, v2
    v_add_u32 v181, 6, v181
    v_lshrrev_b32 v182, 1, v2
    v_and_b32 v182, 7, v182
    v_xor_b32 v181, v181, v182
    v_lshlrev_b32 v181, 4, v181
    v_and_b32 v182, 31, v2
    v_lshlrev_b32 v182, 7, v182
    v_add_u32 v181, v181, v182
    v_add_u32 v187, s24, v181
    v_add_u32 v191, 40960, v187
    v_add_u32 v195, 81920, v187
    v_add_u32 v199, 122880, v187
    v_lshrrev_b32 v181, 5, v2
    v_lshlrev_b32 v181, 3, v181
    v_lshrrev_b32 v182, 2, v2
    v_and_b32 v182, 3, v182
    v_add_u32 v181, v181, v182
    v_lshlrev_b32 v200, 7, v181
    v_lshrrev_b32 v181, 4, v2
    v_and_b32 v181, 1, v181
    v_lshlrev_b32 v181, 1, v181
    v_lshrrev_b32 v182, 1, v2
    v_and_b32 v182, 1, v182
    v_add_u32 v181, v181, v182
    v_add_u32 v181, s25, v181
    v_lshrrev_b32 v182, 3, v2
    v_and_b32 v182, 1, v182
    v_lshlrev_b32 v182, 2, v182
    v_xor_b32 v181, v181, v182
    v_lshlrev_b32 v181, 4, v181
    v_add_u32 v200, v200, v181
    v_and_b32 v181, 1, v2
    v_lshlrev_b32 v181, 3, v181
    v_add_u32 v200, v200, v181
    v_add_u32 v200, 16384, v200
    v_add_u32 v201, 40960, v200
    v_add_u32 v202, 81920, v200
    v_add_u32 v203, 122880, v200
    s_mov_b32 s60, 0
    s_mov_b32 s61, 0
    s_add_u32 s58, s57, 0
    s_mov_b32 m0, s58
    s_add_u32 s59, s41, s60
    buffer_load_dwordx4 v176, s[8:11], s59 offen lds
    s_add_u32 s58, s57, 1024
    s_mov_b32 m0, s58
    s_add_u32 s59, s41, s60
    buffer_load_dwordx4 v177, s[8:11], s59 offen lds
    s_add_u32 s58, s57, 2048
    s_mov_b32 m0, s58
    s_add_u32 s59, s41, s60
    buffer_load_dwordx4 v178, s[8:11], s59 offen lds
    s_add_u32 s58, s57, 3072
    s_mov_b32 m0, s58
    s_add_u32 s59, s41, s60
    buffer_load_dwordx4 v179, s[8:11], s59 offen lds
    s_add_u32 s58, s51, 0
    s_mov_b32 m0, s58
    s_add_u32 s59, s45, s61
    buffer_load_dwordx4 v180, s[12:15], s59 offen lds
    s_add_u32 s58, s52, 0
    s_mov_b32 m0, s58
    s_add_u32 s59, s46, s61
    buffer_load_dwordx4 v180, s[12:15], s59 offen lds
    s_add_u32 s58, s53, 0
    s_mov_b32 m0, s58
    s_add_u32 s59, s47, s61
    buffer_load_dwordx4 v180, s[12:15], s59 offen lds
    s_add_u32 s58, s54, 0
    s_mov_b32 m0, s58
    s_add_u32 s59, s48, s61
    buffer_load_dwordx4 v180, s[12:15], s59 offen lds
    s_add_u32 s58, s55, 0
    s_mov_b32 m0, s58
    s_add_u32 s59, s49, s61
    buffer_load_dwordx4 v180, s[12:15], s59 offen lds
    s_add_u32 s58, s56, 0
    s_mov_b32 m0, s58
    s_add_u32 s59, s50, s61
    buffer_load_dwordx4 v180, s[12:15], s59 offen lds
    s_add_u32 s60, s60, 128
    s_add_u32 s61, s61, 393216
    s_add_u32 s58, s57, 40960
    s_mov_b32 m0, s58
    s_add_u32 s59, s41, s60
    buffer_load_dwordx4 v176, s[8:11], s59 offen lds
    s_add_u32 s58, s57, 41984
    s_mov_b32 m0, s58
    s_add_u32 s59, s41, s60
    buffer_load_dwordx4 v177, s[8:11], s59 offen lds
    s_add_u32 s58, s57, 43008
    s_mov_b32 m0, s58
    s_add_u32 s59, s41, s60
    buffer_load_dwordx4 v178, s[8:11], s59 offen lds
    s_add_u32 s58, s57, 44032
    s_mov_b32 m0, s58
    s_add_u32 s59, s41, s60
    buffer_load_dwordx4 v179, s[8:11], s59 offen lds
    s_add_u32 s58, s51, 40960
    s_mov_b32 m0, s58
    s_add_u32 s59, s45, s61
    buffer_load_dwordx4 v180, s[12:15], s59 offen lds
    s_add_u32 s58, s52, 40960
    s_mov_b32 m0, s58
    s_add_u32 s59, s46, s61
    buffer_load_dwordx4 v180, s[12:15], s59 offen lds
    s_add_u32 s58, s53, 40960
    s_mov_b32 m0, s58
    s_add_u32 s59, s47, s61
    buffer_load_dwordx4 v180, s[12:15], s59 offen lds
    s_add_u32 s58, s54, 40960
    s_mov_b32 m0, s58
    s_add_u32 s59, s48, s61
    buffer_load_dwordx4 v180, s[12:15], s59 offen lds
    s_add_u32 s58, s55, 40960
    s_mov_b32 m0, s58
    s_add_u32 s59, s49, s61
    buffer_load_dwordx4 v180, s[12:15], s59 offen lds
    s_add_u32 s58, s56, 40960
    s_mov_b32 m0, s58
    s_add_u32 s59, s50, s61
    buffer_load_dwordx4 v180, s[12:15], s59 offen lds
    s_add_u32 s60, s60, 128
    s_add_u32 s61, s61, 393216
    s_add_u32 s58, s57, 81920
    s_mov_b32 m0, s58
    s_add_u32 s59, s41, s60
    buffer_load_dwordx4 v176, s[8:11], s59 offen lds
    s_add_u32 s58, s57, 82944
    s_mov_b32 m0, s58
    s_add_u32 s59, s41, s60
    buffer_load_dwordx4 v177, s[8:11], s59 offen lds
    s_add_u32 s58, s57, 83968
    s_mov_b32 m0, s58
    s_add_u32 s59, s41, s60
    buffer_load_dwordx4 v178, s[8:11], s59 offen lds
    s_add_u32 s58, s57, 84992
    s_mov_b32 m0, s58
    s_add_u32 s59, s41, s60
    buffer_load_dwordx4 v179, s[8:11], s59 offen lds
    s_add_u32 s58, s51, 81920
    s_mov_b32 m0, s58
    s_add_u32 s59, s45, s61
    buffer_load_dwordx4 v180, s[12:15], s59 offen lds
    s_add_u32 s58, s52, 81920
    s_mov_b32 m0, s58
    s_add_u32 s59, s46, s61
    buffer_load_dwordx4 v180, s[12:15], s59 offen lds
    s_add_u32 s58, s53, 81920
    s_mov_b32 m0, s58
    s_add_u32 s59, s47, s61
    buffer_load_dwordx4 v180, s[12:15], s59 offen lds
    s_add_u32 s58, s54, 81920
    s_mov_b32 m0, s58
    s_add_u32 s59, s48, s61
    buffer_load_dwordx4 v180, s[12:15], s59 offen lds
    s_add_u32 s58, s55, 81920
    s_mov_b32 m0, s58
    s_add_u32 s59, s49, s61
    buffer_load_dwordx4 v180, s[12:15], s59 offen lds
    s_add_u32 s58, s56, 81920
    s_mov_b32 m0, s58
    s_add_u32 s59, s50, s61
    buffer_load_dwordx4 v180, s[12:15], s59 offen lds
    s_add_u32 s60, s60, 128
    s_add_u32 s61, s61, 393216
    s_waitcnt vmcnt(20)
    s_barrier
    s_mov_b32 s62, 0
L_gl_k1b_kernel:
    s_add_u32 s58, s57, 122880
    s_mov_b32 m0, s58
    s_add_u32 s59, s41, s60
    buffer_load_dwordx4 v176, s[8:11], s59 offen lds
    s_add_u32 s58, s57, 123904
    s_mov_b32 m0, s58
    s_add_u32 s59, s41, s60
    buffer_load_dwordx4 v177, s[8:11], s59 offen lds
    s_add_u32 s58, s57, 124928
    s_mov_b32 m0, s58
    s_add_u32 s59, s41, s60
    buffer_load_dwordx4 v178, s[8:11], s59 offen lds
    s_add_u32 s58, s57, 125952
    s_mov_b32 m0, s58
    s_add_u32 s59, s41, s60
    buffer_load_dwordx4 v179, s[8:11], s59 offen lds
    s_add_u32 s58, s51, 122880
    s_mov_b32 m0, s58
    s_add_u32 s59, s45, s61
    buffer_load_dwordx4 v180, s[12:15], s59 offen lds
    s_add_u32 s58, s52, 122880
    s_mov_b32 m0, s58
    s_add_u32 s59, s46, s61
    buffer_load_dwordx4 v180, s[12:15], s59 offen lds
    s_add_u32 s58, s53, 122880
    s_mov_b32 m0, s58
    s_add_u32 s59, s47, s61
    buffer_load_dwordx4 v180, s[12:15], s59 offen lds
    s_add_u32 s58, s54, 122880
    s_mov_b32 m0, s58
    s_add_u32 s59, s48, s61
    buffer_load_dwordx4 v180, s[12:15], s59 offen lds
    s_add_u32 s58, s55, 122880
    s_mov_b32 m0, s58
    s_add_u32 s59, s49, s61
    buffer_load_dwordx4 v180, s[12:15], s59 offen lds
    s_add_u32 s58, s56, 122880
    s_mov_b32 m0, s58
    s_add_u32 s59, s50, s61
    buffer_load_dwordx4 v180, s[12:15], s59 offen lds
    s_add_u32 s60, s60, 128
    s_add_u32 s61, s61, 393216
    ds_read_b128 v[128:131], v184 offset:0
    ds_read_b128 v[132:135], v184 offset:4096
    ds_read_b64_tr_b16 v[136:137], v200 offset:0
    ds_read_b64_tr_b16 v[138:139], v200 offset:512
    ds_read_b64_tr_b16 v[140:141], v200 offset:8192
    ds_read_b64_tr_b16 v[142:143], v200 offset:8704
    ds_read_b64_tr_b16 v[144:145], v200 offset:16384
    ds_read_b64_tr_b16 v[146:147], v200 offset:16896
    ds_read_b128 v[148:151], v185 offset:0
    ds_read_b128 v[152:155], v185 offset:4096
    ds_read_b64_tr_b16 v[156:157], v200 offset:2048
    ds_read_b64_tr_b16 v[158:159], v200 offset:2560
    ds_read_b64_tr_b16 v[160:161], v200 offset:10240
    ds_read_b64_tr_b16 v[162:163], v200 offset:10752
    ds_read_b64_tr_b16 v[164:165], v200 offset:18432
    ds_read_b64_tr_b16 v[166:167], v200 offset:18944
    s_waitcnt lgkmcnt(8)
    v_mfma_f32_32x32x16_bf16 v[32:47], v[136:139], v[128:131], v[32:47]
    v_mfma_f32_32x32x16_bf16 v[48:63], v[128:131], v[140:143], v[48:63]
    v_mfma_f32_32x32x16_bf16 v[64:79], v[128:131], v[144:147], v[64:79]
    v_mfma_f32_32x32x16_bf16 v[80:95], v[136:139], v[132:135], v[80:95]
    v_mfma_f32_32x32x16_bf16 v[96:111], v[132:135], v[140:143], v[96:111]
    v_mfma_f32_32x32x16_bf16 v[112:127], v[132:135], v[144:147], v[112:127]
    ds_read_b128 v[128:131], v186 offset:0
    ds_read_b128 v[132:135], v186 offset:4096
    ds_read_b64_tr_b16 v[136:137], v200 offset:4096
    ds_read_b64_tr_b16 v[138:139], v200 offset:4608
    ds_read_b64_tr_b16 v[140:141], v200 offset:12288
    ds_read_b64_tr_b16 v[142:143], v200 offset:12800
    ds_read_b64_tr_b16 v[144:145], v200 offset:20480
    ds_read_b64_tr_b16 v[146:147], v200 offset:20992
    s_waitcnt lgkmcnt(8)
    v_mfma_f32_32x32x16_bf16 v[32:47], v[156:159], v[148:151], v[32:47]
    v_mfma_f32_32x32x16_bf16 v[48:63], v[148:151], v[160:163], v[48:63]
    v_mfma_f32_32x32x16_bf16 v[64:79], v[148:151], v[164:167], v[64:79]
    v_mfma_f32_32x32x16_bf16 v[80:95], v[156:159], v[152:155], v[80:95]
    v_mfma_f32_32x32x16_bf16 v[96:111], v[152:155], v[160:163], v[96:111]
    v_mfma_f32_32x32x16_bf16 v[112:127], v[152:155], v[164:167], v[112:127]
    ds_read_b128 v[148:151], v187 offset:0
    ds_read_b128 v[152:155], v187 offset:4096
    ds_read_b64_tr_b16 v[156:157], v200 offset:6144
    ds_read_b64_tr_b16 v[158:159], v200 offset:6656
    ds_read_b64_tr_b16 v[160:161], v200 offset:14336
    ds_read_b64_tr_b16 v[162:163], v200 offset:14848
    ds_read_b64_tr_b16 v[164:165], v200 offset:22528
    ds_read_b64_tr_b16 v[166:167], v200 offset:23040
    s_waitcnt lgkmcnt(8)
    v_mfma_f32_32x32x16_bf16 v[32:47], v[136:139], v[128:131], v[32:47]
    v_mfma_f32_32x32x16_bf16 v[48:63], v[128:131], v[140:143], v[48:63]
    v_mfma_f32_32x32x16_bf16 v[64:79], v[128:131], v[144:147], v[64:79]
    v_mfma_f32_32x32x16_bf16 v[80:95], v[136:139], v[132:135], v[80:95]
    v_mfma_f32_32x32x16_bf16 v[96:111], v[132:135], v[140:143], v[96:111]
    v_mfma_f32_32x32x16_bf16 v[112:127], v[132:135], v[144:147], v[112:127]
    s_waitcnt lgkmcnt(0)
    v_mfma_f32_32x32x16_bf16 v[32:47], v[156:159], v[148:151], v[32:47]
    v_mfma_f32_32x32x16_bf16 v[48:63], v[148:151], v[160:163], v[48:63]
    v_mfma_f32_32x32x16_bf16 v[64:79], v[148:151], v[164:167], v[64:79]
    v_mfma_f32_32x32x16_bf16 v[80:95], v[156:159], v[152:155], v[80:95]
    v_mfma_f32_32x32x16_bf16 v[96:111], v[152:155], v[160:163], v[96:111]
    v_mfma_f32_32x32x16_bf16 v[112:127], v[152:155], v[164:167], v[112:127]
    s_waitcnt vmcnt(20)
    s_barrier
    s_add_u32 s58, s57, 0
    s_mov_b32 m0, s58
    s_add_u32 s59, s41, s60
    buffer_load_dwordx4 v176, s[8:11], s59 offen lds
    s_add_u32 s58, s57, 1024
    s_mov_b32 m0, s58
    s_add_u32 s59, s41, s60
    buffer_load_dwordx4 v177, s[8:11], s59 offen lds
    s_add_u32 s58, s57, 2048
    s_mov_b32 m0, s58
    s_add_u32 s59, s41, s60
    buffer_load_dwordx4 v178, s[8:11], s59 offen lds
    s_add_u32 s58, s57, 3072
    s_mov_b32 m0, s58
    s_add_u32 s59, s41, s60
    buffer_load_dwordx4 v179, s[8:11], s59 offen lds
    s_add_u32 s58, s51, 0
    s_mov_b32 m0, s58
    s_add_u32 s59, s45, s61
    buffer_load_dwordx4 v180, s[12:15], s59 offen lds
    s_add_u32 s58, s52, 0
    s_mov_b32 m0, s58
    s_add_u32 s59, s46, s61
    buffer_load_dwordx4 v180, s[12:15], s59 offen lds
    s_add_u32 s58, s53, 0
    s_mov_b32 m0, s58
    s_add_u32 s59, s47, s61
    buffer_load_dwordx4 v180, s[12:15], s59 offen lds
    s_add_u32 s58, s54, 0
    s_mov_b32 m0, s58
    s_add_u32 s59, s48, s61
    buffer_load_dwordx4 v180, s[12:15], s59 offen lds
    s_add_u32 s58, s55, 0
    s_mov_b32 m0, s58
    s_add_u32 s59, s49, s61
    buffer_load_dwordx4 v180, s[12:15], s59 offen lds
    s_add_u32 s58, s56, 0
    s_mov_b32 m0, s58
    s_add_u32 s59, s50, s61
    buffer_load_dwordx4 v180, s[12:15], s59 offen lds
    s_add_u32 s60, s60, 128
    s_add_u32 s61, s61, 393216
    ds_read_b128 v[128:131], v188 offset:0
    ds_read_b128 v[132:135], v188 offset:4096
    ds_read_b64_tr_b16 v[136:137], v201 offset:0
    ds_read_b64_tr_b16 v[138:139], v201 offset:512
    ds_read_b64_tr_b16 v[140:141], v201 offset:8192
    ds_read_b64_tr_b16 v[142:143], v201 offset:8704
    ds_read_b64_tr_b16 v[144:145], v201 offset:16384
    ds_read_b64_tr_b16 v[146:147], v201 offset:16896
    ds_read_b128 v[148:151], v189 offset:0
    ds_read_b128 v[152:155], v189 offset:4096
    ds_read_b64_tr_b16 v[156:157], v201 offset:2048
    ds_read_b64_tr_b16 v[158:159], v201 offset:2560
    ds_read_b64_tr_b16 v[160:161], v201 offset:10240
    ds_read_b64_tr_b16 v[162:163], v201 offset:10752
    ds_read_b64_tr_b16 v[164:165], v201 offset:18432
    ds_read_b64_tr_b16 v[166:167], v201 offset:18944
    s_waitcnt lgkmcnt(8)
    v_mfma_f32_32x32x16_bf16 v[32:47], v[136:139], v[128:131], v[32:47]
    v_mfma_f32_32x32x16_bf16 v[48:63], v[128:131], v[140:143], v[48:63]
    v_mfma_f32_32x32x16_bf16 v[64:79], v[128:131], v[144:147], v[64:79]
    v_mfma_f32_32x32x16_bf16 v[80:95], v[136:139], v[132:135], v[80:95]
    v_mfma_f32_32x32x16_bf16 v[96:111], v[132:135], v[140:143], v[96:111]
    v_mfma_f32_32x32x16_bf16 v[112:127], v[132:135], v[144:147], v[112:127]
    ds_read_b128 v[128:131], v190 offset:0
    ds_read_b128 v[132:135], v190 offset:4096
    ds_read_b64_tr_b16 v[136:137], v201 offset:4096
    ds_read_b64_tr_b16 v[138:139], v201 offset:4608
    ds_read_b64_tr_b16 v[140:141], v201 offset:12288
    ds_read_b64_tr_b16 v[142:143], v201 offset:12800
    ds_read_b64_tr_b16 v[144:145], v201 offset:20480
    ds_read_b64_tr_b16 v[146:147], v201 offset:20992
    s_waitcnt lgkmcnt(8)
    v_mfma_f32_32x32x16_bf16 v[32:47], v[156:159], v[148:151], v[32:47]
    v_mfma_f32_32x32x16_bf16 v[48:63], v[148:151], v[160:163], v[48:63]
    v_mfma_f32_32x32x16_bf16 v[64:79], v[148:151], v[164:167], v[64:79]
    v_mfma_f32_32x32x16_bf16 v[80:95], v[156:159], v[152:155], v[80:95]
    v_mfma_f32_32x32x16_bf16 v[96:111], v[152:155], v[160:163], v[96:111]
    v_mfma_f32_32x32x16_bf16 v[112:127], v[152:155], v[164:167], v[112:127]
    ds_read_b128 v[148:151], v191 offset:0
    ds_read_b128 v[152:155], v191 offset:4096
    ds_read_b64_tr_b16 v[156:157], v201 offset:6144
    ds_read_b64_tr_b16 v[158:159], v201 offset:6656
    ds_read_b64_tr_b16 v[160:161], v201 offset:14336
    ds_read_b64_tr_b16 v[162:163], v201 offset:14848
    ds_read_b64_tr_b16 v[164:165], v201 offset:22528
    ds_read_b64_tr_b16 v[166:167], v201 offset:23040
    s_waitcnt lgkmcnt(8)
    v_mfma_f32_32x32x16_bf16 v[32:47], v[136:139], v[128:131], v[32:47]
    v_mfma_f32_32x32x16_bf16 v[48:63], v[128:131], v[140:143], v[48:63]
    v_mfma_f32_32x32x16_bf16 v[64:79], v[128:131], v[144:147], v[64:79]
    v_mfma_f32_32x32x16_bf16 v[80:95], v[136:139], v[132:135], v[80:95]
    v_mfma_f32_32x32x16_bf16 v[96:111], v[132:135], v[140:143], v[96:111]
    v_mfma_f32_32x32x16_bf16 v[112:127], v[132:135], v[144:147], v[112:127]
    s_waitcnt lgkmcnt(0)
    v_mfma_f32_32x32x16_bf16 v[32:47], v[156:159], v[148:151], v[32:47]
    v_mfma_f32_32x32x16_bf16 v[48:63], v[148:151], v[160:163], v[48:63]
    v_mfma_f32_32x32x16_bf16 v[64:79], v[148:151], v[164:167], v[64:79]
    v_mfma_f32_32x32x16_bf16 v[80:95], v[156:159], v[152:155], v[80:95]
    v_mfma_f32_32x32x16_bf16 v[96:111], v[152:155], v[160:163], v[96:111]
    v_mfma_f32_32x32x16_bf16 v[112:127], v[152:155], v[164:167], v[112:127]
    s_waitcnt vmcnt(20)
    s_barrier
    s_add_u32 s58, s57, 40960
    s_mov_b32 m0, s58
    s_add_u32 s59, s41, s60
    buffer_load_dwordx4 v176, s[8:11], s59 offen lds
    s_add_u32 s58, s57, 41984
    s_mov_b32 m0, s58
    s_add_u32 s59, s41, s60
    buffer_load_dwordx4 v177, s[8:11], s59 offen lds
    s_add_u32 s58, s57, 43008
    s_mov_b32 m0, s58
    s_add_u32 s59, s41, s60
    buffer_load_dwordx4 v178, s[8:11], s59 offen lds
    s_add_u32 s58, s57, 44032
    s_mov_b32 m0, s58
    s_add_u32 s59, s41, s60
    buffer_load_dwordx4 v179, s[8:11], s59 offen lds
    s_add_u32 s58, s51, 40960
    s_mov_b32 m0, s58
    s_add_u32 s59, s45, s61
    buffer_load_dwordx4 v180, s[12:15], s59 offen lds
    s_add_u32 s58, s52, 40960
    s_mov_b32 m0, s58
    s_add_u32 s59, s46, s61
    buffer_load_dwordx4 v180, s[12:15], s59 offen lds
    s_add_u32 s58, s53, 40960
    s_mov_b32 m0, s58
    s_add_u32 s59, s47, s61
    buffer_load_dwordx4 v180, s[12:15], s59 offen lds
    s_add_u32 s58, s54, 40960
    s_mov_b32 m0, s58
    s_add_u32 s59, s48, s61
    buffer_load_dwordx4 v180, s[12:15], s59 offen lds
    s_add_u32 s58, s55, 40960
    s_mov_b32 m0, s58
    s_add_u32 s59, s49, s61
    buffer_load_dwordx4 v180, s[12:15], s59 offen lds
    s_add_u32 s58, s56, 40960
    s_mov_b32 m0, s58
    s_add_u32 s59, s50, s61
    buffer_load_dwordx4 v180, s[12:15], s59 offen lds
    s_add_u32 s60, s60, 128
    s_add_u32 s61, s61, 393216
    ds_read_b128 v[128:131], v192 offset:0
    ds_read_b128 v[132:135], v192 offset:4096
    ds_read_b64_tr_b16 v[136:137], v202 offset:0
    ds_read_b64_tr_b16 v[138:139], v202 offset:512
    ds_read_b64_tr_b16 v[140:141], v202 offset:8192
    ds_read_b64_tr_b16 v[142:143], v202 offset:8704
    ds_read_b64_tr_b16 v[144:145], v202 offset:16384
    ds_read_b64_tr_b16 v[146:147], v202 offset:16896
    ds_read_b128 v[148:151], v193 offset:0
    ds_read_b128 v[152:155], v193 offset:4096
    ds_read_b64_tr_b16 v[156:157], v202 offset:2048
    ds_read_b64_tr_b16 v[158:159], v202 offset:2560
    ds_read_b64_tr_b16 v[160:161], v202 offset:10240
    ds_read_b64_tr_b16 v[162:163], v202 offset:10752
    ds_read_b64_tr_b16 v[164:165], v202 offset:18432
    ds_read_b64_tr_b16 v[166:167], v202 offset:18944
    s_waitcnt lgkmcnt(8)
    v_mfma_f32_32x32x16_bf16 v[32:47], v[136:139], v[128:131], v[32:47]
    v_mfma_f32_32x32x16_bf16 v[48:63], v[128:131], v[140:143], v[48:63]
    v_mfma_f32_32x32x16_bf16 v[64:79], v[128:131], v[144:147], v[64:79]
    v_mfma_f32_32x32x16_bf16 v[80:95], v[136:139], v[132:135], v[80:95]
    v_mfma_f32_32x32x16_bf16 v[96:111], v[132:135], v[140:143], v[96:111]
    v_mfma_f32_32x32x16_bf16 v[112:127], v[132:135], v[144:147], v[112:127]
    ds_read_b128 v[128:131], v194 offset:0
    ds_read_b128 v[132:135], v194 offset:4096
    ds_read_b64_tr_b16 v[136:137], v202 offset:4096
    ds_read_b64_tr_b16 v[138:139], v202 offset:4608
    ds_read_b64_tr_b16 v[140:141], v202 offset:12288
    ds_read_b64_tr_b16 v[142:143], v202 offset:12800
    ds_read_b64_tr_b16 v[144:145], v202 offset:20480
    ds_read_b64_tr_b16 v[146:147], v202 offset:20992
    s_waitcnt lgkmcnt(8)
    v_mfma_f32_32x32x16_bf16 v[32:47], v[156:159], v[148:151], v[32:47]
    v_mfma_f32_32x32x16_bf16 v[48:63], v[148:151], v[160:163], v[48:63]
    v_mfma_f32_32x32x16_bf16 v[64:79], v[148:151], v[164:167], v[64:79]
    v_mfma_f32_32x32x16_bf16 v[80:95], v[156:159], v[152:155], v[80:95]
    v_mfma_f32_32x32x16_bf16 v[96:111], v[152:155], v[160:163], v[96:111]
    v_mfma_f32_32x32x16_bf16 v[112:127], v[152:155], v[164:167], v[112:127]
    ds_read_b128 v[148:151], v195 offset:0
    ds_read_b128 v[152:155], v195 offset:4096
    ds_read_b64_tr_b16 v[156:157], v202 offset:6144
    ds_read_b64_tr_b16 v[158:159], v202 offset:6656
    ds_read_b64_tr_b16 v[160:161], v202 offset:14336
    ds_read_b64_tr_b16 v[162:163], v202 offset:14848
    ds_read_b64_tr_b16 v[164:165], v202 offset:22528
    ds_read_b64_tr_b16 v[166:167], v202 offset:23040
    s_waitcnt lgkmcnt(8)
    v_mfma_f32_32x32x16_bf16 v[32:47], v[136:139], v[128:131], v[32:47]
    v_mfma_f32_32x32x16_bf16 v[48:63], v[128:131], v[140:143], v[48:63]
    v_mfma_f32_32x32x16_bf16 v[64:79], v[128:131], v[144:147], v[64:79]
    v_mfma_f32_32x32x16_bf16 v[80:95], v[136:139], v[132:135], v[80:95]
    v_mfma_f32_32x32x16_bf16 v[96:111], v[132:135], v[140:143], v[96:111]
    v_mfma_f32_32x32x16_bf16 v[112:127], v[132:135], v[144:147], v[112:127]
    s_waitcnt lgkmcnt(0)
    v_mfma_f32_32x32x16_bf16 v[32:47], v[156:159], v[148:151], v[32:47]
    v_mfma_f32_32x32x16_bf16 v[48:63], v[148:151], v[160:163], v[48:63]
    v_mfma_f32_32x32x16_bf16 v[64:79], v[148:151], v[164:167], v[64:79]
    v_mfma_f32_32x32x16_bf16 v[80:95], v[156:159], v[152:155], v[80:95]
    v_mfma_f32_32x32x16_bf16 v[96:111], v[152:155], v[160:163], v[96:111]
    v_mfma_f32_32x32x16_bf16 v[112:127], v[152:155], v[164:167], v[112:127]
    s_waitcnt vmcnt(20)
    s_barrier
    s_add_u32 s58, s57, 81920
    s_mov_b32 m0, s58
    s_add_u32 s59, s41, s60
    buffer_load_dwordx4 v176, s[8:11], s59 offen lds
    s_add_u32 s58, s57, 82944
    s_mov_b32 m0, s58
    s_add_u32 s59, s41, s60
    buffer_load_dwordx4 v177, s[8:11], s59 offen lds
    s_add_u32 s58, s57, 83968
    s_mov_b32 m0, s58
    s_add_u32 s59, s41, s60
    buffer_load_dwordx4 v178, s[8:11], s59 offen lds
    s_add_u32 s58, s57, 84992
    s_mov_b32 m0, s58
    s_add_u32 s59, s41, s60
    buffer_load_dwordx4 v179, s[8:11], s59 offen lds
    s_add_u32 s58, s51, 81920
    s_mov_b32 m0, s58
    s_add_u32 s59, s45, s61
    buffer_load_dwordx4 v180, s[12:15], s59 offen lds
    s_add_u32 s58, s52, 81920
    s_mov_b32 m0, s58
    s_add_u32 s59, s46, s61
    buffer_load_dwordx4 v180, s[12:15], s59 offen lds
    s_add_u32 s58, s53, 81920
    s_mov_b32 m0, s58
    s_add_u32 s59, s47, s61
    buffer_load_dwordx4 v180, s[12:15], s59 offen lds
    s_add_u32 s58, s54, 81920
    s_mov_b32 m0, s58
    s_add_u32 s59, s48, s61
    buffer_load_dwordx4 v180, s[12:15], s59 offen lds
    s_add_u32 s58, s55, 81920
    s_mov_b32 m0, s58
    s_add_u32 s59, s49, s61
    buffer_load_dwordx4 v180, s[12:15], s59 offen lds
    s_add_u32 s58, s56, 81920
    s_mov_b32 m0, s58
    s_add_u32 s59, s50, s61
    buffer_load_dwordx4 v180, s[12:15], s59 offen lds
    s_add_u32 s60, s60, 128
    s_add_u32 s61, s61, 393216
    ds_read_b128 v[128:131], v196 offset:0
    ds_read_b128 v[132:135], v196 offset:4096
    ds_read_b64_tr_b16 v[136:137], v203 offset:0
    ds_read_b64_tr_b16 v[138:139], v203 offset:512
    ds_read_b64_tr_b16 v[140:141], v203 offset:8192
    ds_read_b64_tr_b16 v[142:143], v203 offset:8704
    ds_read_b64_tr_b16 v[144:145], v203 offset:16384
    ds_read_b64_tr_b16 v[146:147], v203 offset:16896
    ds_read_b128 v[148:151], v197 offset:0
    ds_read_b128 v[152:155], v197 offset:4096
    ds_read_b64_tr_b16 v[156:157], v203 offset:2048
    ds_read_b64_tr_b16 v[158:159], v203 offset:2560
    ds_read_b64_tr_b16 v[160:161], v203 offset:10240
    ds_read_b64_tr_b16 v[162:163], v203 offset:10752
    ds_read_b64_tr_b16 v[164:165], v203 offset:18432
    ds_read_b64_tr_b16 v[166:167], v203 offset:18944
    s_waitcnt lgkmcnt(8)
    v_mfma_f32_32x32x16_bf16 v[32:47], v[136:139], v[128:131], v[32:47]
    v_mfma_f32_32x32x16_bf16 v[48:63], v[128:131], v[140:143], v[48:63]
    v_mfma_f32_32x32x16_bf16 v[64:79], v[128:131], v[144:147], v[64:79]
    v_mfma_f32_32x32x16_bf16 v[80:95], v[136:139], v[132:135], v[80:95]
    v_mfma_f32_32x32x16_bf16 v[96:111], v[132:135], v[140:143], v[96:111]
    v_mfma_f32_32x32x16_bf16 v[112:127], v[132:135], v[144:147], v[112:127]
    ds_read_b128 v[128:131], v198 offset:0
    ds_read_b128 v[132:135], v198 offset:4096
    ds_read_b64_tr_b16 v[136:137], v203 offset:4096
    ds_read_b64_tr_b16 v[138:139], v203 offset:4608
    ds_read_b64_tr_b16 v[140:141], v203 offset:12288
    ds_read_b64_tr_b16 v[142:143], v203 offset:12800
    ds_read_b64_tr_b16 v[144:145], v203 offset:20480
    ds_read_b64_tr_b16 v[146:147], v203 offset:20992
    s_waitcnt lgkmcnt(8)
    v_mfma_f32_32x32x16_bf16 v[32:47], v[156:159], v[148:151], v[32:47]
    v_mfma_f32_32x32x16_bf16 v[48:63], v[148:151], v[160:163], v[48:63]
    v_mfma_f32_32x32x16_bf16 v[64:79], v[148:151], v[164:167], v[64:79]
    v_mfma_f32_32x32x16_bf16 v[80:95], v[156:159], v[152:155], v[80:95]
    v_mfma_f32_32x32x16_bf16 v[96:111], v[152:155], v[160:163], v[96:111]
    v_mfma_f32_32x32x16_bf16 v[112:127], v[152:155], v[164:167], v[112:127]
    ds_read_b128 v[148:151], v199 offset:0
    ds_read_b128 v[152:155], v199 offset:4096
    ds_read_b64_tr_b16 v[156:157], v203 offset:6144
    ds_read_b64_tr_b16 v[158:159], v203 offset:6656
    ds_read_b64_tr_b16 v[160:161], v203 offset:14336
    ds_read_b64_tr_b16 v[162:163], v203 offset:14848
    ds_read_b64_tr_b16 v[164:165], v203 offset:22528
    ds_read_b64_tr_b16 v[166:167], v203 offset:23040
    s_waitcnt lgkmcnt(8)
    v_mfma_f32_32x32x16_bf16 v[32:47], v[136:139], v[128:131], v[32:47]
    v_mfma_f32_32x32x16_bf16 v[48:63], v[128:131], v[140:143], v[48:63]
    v_mfma_f32_32x32x16_bf16 v[64:79], v[128:131], v[144:147], v[64:79]
    v_mfma_f32_32x32x16_bf16 v[80:95], v[136:139], v[132:135], v[80:95]
    v_mfma_f32_32x32x16_bf16 v[96:111], v[132:135], v[140:143], v[96:111]
    v_mfma_f32_32x32x16_bf16 v[112:127], v[132:135], v[144:147], v[112:127]
    s_waitcnt lgkmcnt(0)
    v_mfma_f32_32x32x16_bf16 v[32:47], v[156:159], v[148:151], v[32:47]
    v_mfma_f32_32x32x16_bf16 v[48:63], v[148:151], v[160:163], v[48:63]
    v_mfma_f32_32x32x16_bf16 v[64:79], v[148:151], v[164:167], v[64:79]
    v_mfma_f32_32x32x16_bf16 v[80:95], v[156:159], v[152:155], v[80:95]
    v_mfma_f32_32x32x16_bf16 v[96:111], v[152:155], v[160:163], v[96:111]
    v_mfma_f32_32x32x16_bf16 v[112:127], v[152:155], v[164:167], v[112:127]
    s_waitcnt vmcnt(20)
    s_barrier
    s_add_u32 s62, s62, 1
    s_cmp_lt_u32 s62, 3
    s_cbranch_scc1 L_gl_k1b_kernel
    s_add_u32 s58, s57, 122880
    s_mov_b32 m0, s58
    s_add_u32 s59, s41, s60
    buffer_load_dwordx4 v176, s[8:11], s59 offen lds
    s_add_u32 s58, s57, 123904
    s_mov_b32 m0, s58
    s_add_u32 s59, s41, s60
    buffer_load_dwordx4 v177, s[8:11], s59 offen lds
    s_add_u32 s58, s57, 124928
    s_mov_b32 m0, s58
    s_add_u32 s59, s41, s60
    buffer_load_dwordx4 v178, s[8:11], s59 offen lds
    s_add_u32 s58, s57, 125952
    s_mov_b32 m0, s58
    s_add_u32 s59, s41, s60
    buffer_load_dwordx4 v179, s[8:11], s59 offen lds
    s_add_u32 s58, s51, 122880
    s_mov_b32 m0, s58
    s_add_u32 s59, s45, s61
    buffer_load_dwordx4 v180, s[12:15], s59 offen lds
    s_add_u32 s58, s52, 122880
    s_mov_b32 m0, s58
    s_add_u32 s59, s46, s61
    buffer_load_dwordx4 v180, s[12:15], s59 offen lds
    s_add_u32 s58, s53, 122880
    s_mov_b32 m0, s58
    s_add_u32 s59, s47, s61
    buffer_load_dwordx4 v180, s[12:15], s59 offen lds
    s_add_u32 s58, s54, 122880
    s_mov_b32 m0, s58
    s_add_u32 s59, s48, s61
    buffer_load_dwordx4 v180, s[12:15], s59 offen lds
    s_add_u32 s58, s55, 122880
    s_mov_b32 m0, s58
    s_add_u32 s59, s49, s61
    buffer_load_dwordx4 v180, s[12:15], s59 offen lds
    s_add_u32 s58, s56, 122880
    s_mov_b32 m0, s58
    s_add_u32 s59, s50, s61
    buffer_load_dwordx4 v180, s[12:15], s59 offen lds
    s_add_u32 s60, s60, 128
    s_add_u32 s61, s61, 393216
    ds_read_b128 v[128:131], v184 offset:0
    ds_read_b128 v[132:135], v184 offset:4096
    ds_read_b64_tr_b16 v[136:137], v200 offset:0
    ds_read_b64_tr_b16 v[138:139], v200 offset:512
    ds_read_b64_tr_b16 v[140:141], v200 offset:8192
    ds_read_b64_tr_b16 v[142:143], v200 offset:8704
    ds_read_b64_tr_b16 v[144:145], v200 offset:16384
    ds_read_b64_tr_b16 v[146:147], v200 offset:16896
    ds_read_b128 v[148:151], v185 offset:0
    ds_read_b128 v[152:155], v185 offset:4096
    ds_read_b64_tr_b16 v[156:157], v200 offset:2048
    ds_read_b64_tr_b16 v[158:159], v200 offset:2560
    ds_read_b64_tr_b16 v[160:161], v200 offset:10240
    ds_read_b64_tr_b16 v[162:163], v200 offset:10752
    ds_read_b64_tr_b16 v[164:165], v200 offset:18432
    ds_read_b64_tr_b16 v[166:167], v200 offset:18944
    s_waitcnt lgkmcnt(8)
    v_mfma_f32_32x32x16_bf16 v[32:47], v[136:139], v[128:131], v[32:47]
    v_mfma_f32_32x32x16_bf16 v[48:63], v[128:131], v[140:143], v[48:63]
    v_mfma_f32_32x32x16_bf16 v[64:79], v[128:131], v[144:147], v[64:79]
    v_mfma_f32_32x32x16_bf16 v[80:95], v[136:139], v[132:135], v[80:95]
    v_mfma_f32_32x32x16_bf16 v[96:111], v[132:135], v[140:143], v[96:111]
    v_mfma_f32_32x32x16_bf16 v[112:127], v[132:135], v[144:147], v[112:127]
    ds_read_b128 v[128:131], v186 offset:0
    ds_read_b128 v[132:135], v186 offset:4096
    ds_read_b64_tr_b16 v[136:137], v200 offset:4096
    ds_read_b64_tr_b16 v[138:139], v200 offset:4608
    ds_read_b64_tr_b16 v[140:141], v200 offset:12288
    ds_read_b64_tr_b16 v[142:143], v200 offset:12800
    ds_read_b64_tr_b16 v[144:145], v200 offset:20480
    ds_read_b64_tr_b16 v[146:147], v200 offset:20992
    s_waitcnt lgkmcnt(8)
    v_mfma_f32_32x32x16_bf16 v[32:47], v[156:159], v[148:151], v[32:47]
    v_mfma_f32_32x32x16_bf16 v[48:63], v[148:151], v[160:163], v[48:63]
    v_mfma_f32_32x32x16_bf16 v[64:79], v[148:151], v[164:167], v[64:79]
    v_mfma_f32_32x32x16_bf16 v[80:95], v[156:159], v[152:155], v[80:95]
    v_mfma_f32_32x32x16_bf16 v[96:111], v[152:155], v[160:163], v[96:111]
    v_mfma_f32_32x32x16_bf16 v[112:127], v[152:155], v[164:167], v[112:127]
    ds_read_b128 v[148:151], v187 offset:0
    ds_read_b128 v[152:155], v187 offset:4096
    ds_read_b64_tr_b16 v[156:157], v200 offset:6144
    ds_read_b64_tr_b16 v[158:159], v200 offset:6656
    ds_read_b64_tr_b16 v[160:161], v200 offset:14336
    ds_read_b64_tr_b16 v[162:163], v200 offset:14848
    ds_read_b64_tr_b16 v[164:165], v200 offset:22528
    ds_read_b64_tr_b16 v[166:167], v200 offset:23040
    s_waitcnt lgkmcnt(8)
    v_mfma_f32_32x32x16_bf16 v[32:47], v[136:139], v[128:131], v[32:47]
    v_mfma_f32_32x32x16_bf16 v[48:63], v[128:131], v[140:143], v[48:63]
    v_mfma_f32_32x32x16_bf16 v[64:79], v[128:131], v[144:147], v[64:79]
    v_mfma_f32_32x32x16_bf16 v[80:95], v[136:139], v[132:135], v[80:95]
    v_mfma_f32_32x32x16_bf16 v[96:111], v[132:135], v[140:143], v[96:111]
    v_mfma_f32_32x32x16_bf16 v[112:127], v[132:135], v[144:147], v[112:127]
    s_waitcnt lgkmcnt(0)
    v_mfma_f32_32x32x16_bf16 v[32:47], v[156:159], v[148:151], v[32:47]
    v_mfma_f32_32x32x16_bf16 v[48:63], v[148:151], v[160:163], v[48:63]
    v_mfma_f32_32x32x16_bf16 v[64:79], v[148:151], v[164:167], v[64:79]
    v_mfma_f32_32x32x16_bf16 v[80:95], v[156:159], v[152:155], v[80:95]
    v_mfma_f32_32x32x16_bf16 v[96:111], v[152:155], v[160:163], v[96:111]
    v_mfma_f32_32x32x16_bf16 v[112:127], v[152:155], v[164:167], v[112:127]
    s_waitcnt vmcnt(20)
    s_barrier
    ds_read_b128 v[128:131], v188 offset:0
    ds_read_b128 v[132:135], v188 offset:4096
    ds_read_b64_tr_b16 v[136:137], v201 offset:0
    ds_read_b64_tr_b16 v[138:139], v201 offset:512
    ds_read_b64_tr_b16 v[140:141], v201 offset:8192
    ds_read_b64_tr_b16 v[142:143], v201 offset:8704
    ds_read_b64_tr_b16 v[144:145], v201 offset:16384
    ds_read_b64_tr_b16 v[146:147], v201 offset:16896
    ds_read_b128 v[148:151], v189 offset:0
    ds_read_b128 v[152:155], v189 offset:4096
    ds_read_b64_tr_b16 v[156:157], v201 offset:2048
    ds_read_b64_tr_b16 v[158:159], v201 offset:2560
    ds_read_b64_tr_b16 v[160:161], v201 offset:10240
    ds_read_b64_tr_b16 v[162:163], v201 offset:10752
    ds_read_b64_tr_b16 v[164:165], v201 offset:18432
    ds_read_b64_tr_b16 v[166:167], v201 offset:18944
    s_waitcnt lgkmcnt(8)
    v_mfma_f32_32x32x16_bf16 v[32:47], v[136:139], v[128:131], v[32:47]
    v_mfma_f32_32x32x16_bf16 v[48:63], v[128:131], v[140:143], v[48:63]
    v_mfma_f32_32x32x16_bf16 v[64:79], v[128:131], v[144:147], v[64:79]
    v_mfma_f32_32x32x16_bf16 v[80:95], v[136:139], v[132:135], v[80:95]
    v_mfma_f32_32x32x16_bf16 v[96:111], v[132:135], v[140:143], v[96:111]
    v_mfma_f32_32x32x16_bf16 v[112:127], v[132:135], v[144:147], v[112:127]
    ds_read_b128 v[128:131], v190 offset:0
    ds_read_b128 v[132:135], v190 offset:4096
    ds_read_b64_tr_b16 v[136:137], v201 offset:4096
    ds_read_b64_tr_b16 v[138:139], v201 offset:4608
    ds_read_b64_tr_b16 v[140:141], v201 offset:12288
    ds_read_b64_tr_b16 v[142:143], v201 offset:12800
    ds_read_b64_tr_b16 v[144:145], v201 offset:20480
    ds_read_b64_tr_b16 v[146:147], v201 offset:20992
    s_waitcnt lgkmcnt(8)
    v_mfma_f32_32x32x16_bf16 v[32:47], v[156:159], v[148:151], v[32:47]
    v_mfma_f32_32x32x16_bf16 v[48:63], v[148:151], v[160:163], v[48:63]
    v_mfma_f32_32x32x16_bf16 v[64:79], v[148:151], v[164:167], v[64:79]
    v_mfma_f32_32x32x16_bf16 v[80:95], v[156:159], v[152:155], v[80:95]
    v_mfma_f32_32x32x16_bf16 v[96:111], v[152:155], v[160:163], v[96:111]
    v_mfma_f32_32x32x16_bf16 v[112:127], v[152:155], v[164:167], v[112:127]
    ds_read_b128 v[148:151], v191 offset:0
    ds_read_b128 v[152:155], v191 offset:4096
    ds_read_b64_tr_b16 v[156:157], v201 offset:6144
    ds_read_b64_tr_b16 v[158:159], v201 offset:6656
    ds_read_b64_tr_b16 v[160:161], v201 offset:14336
    ds_read_b64_tr_b16 v[162:163], v201 offset:14848
    ds_read_b64_tr_b16 v[164:165], v201 offset:22528
    ds_read_b64_tr_b16 v[166:167], v201 offset:23040
    s_waitcnt lgkmcnt(8)
    v_mfma_f32_32x32x16_bf16 v[32:47], v[136:139], v[128:131], v[32:47]
    v_mfma_f32_32x32x16_bf16 v[48:63], v[128:131], v[140:143], v[48:63]
    v_mfma_f32_32x32x16_bf16 v[64:79], v[128:131], v[144:147], v[64:79]
    v_mfma_f32_32x32x16_bf16 v[80:95], v[136:139], v[132:135], v[80:95]
    v_mfma_f32_32x32x16_bf16 v[96:111], v[132:135], v[140:143], v[96:111]
    v_mfma_f32_32x32x16_bf16 v[112:127], v[132:135], v[144:147], v[112:127]
    s_waitcnt lgkmcnt(0)
    v_mfma_f32_32x32x16_bf16 v[32:47], v[156:159], v[148:151], v[32:47]
    v_mfma_f32_32x32x16_bf16 v[48:63], v[148:151], v[160:163], v[48:63]
    v_mfma_f32_32x32x16_bf16 v[64:79], v[148:151], v[164:167], v[64:79]
    v_mfma_f32_32x32x16_bf16 v[80:95], v[156:159], v[152:155], v[80:95]
    v_mfma_f32_32x32x16_bf16 v[96:111], v[152:155], v[160:163], v[96:111]
    v_mfma_f32_32x32x16_bf16 v[112:127], v[152:155], v[164:167], v[112:127]
    s_waitcnt vmcnt(10)
    s_barrier
    ds_read_b128 v[128:131], v192 offset:0
    ds_read_b128 v[132:135], v192 offset:4096
    ds_read_b64_tr_b16 v[136:137], v202 offset:0
    ds_read_b64_tr_b16 v[138:139], v202 offset:512
    ds_read_b64_tr_b16 v[140:141], v202 offset:8192
    ds_read_b64_tr_b16 v[142:143], v202 offset:8704
    ds_read_b64_tr_b16 v[144:145], v202 offset:16384
    ds_read_b64_tr_b16 v[146:147], v202 offset:16896
    ds_read_b128 v[148:151], v193 offset:0
    ds_read_b128 v[152:155], v193 offset:4096
    ds_read_b64_tr_b16 v[156:157], v202 offset:2048
    ds_read_b64_tr_b16 v[158:159], v202 offset:2560
    ds_read_b64_tr_b16 v[160:161], v202 offset:10240
    ds_read_b64_tr_b16 v[162:163], v202 offset:10752
    ds_read_b64_tr_b16 v[164:165], v202 offset:18432
    ds_read_b64_tr_b16 v[166:167], v202 offset:18944
    s_waitcnt lgkmcnt(8)
    v_mfma_f32_32x32x16_bf16 v[32:47], v[136:139], v[128:131], v[32:47]
    v_mfma_f32_32x32x16_bf16 v[48:63], v[128:131], v[140:143], v[48:63]
    v_mfma_f32_32x32x16_bf16 v[64:79], v[128:131], v[144:147], v[64:79]
    v_mfma_f32_32x32x16_bf16 v[80:95], v[136:139], v[132:135], v[80:95]
    v_mfma_f32_32x32x16_bf16 v[96:111], v[132:135], v[140:143], v[96:111]
    v_mfma_f32_32x32x16_bf16 v[112:127], v[132:135], v[144:147], v[112:127]
    ds_read_b128 v[128:131], v194 offset:0
    ds_read_b128 v[132:135], v194 offset:4096
    ds_read_b64_tr_b16 v[136:137], v202 offset:4096
    ds_read_b64_tr_b16 v[138:139], v202 offset:4608
    ds_read_b64_tr_b16 v[140:141], v202 offset:12288
    ds_read_b64_tr_b16 v[142:143], v202 offset:12800
    ds_read_b64_tr_b16 v[144:145], v202 offset:20480
    ds_read_b64_tr_b16 v[146:147], v202 offset:20992
    s_waitcnt lgkmcnt(8)
    v_mfma_f32_32x32x16_bf16 v[32:47], v[156:159], v[148:151], v[32:47]
    v_mfma_f32_32x32x16_bf16 v[48:63], v[148:151], v[160:163], v[48:63]
    v_mfma_f32_32x32x16_bf16 v[64:79], v[148:151], v[164:167], v[64:79]
    v_mfma_f32_32x32x16_bf16 v[80:95], v[156:159], v[152:155], v[80:95]
    v_mfma_f32_32x32x16_bf16 v[96:111], v[152:155], v[160:163], v[96:111]
    v_mfma_f32_32x32x16_bf16 v[112:127], v[152:155], v[164:167], v[112:127]
    ds_read_b128 v[148:151], v195 offset:0
    ds_read_b128 v[152:155], v195 offset:4096
    ds_read_b64_tr_b16 v[156:157], v202 offset:6144
    ds_read_b64_tr_b16 v[158:159], v202 offset:6656
    ds_read_b64_tr_b16 v[160:161], v202 offset:14336
    ds_read_b64_tr_b16 v[162:163], v202 offset:14848
    ds_read_b64_tr_b16 v[164:165], v202 offset:22528
    ds_read_b64_tr_b16 v[166:167], v202 offset:23040
    s_waitcnt lgkmcnt(8)
    v_mfma_f32_32x32x16_bf16 v[32:47], v[136:139], v[128:131], v[32:47]
    v_mfma_f32_32x32x16_bf16 v[48:63], v[128:131], v[140:143], v[48:63]
    v_mfma_f32_32x32x16_bf16 v[64:79], v[128:131], v[144:147], v[64:79]
    v_mfma_f32_32x32x16_bf16 v[80:95], v[136:139], v[132:135], v[80:95]
    v_mfma_f32_32x32x16_bf16 v[96:111], v[132:135], v[140:143], v[96:111]
    v_mfma_f32_32x32x16_bf16 v[112:127], v[132:135], v[144:147], v[112:127]
    s_waitcnt lgkmcnt(0)
    v_mfma_f32_32x32x16_bf16 v[32:47], v[156:159], v[148:151], v[32:47]
    v_mfma_f32_32x32x16_bf16 v[48:63], v[148:151], v[160:163], v[48:63]
    v_mfma_f32_32x32x16_bf16 v[64:79], v[148:151], v[164:167], v[64:79]
    v_mfma_f32_32x32x16_bf16 v[80:95], v[156:159], v[152:155], v[80:95]
    v_mfma_f32_32x32x16_bf16 v[96:111], v[152:155], v[160:163], v[96:111]
    v_mfma_f32_32x32x16_bf16 v[112:127], v[152:155], v[164:167], v[112:127]
    s_waitcnt vmcnt(0)
    s_barrier
    ds_read_b128 v[128:131], v196 offset:0
    ds_read_b128 v[132:135], v196 offset:4096
    ds_read_b64_tr_b16 v[136:137], v203 offset:0
    ds_read_b64_tr_b16 v[138:139], v203 offset:512
    ds_read_b64_tr_b16 v[140:141], v203 offset:8192
    ds_read_b64_tr_b16 v[142:143], v203 offset:8704
    ds_read_b64_tr_b16 v[144:145], v203 offset:16384
    ds_read_b64_tr_b16 v[146:147], v203 offset:16896
    ds_read_b128 v[148:151], v197 offset:0
    ds_read_b128 v[152:155], v197 offset:4096
    ds_read_b64_tr_b16 v[156:157], v203 offset:2048
    ds_read_b64_tr_b16 v[158:159], v203 offset:2560
    ds_read_b64_tr_b16 v[160:161], v203 offset:10240
    ds_read_b64_tr_b16 v[162:163], v203 offset:10752
    ds_read_b64_tr_b16 v[164:165], v203 offset:18432
    ds_read_b64_tr_b16 v[166:167], v203 offset:18944
    s_waitcnt lgkmcnt(8)
    v_mfma_f32_32x32x16_bf16 v[32:47], v[136:139], v[128:131], v[32:47]
    v_mfma_f32_32x32x16_bf16 v[48:63], v[128:131], v[140:143], v[48:63]
    v_mfma_f32_32x32x16_bf16 v[64:79], v[128:131], v[144:147], v[64:79]
    v_mfma_f32_32x32x16_bf16 v[80:95], v[136:139], v[132:135], v[80:95]
    v_mfma_f32_32x32x16_bf16 v[96:111], v[132:135], v[140:143], v[96:111]
    v_mfma_f32_32x32x16_bf16 v[112:127], v[132:135], v[144:147], v[112:127]
    ds_read_b128 v[128:131], v198 offset:0
    ds_read_b128 v[132:135], v198 offset:4096
    ds_read_b64_tr_b16 v[136:137], v203 offset:4096
    ds_read_b64_tr_b16 v[138:139], v203 offset:4608
    ds_read_b64_tr_b16 v[140:141], v203 offset:12288
    ds_read_b64_tr_b16 v[142:143], v203 offset:12800
    ds_read_b64_tr_b16 v[144:145], v203 offset:20480
    ds_read_b64_tr_b16 v[146:147], v203 offset:20992
    s_waitcnt lgkmcnt(8)
    v_mfma_f32_32x32x16_bf16 v[32:47], v[156:159], v[148:151], v[32:47]
    v_mfma_f32_32x32x16_bf16 v[48:63], v[148:151], v[160:163], v[48:63]
    v_mfma_f32_32x32x16_bf16 v[64:79], v[148:151], v[164:167], v[64:79]
    v_mfma_f32_32x32x16_bf16 v[80:95], v[156:159], v[152:155], v[80:95]
    v_mfma_f32_32x32x16_bf16 v[96:111], v[152:155], v[160:163], v[96:111]
    v_mfma_f32_32x32x16_bf16 v[112:127], v[152:155], v[164:167], v[112:127]
    ds_read_b128 v[148:151], v199 offset:0
    ds_read_b128 v[152:155], v199 offset:4096
    ds_read_b64_tr_b16 v[156:157], v203 offset:6144
    ds_read_b64_tr_b16 v[158:159], v203 offset:6656
    ds_read_b64_tr_b16 v[160:161], v203 offset:14336
    ds_read_b64_tr_b16 v[162:163], v203 offset:14848
    ds_read_b64_tr_b16 v[164:165], v203 offset:22528
    ds_read_b64_tr_b16 v[166:167], v203 offset:23040
    s_waitcnt lgkmcnt(8)
    v_mfma_f32_32x32x16_bf16 v[32:47], v[136:139], v[128:131], v[32:47]
    v_mfma_f32_32x32x16_bf16 v[48:63], v[128:131], v[140:143], v[48:63]
    v_mfma_f32_32x32x16_bf16 v[64:79], v[128:131], v[144:147], v[64:79]
    v_mfma_f32_32x32x16_bf16 v[80:95], v[136:139], v[132:135], v[80:95]
    v_mfma_f32_32x32x16_bf16 v[96:111], v[132:135], v[140:143], v[96:111]
    v_mfma_f32_32x32x16_bf16 v[112:127], v[132:135], v[144:147], v[112:127]
    s_waitcnt lgkmcnt(0)
    v_mfma_f32_32x32x16_bf16 v[32:47], v[156:159], v[148:151], v[32:47]
    v_mfma_f32_32x32x16_bf16 v[48:63], v[148:151], v[160:163], v[48:63]
    v_mfma_f32_32x32x16_bf16 v[64:79], v[148:151], v[164:167], v[64:79]
    v_mfma_f32_32x32x16_bf16 v[80:95], v[156:159], v[152:155], v[80:95]
    v_mfma_f32_32x32x16_bf16 v[96:111], v[152:155], v[160:163], v[96:111]
    v_mfma_f32_32x32x16_bf16 v[112:127], v[152:155], v[164:167], v[112:127]
    s_nop 15
    s_nop 7
    v_cvt_pk_bf16_f32 v176, v32, v33
    v_lshlrev_b32 v32, 16, v176
    v_and_b32 v33, 0xffff0000, v176
    v_mul_f32 v176, 1069066811, v32
    v_mul_f32 v177, 1069066811, v33
    v_exp_f32 v176, v176
    v_exp_f32 v177, v177
    v_add_f32 v178, 1.0, v32
    v_add_f32 v179, 1.0, v33
    v_cmp_lt_f32 vcc, 0, v32
    s_nop 1
    v_cndmask_b32 v176, v176, v178, vcc
    v_cmp_lt_f32 vcc, 0, v33
    s_nop 1
    v_cndmask_b32 v177, v177, v179, vcc
    v_cvt_pk_bf16_f32 v178, v176, v177
    v_lshlrev_b32 v176, 16, v178
    v_and_b32 v177, 0xffff0000, v178
    v_add_f32 v32, 0x358637bd, v176
    v_add_f32 v33, 0x358637bd, v177
    v_cvt_pk_bf16_f32 v178, v32, v33
    v_lshlrev_b32 v32, 16, v178
    v_and_b32 v33, 0xffff0000, v178
    v_cvt_pk_bf16_f32 v176, v34, v35
    v_lshlrev_b32 v34, 16, v176
    v_and_b32 v35, 0xffff0000, v176
    v_mul_f32 v176, 1069066811, v34
    v_mul_f32 v177, 1069066811, v35
    v_exp_f32 v176, v176
    v_exp_f32 v177, v177
    v_add_f32 v178, 1.0, v34
    v_add_f32 v179, 1.0, v35
    v_cmp_lt_f32 vcc, 0, v34
    s_nop 1
    v_cndmask_b32 v176, v176, v178, vcc
    v_cmp_lt_f32 vcc, 0, v35
    s_nop 1
    v_cndmask_b32 v177, v177, v179, vcc
    v_cvt_pk_bf16_f32 v178, v176, v177
    v_lshlrev_b32 v176, 16, v178
    v_and_b32 v177, 0xffff0000, v178
    v_add_f32 v34, 0x358637bd, v176
    v_add_f32 v35, 0x358637bd, v177
    v_cvt_pk_bf16_f32 v178, v34, v35
    v_lshlrev_b32 v34, 16, v178
    v_and_b32 v35, 0xffff0000, v178
    v_cvt_pk_bf16_f32 v176, v36, v37
    v_lshlrev_b32 v36, 16, v176
    v_and_b32 v37, 0xffff0000, v176
    v_mul_f32 v176, 1069066811, v36
    v_mul_f32 v177, 1069066811, v37
    v_exp_f32 v176, v176
    v_exp_f32 v177, v177
    v_add_f32 v178, 1.0, v36
    v_add_f32 v179, 1.0, v37
    v_cmp_lt_f32 vcc, 0, v36
    s_nop 1
    v_cndmask_b32 v176, v176, v178, vcc
    v_cmp_lt_f32 vcc, 0, v37
    s_nop 1
    v_cndmask_b32 v177, v177, v179, vcc
    v_cvt_pk_bf16_f32 v178, v176, v177
    v_lshlrev_b32 v176, 16, v178
    v_and_b32 v177, 0xffff0000, v178
    v_add_f32 v36, 0x358637bd, v176
    v_add_f32 v37, 0x358637bd, v177
    v_cvt_pk_bf16_f32 v178, v36, v37
    v_lshlrev_b32 v36, 16, v178
    v_and_b32 v37, 0xffff0000, v178
    v_cvt_pk_bf16_f32 v176, v38, v39
    v_lshlrev_b32 v38, 16, v176
    v_and_b32 v39, 0xffff0000, v176
    v_mul_f32 v176, 1069066811, v38
    v_mul_f32 v177, 1069066811, v39
    v_exp_f32 v176, v176
    v_exp_f32 v177, v177
    v_add_f32 v178, 1.0, v38
    v_add_f32 v179, 1.0, v39
    v_cmp_lt_f32 vcc, 0, v38
    s_nop 1
    v_cndmask_b32 v176, v176, v178, vcc
    v_cmp_lt_f32 vcc, 0, v39
    s_nop 1
    v_cndmask_b32 v177, v177, v179, vcc
    v_cvt_pk_bf16_f32 v178, v176, v177
    v_lshlrev_b32 v176, 16, v178
    v_and_b32 v177, 0xffff0000, v178
    v_add_f32 v38, 0x358637bd, v176
    v_add_f32 v39, 0x358637bd, v177
    v_cvt_pk_bf16_f32 v178, v38, v39
    v_lshlrev_b32 v38, 16, v178
    v_and_b32 v39, 0xffff0000, v178
    v_cvt_pk_bf16_f32 v176, v40, v41
    v_lshlrev_b32 v40, 16, v176
    v_and_b32 v41, 0xffff0000, v176
    v_mul_f32 v176, 1069066811, v40
    v_mul_f32 v177, 1069066811, v41
    v_exp_f32 v176, v176
    v_exp_f32 v177, v177
    v_add_f32 v178, 1.0, v40
    v_add_f32 v179, 1.0, v41
    v_cmp_lt_f32 vcc, 0, v40
    s_nop 1
    v_cndmask_b32 v176, v176, v178, vcc
    v_cmp_lt_f32 vcc, 0, v41
    s_nop 1
    v_cndmask_b32 v177, v177, v179, vcc
    v_cvt_pk_bf16_f32 v178, v176, v177
    v_lshlrev_b32 v176, 16, v178
    v_and_b32 v177, 0xffff0000, v178
    v_add_f32 v40, 0x358637bd, v176
    v_add_f32 v41, 0x358637bd, v177
    v_cvt_pk_bf16_f32 v178, v40, v41
    v_lshlrev_b32 v40, 16, v178
    v_and_b32 v41, 0xffff0000, v178
    v_cvt_pk_bf16_f32 v176, v42, v43
    v_lshlrev_b32 v42, 16, v176
    v_and_b32 v43, 0xffff0000, v176
    v_mul_f32 v176, 1069066811, v42
    v_mul_f32 v177, 1069066811, v43
    v_exp_f32 v176, v176
    v_exp_f32 v177, v177
    v_add_f32 v178, 1.0, v42
    v_add_f32 v179, 1.0, v43
    v_cmp_lt_f32 vcc, 0, v42
    s_nop 1
    v_cndmask_b32 v176, v176, v178, vcc
    v_cmp_lt_f32 vcc, 0, v43
    s_nop 1
    v_cndmask_b32 v177, v177, v179, vcc
    v_cvt_pk_bf16_f32 v178, v176, v177
    v_lshlrev_b32 v176, 16, v178
    v_and_b32 v177, 0xffff0000, v178
    v_add_f32 v42, 0x358637bd, v176
    v_add_f32 v43, 0x358637bd, v177
    v_cvt_pk_bf16_f32 v178, v42, v43
    v_lshlrev_b32 v42, 16, v178
    v_and_b32 v43, 0xffff0000, v178
    v_cvt_pk_bf16_f32 v176, v44, v45
    v_lshlrev_b32 v44, 16, v176
    v_and_b32 v45, 0xffff0000, v176
    v_mul_f32 v176, 1069066811, v44
    v_mul_f32 v177, 1069066811, v45
    v_exp_f32 v176, v176
    v_exp_f32 v177, v177
    v_add_f32 v178, 1.0, v44
    v_add_f32 v179, 1.0, v45
    v_cmp_lt_f32 vcc, 0, v44
    s_nop 1
    v_cndmask_b32 v176, v176, v178, vcc
    v_cmp_lt_f32 vcc, 0, v45
    s_nop 1
    v_cndmask_b32 v177, v177, v179, vcc
    v_cvt_pk_bf16_f32 v178, v176, v177
    v_lshlrev_b32 v176, 16, v178
    v_and_b32 v177, 0xffff0000, v178
    v_add_f32 v44, 0x358637bd, v176
    v_add_f32 v45, 0x358637bd, v177
    v_cvt_pk_bf16_f32 v178, v44, v45
    v_lshlrev_b32 v44, 16, v178
    v_and_b32 v45, 0xffff0000, v178
    v_cvt_pk_bf16_f32 v176, v46, v47
    v_lshlrev_b32 v46, 16, v176
    v_and_b32 v47, 0xffff0000, v176
    v_mul_f32 v176, 1069066811, v46
    v_mul_f32 v177, 1069066811, v47
    v_exp_f32 v176, v176
    v_exp_f32 v177, v177
    v_add_f32 v178, 1.0, v46
    v_add_f32 v179, 1.0, v47
    v_cmp_lt_f32 vcc, 0, v46
    s_nop 1
    v_cndmask_b32 v176, v176, v178, vcc
    v_cmp_lt_f32 vcc, 0, v47
    s_nop 1
    v_cndmask_b32 v177, v177, v179, vcc
    v_cvt_pk_bf16_f32 v178, v176, v177
    v_lshlrev_b32 v176, 16, v178
    v_and_b32 v177, 0xffff0000, v178
    v_add_f32 v46, 0x358637bd, v176
    v_add_f32 v47, 0x358637bd, v177
    v_cvt_pk_bf16_f32 v178, v46, v47
    v_lshlrev_b32 v46, 16, v178
    v_and_b32 v47, 0xffff0000, v178
    v_cvt_pk_bf16_f32 v176, v48, v49
    v_lshlrev_b32 v48, 16, v176
    v_and_b32 v49, 0xffff0000, v176
    v_mul_f32 v176, 1069066811, v48
    v_mul_f32 v177, 1069066811, v49
    v_exp_f32 v176, v176
    v_exp_f32 v177, v177
    v_add_f32 v178, 1.0, v48
    v_add_f32 v179, 1.0, v49
    v_cmp_lt_f32 vcc, 0, v48
    s_nop 1
    v_cndmask_b32 v176, v176, v178, vcc
    v_cmp_lt_f32 vcc, 0, v49
    s_nop 1
    v_cndmask_b32 v177, v177, v179, vcc
    v_cvt_pk_bf16_f32 v178, v176, v177
    v_lshlrev_b32 v176, 16, v178
    v_and_b32 v177, 0xffff0000, v178
    v_add_f32 v48, 0x358637bd, v176
    v_add_f32 v49, 0x358637bd, v177
    v_cvt_pk_bf16_f32 v178, v48, v49
    v_lshlrev_b32 v48, 16, v178
    v_and_b32 v49, 0xffff0000, v178
    v_cvt_pk_bf16_f32 v176, v50, v51
    v_lshlrev_b32 v50, 16, v176
    v_and_b32 v51, 0xffff0000, v176
    v_mul_f32 v176, 1069066811, v50
    v_mul_f32 v177, 1069066811, v51
    v_exp_f32 v176, v176
    v_exp_f32 v177, v177
    v_add_f32 v178, 1.0, v50
    v_add_f32 v179, 1.0, v51
    v_cmp_lt_f32 vcc, 0, v50
    s_nop 1
    v_cndmask_b32 v176, v176, v178, vcc
    v_cmp_lt_f32 vcc, 0, v51
    s_nop 1
    v_cndmask_b32 v177, v177, v179, vcc
    v_cvt_pk_bf16_f32 v178, v176, v177
    v_lshlrev_b32 v176, 16, v178
    v_and_b32 v177, 0xffff0000, v178
    v_add_f32 v50, 0x358637bd, v176
    v_add_f32 v51, 0x358637bd, v177
    v_cvt_pk_bf16_f32 v178, v50, v51
    v_lshlrev_b32 v50, 16, v178
    v_and_b32 v51, 0xffff0000, v178
    v_cvt_pk_bf16_f32 v176, v52, v53
    v_lshlrev_b32 v52, 16, v176
    v_and_b32 v53, 0xffff0000, v176
    v_mul_f32 v176, 1069066811, v52
    v_mul_f32 v177, 1069066811, v53
    v_exp_f32 v176, v176
    v_exp_f32 v177, v177
    v_add_f32 v178, 1.0, v52
    v_add_f32 v179, 1.0, v53
    v_cmp_lt_f32 vcc, 0, v52
    s_nop 1
    v_cndmask_b32 v176, v176, v178, vcc
    v_cmp_lt_f32 vcc, 0, v53
    s_nop 1
    v_cndmask_b32 v177, v177, v179, vcc
    v_cvt_pk_bf16_f32 v178, v176, v177
    v_lshlrev_b32 v176, 16, v178
    v_and_b32 v177, 0xffff0000, v178
    v_add_f32 v52, 0x358637bd, v176
    v_add_f32 v53, 0x358637bd, v177
    v_cvt_pk_bf16_f32 v178, v52, v53
    v_lshlrev_b32 v52, 16, v178
    v_and_b32 v53, 0xffff0000, v178
    v_cvt_pk_bf16_f32 v176, v54, v55
    v_lshlrev_b32 v54, 16, v176
    v_and_b32 v55, 0xffff0000, v176
    v_mul_f32 v176, 1069066811, v54
    v_mul_f32 v177, 1069066811, v55
    v_exp_f32 v176, v176
    v_exp_f32 v177, v177
    v_add_f32 v178, 1.0, v54
    v_add_f32 v179, 1.0, v55
    v_cmp_lt_f32 vcc, 0, v54
    s_nop 1
    v_cndmask_b32 v176, v176, v178, vcc
    v_cmp_lt_f32 vcc, 0, v55
    s_nop 1
    v_cndmask_b32 v177, v177, v179, vcc
    v_cvt_pk_bf16_f32 v178, v176, v177
    v_lshlrev_b32 v176, 16, v178
    v_and_b32 v177, 0xffff0000, v178
    v_add_f32 v54, 0x358637bd, v176
    v_add_f32 v55, 0x358637bd, v177
    v_cvt_pk_bf16_f32 v178, v54, v55
    v_lshlrev_b32 v54, 16, v178
    v_and_b32 v55, 0xffff0000, v178
    v_cvt_pk_bf16_f32 v176, v56, v57
    v_lshlrev_b32 v56, 16, v176
    v_and_b32 v57, 0xffff0000, v176
    v_mul_f32 v176, 1069066811, v56
    v_mul_f32 v177, 1069066811, v57
    v_exp_f32 v176, v176
    v_exp_f32 v177, v177
    v_add_f32 v178, 1.0, v56
    v_add_f32 v179, 1.0, v57
    v_cmp_lt_f32 vcc, 0, v56
    s_nop 1
    v_cndmask_b32 v176, v176, v178, vcc
    v_cmp_lt_f32 vcc, 0, v57
    s_nop 1
    v_cndmask_b32 v177, v177, v179, vcc
    v_cvt_pk_bf16_f32 v178, v176, v177
    v_lshlrev_b32 v176, 16, v178
    v_and_b32 v177, 0xffff0000, v178
    v_add_f32 v56, 0x358637bd, v176
    v_add_f32 v57, 0x358637bd, v177
    v_cvt_pk_bf16_f32 v178, v56, v57
    v_lshlrev_b32 v56, 16, v178
    v_and_b32 v57, 0xffff0000, v178
    v_cvt_pk_bf16_f32 v176, v58, v59
    v_lshlrev_b32 v58, 16, v176
    v_and_b32 v59, 0xffff0000, v176
    v_mul_f32 v176, 1069066811, v58
    v_mul_f32 v177, 1069066811, v59
    v_exp_f32 v176, v176
    v_exp_f32 v177, v177
    v_add_f32 v178, 1.0, v58
    v_add_f32 v179, 1.0, v59
    v_cmp_lt_f32 vcc, 0, v58
    s_nop 1
    v_cndmask_b32 v176, v176, v178, vcc
    v_cmp_lt_f32 vcc, 0, v59
    s_nop 1
    v_cndmask_b32 v177, v177, v179, vcc
    v_cvt_pk_bf16_f32 v178, v176, v177
    v_lshlrev_b32 v176, 16, v178
    v_and_b32 v177, 0xffff0000, v178
    v_add_f32 v58, 0x358637bd, v176
    v_add_f32 v59, 0x358637bd, v177
    v_cvt_pk_bf16_f32 v178, v58, v59
    v_lshlrev_b32 v58, 16, v178
    v_and_b32 v59, 0xffff0000, v178
    v_cvt_pk_bf16_f32 v176, v60, v61
    v_lshlrev_b32 v60, 16, v176
    v_and_b32 v61, 0xffff0000, v176
    v_mul_f32 v176, 1069066811, v60
    v_mul_f32 v177, 1069066811, v61
    v_exp_f32 v176, v176
    v_exp_f32 v177, v177
    v_add_f32 v178, 1.0, v60
    v_add_f32 v179, 1.0, v61
    v_cmp_lt_f32 vcc, 0, v60
    s_nop 1
    v_cndmask_b32 v176, v176, v178, vcc
    v_cmp_lt_f32 vcc, 0, v61
    s_nop 1
    v_cndmask_b32 v177, v177, v179, vcc
    v_cvt_pk_bf16_f32 v178, v176, v177
    v_lshlrev_b32 v176, 16, v178
    v_and_b32 v177, 0xffff0000, v178
    v_add_f32 v60, 0x358637bd, v176
    v_add_f32 v61, 0x358637bd, v177
    v_cvt_pk_bf16_f32 v178, v60, v61
    v_lshlrev_b32 v60, 16, v178
    v_and_b32 v61, 0xffff0000, v178
    v_cvt_pk_bf16_f32 v176, v62, v63
    v_lshlrev_b32 v62, 16, v176
    v_and_b32 v63, 0xffff0000, v176
    v_mul_f32 v176, 1069066811, v62
    v_mul_f32 v177, 1069066811, v63
    v_exp_f32 v176, v176
    v_exp_f32 v177, v177
    v_add_f32 v178, 1.0, v62
    v_add_f32 v179, 1.0, v63
    v_cmp_lt_f32 vcc, 0, v62
    s_nop 1
    v_cndmask_b32 v176, v176, v178, vcc
    v_cmp_lt_f32 vcc, 0, v63
    s_nop 1
    v_cndmask_b32 v177, v177, v179, vcc
    v_cvt_pk_bf16_f32 v178, v176, v177
    v_lshlrev_b32 v176, 16, v178
    v_and_b32 v177, 0xffff0000, v178
    v_add_f32 v62, 0x358637bd, v176
    v_add_f32 v63, 0x358637bd, v177
    v_cvt_pk_bf16_f32 v178, v62, v63
    v_lshlrev_b32 v62, 16, v178
    v_and_b32 v63, 0xffff0000, v178
    v_cvt_pk_bf16_f32 v176, v80, v81
    v_lshlrev_b32 v80, 16, v176
    v_and_b32 v81, 0xffff0000, v176
    v_mul_f32 v176, 1069066811, v80
    v_mul_f32 v177, 1069066811, v81
    v_exp_f32 v176, v176
    v_exp_f32 v177, v177
    v_add_f32 v178, 1.0, v80
    v_add_f32 v179, 1.0, v81
    v_cmp_lt_f32 vcc, 0, v80
    s_nop 1
    v_cndmask_b32 v176, v176, v178, vcc
    v_cmp_lt_f32 vcc, 0, v81
    s_nop 1
    v_cndmask_b32 v177, v177, v179, vcc
    v_cvt_pk_bf16_f32 v178, v176, v177
    v_lshlrev_b32 v176, 16, v178
    v_and_b32 v177, 0xffff0000, v178
    v_add_f32 v80, 0x358637bd, v176
    v_add_f32 v81, 0x358637bd, v177
    v_cvt_pk_bf16_f32 v178, v80, v81
    v_lshlrev_b32 v80, 16, v178
    v_and_b32 v81, 0xffff0000, v178
    v_cvt_pk_bf16_f32 v176, v82, v83
    v_lshlrev_b32 v82, 16, v176
    v_and_b32 v83, 0xffff0000, v176
    v_mul_f32 v176, 1069066811, v82
    v_mul_f32 v177, 1069066811, v83
    v_exp_f32 v176, v176
    v_exp_f32 v177, v177
    v_add_f32 v178, 1.0, v82
    v_add_f32 v179, 1.0, v83
    v_cmp_lt_f32 vcc, 0, v82
    s_nop 1
    v_cndmask_b32 v176, v176, v178, vcc
    v_cmp_lt_f32 vcc, 0, v83
    s_nop 1
    v_cndmask_b32 v177, v177, v179, vcc
    v_cvt_pk_bf16_f32 v178, v176, v177
    v_lshlrev_b32 v176, 16, v178
    v_and_b32 v177, 0xffff0000, v178
    v_add_f32 v82, 0x358637bd, v176
    v_add_f32 v83, 0x358637bd, v177
    v_cvt_pk_bf16_f32 v178, v82, v83
    v_lshlrev_b32 v82, 16, v178
    v_and_b32 v83, 0xffff0000, v178
    v_cvt_pk_bf16_f32 v176, v84, v85
    v_lshlrev_b32 v84, 16, v176
    v_and_b32 v85, 0xffff0000, v176
    v_mul_f32 v176, 1069066811, v84
    v_mul_f32 v177, 1069066811, v85
    v_exp_f32 v176, v176
    v_exp_f32 v177, v177
    v_add_f32 v178, 1.0, v84
    v_add_f32 v179, 1.0, v85
    v_cmp_lt_f32 vcc, 0, v84
    s_nop 1
    v_cndmask_b32 v176, v176, v178, vcc
    v_cmp_lt_f32 vcc, 0, v85
    s_nop 1
    v_cndmask_b32 v177, v177, v179, vcc
    v_cvt_pk_bf16_f32 v178, v176, v177
    v_lshlrev_b32 v176, 16, v178
    v_and_b32 v177, 0xffff0000, v178
    v_add_f32 v84, 0x358637bd, v176
    v_add_f32 v85, 0x358637bd, v177
    v_cvt_pk_bf16_f32 v178, v84, v85
    v_lshlrev_b32 v84, 16, v178
    v_and_b32 v85, 0xffff0000, v178
    v_cvt_pk_bf16_f32 v176, v86, v87
    v_lshlrev_b32 v86, 16, v176
    v_and_b32 v87, 0xffff0000, v176
    v_mul_f32 v176, 1069066811, v86
    v_mul_f32 v177, 1069066811, v87
    v_exp_f32 v176, v176
    v_exp_f32 v177, v177
    v_add_f32 v178, 1.0, v86
    v_add_f32 v179, 1.0, v87
    v_cmp_lt_f32 vcc, 0, v86
    s_nop 1
    v_cndmask_b32 v176, v176, v178, vcc
    v_cmp_lt_f32 vcc, 0, v87
    s_nop 1
    v_cndmask_b32 v177, v177, v179, vcc
    v_cvt_pk_bf16_f32 v178, v176, v177
    v_lshlrev_b32 v176, 16, v178
    v_and_b32 v177, 0xffff0000, v178
    v_add_f32 v86, 0x358637bd, v176
    v_add_f32 v87, 0x358637bd, v177
    v_cvt_pk_bf16_f32 v178, v86, v87
    v_lshlrev_b32 v86, 16, v178
    v_and_b32 v87, 0xffff0000, v178
    v_cvt_pk_bf16_f32 v176, v88, v89
    v_lshlrev_b32 v88, 16, v176
    v_and_b32 v89, 0xffff0000, v176
    v_mul_f32 v176, 1069066811, v88
    v_mul_f32 v177, 1069066811, v89
    v_exp_f32 v176, v176
    v_exp_f32 v177, v177
    v_add_f32 v178, 1.0, v88
    v_add_f32 v179, 1.0, v89
    v_cmp_lt_f32 vcc, 0, v88
    s_nop 1
    v_cndmask_b32 v176, v176, v178, vcc
    v_cmp_lt_f32 vcc, 0, v89
    s_nop 1
    v_cndmask_b32 v177, v177, v179, vcc
    v_cvt_pk_bf16_f32 v178, v176, v177
    v_lshlrev_b32 v176, 16, v178
    v_and_b32 v177, 0xffff0000, v178
    v_add_f32 v88, 0x358637bd, v176
    v_add_f32 v89, 0x358637bd, v177
    v_cvt_pk_bf16_f32 v178, v88, v89
    v_lshlrev_b32 v88, 16, v178
    v_and_b32 v89, 0xffff0000, v178
    v_cvt_pk_bf16_f32 v176, v90, v91
    v_lshlrev_b32 v90, 16, v176
    v_and_b32 v91, 0xffff0000, v176
    v_mul_f32 v176, 1069066811, v90
    v_mul_f32 v177, 1069066811, v91
    v_exp_f32 v176, v176
    v_exp_f32 v177, v177
    v_add_f32 v178, 1.0, v90
    v_add_f32 v179, 1.0, v91
    v_cmp_lt_f32 vcc, 0, v90
    s_nop 1
    v_cndmask_b32 v176, v176, v178, vcc
    v_cmp_lt_f32 vcc, 0, v91
    s_nop 1
    v_cndmask_b32 v177, v177, v179, vcc
    v_cvt_pk_bf16_f32 v178, v176, v177
    v_lshlrev_b32 v176, 16, v178
    v_and_b32 v177, 0xffff0000, v178
    v_add_f32 v90, 0x358637bd, v176
    v_add_f32 v91, 0x358637bd, v177
    v_cvt_pk_bf16_f32 v178, v90, v91
    v_lshlrev_b32 v90, 16, v178
    v_and_b32 v91, 0xffff0000, v178
    v_cvt_pk_bf16_f32 v176, v92, v93
    v_lshlrev_b32 v92, 16, v176
    v_and_b32 v93, 0xffff0000, v176
    v_mul_f32 v176, 1069066811, v92
    v_mul_f32 v177, 1069066811, v93
    v_exp_f32 v176, v176
    v_exp_f32 v177, v177
    v_add_f32 v178, 1.0, v92
    v_add_f32 v179, 1.0, v93
    v_cmp_lt_f32 vcc, 0, v92
    s_nop 1
    v_cndmask_b32 v176, v176, v178, vcc
    v_cmp_lt_f32 vcc, 0, v93
    s_nop 1
    v_cndmask_b32 v177, v177, v179, vcc
    v_cvt_pk_bf16_f32 v178, v176, v177
    v_lshlrev_b32 v176, 16, v178
    v_and_b32 v177, 0xffff0000, v178
    v_add_f32 v92, 0x358637bd, v176
    v_add_f32 v93, 0x358637bd, v177
    v_cvt_pk_bf16_f32 v178, v92, v93
    v_lshlrev_b32 v92, 16, v178
    v_and_b32 v93, 0xffff0000, v178
    v_cvt_pk_bf16_f32 v176, v94, v95
    v_lshlrev_b32 v94, 16, v176
    v_and_b32 v95, 0xffff0000, v176
    v_mul_f32 v176, 1069066811, v94
    v_mul_f32 v177, 1069066811, v95
    v_exp_f32 v176, v176
    v_exp_f32 v177, v177
    v_add_f32 v178, 1.0, v94
    v_add_f32 v179, 1.0, v95
    v_cmp_lt_f32 vcc, 0, v94
    s_nop 1
    v_cndmask_b32 v176, v176, v178, vcc
    v_cmp_lt_f32 vcc, 0, v95
    s_nop 1
    v_cndmask_b32 v177, v177, v179, vcc
    v_cvt_pk_bf16_f32 v178, v176, v177
    v_lshlrev_b32 v176, 16, v178
    v_and_b32 v177, 0xffff0000, v178
    v_add_f32 v94, 0x358637bd, v176
    v_add_f32 v95, 0x358637bd, v177
    v_cvt_pk_bf16_f32 v178, v94, v95
    v_lshlrev_b32 v94, 16, v178
    v_and_b32 v95, 0xffff0000, v178
    v_cvt_pk_bf16_f32 v176, v96, v97
    v_lshlrev_b32 v96, 16, v176
    v_and_b32 v97, 0xffff0000, v176
    v_mul_f32 v176, 1069066811, v96
    v_mul_f32 v177, 1069066811, v97
    v_exp_f32 v176, v176
    v_exp_f32 v177, v177
    v_add_f32 v178, 1.0, v96
    v_add_f32 v179, 1.0, v97
    v_cmp_lt_f32 vcc, 0, v96
    s_nop 1
    v_cndmask_b32 v176, v176, v178, vcc
    v_cmp_lt_f32 vcc, 0, v97
    s_nop 1
    v_cndmask_b32 v177, v177, v179, vcc
    v_cvt_pk_bf16_f32 v178, v176, v177
    v_lshlrev_b32 v176, 16, v178
    v_and_b32 v177, 0xffff0000, v178
    v_add_f32 v96, 0x358637bd, v176
    v_add_f32 v97, 0x358637bd, v177
    v_cvt_pk_bf16_f32 v178, v96, v97
    v_lshlrev_b32 v96, 16, v178
    v_and_b32 v97, 0xffff0000, v178
    v_cvt_pk_bf16_f32 v176, v98, v99
    v_lshlrev_b32 v98, 16, v176
    v_and_b32 v99, 0xffff0000, v176
    v_mul_f32 v176, 1069066811, v98
    v_mul_f32 v177, 1069066811, v99
    v_exp_f32 v176, v176
    v_exp_f32 v177, v177
    v_add_f32 v178, 1.0, v98
    v_add_f32 v179, 1.0, v99
    v_cmp_lt_f32 vcc, 0, v98
    s_nop 1
    v_cndmask_b32 v176, v176, v178, vcc
    v_cmp_lt_f32 vcc, 0, v99
    s_nop 1
    v_cndmask_b32 v177, v177, v179, vcc
    v_cvt_pk_bf16_f32 v178, v176, v177
    v_lshlrev_b32 v176, 16, v178
    v_and_b32 v177, 0xffff0000, v178
    v_add_f32 v98, 0x358637bd, v176
    v_add_f32 v99, 0x358637bd, v177
    v_cvt_pk_bf16_f32 v178, v98, v99
    v_lshlrev_b32 v98, 16, v178
    v_and_b32 v99, 0xffff0000, v178
    v_cvt_pk_bf16_f32 v176, v100, v101
    v_lshlrev_b32 v100, 16, v176
    v_and_b32 v101, 0xffff0000, v176
    v_mul_f32 v176, 1069066811, v100
    v_mul_f32 v177, 1069066811, v101
    v_exp_f32 v176, v176
    v_exp_f32 v177, v177
    v_add_f32 v178, 1.0, v100
    v_add_f32 v179, 1.0, v101
    v_cmp_lt_f32 vcc, 0, v100
    s_nop 1
    v_cndmask_b32 v176, v176, v178, vcc
    v_cmp_lt_f32 vcc, 0, v101
    s_nop 1
    v_cndmask_b32 v177, v177, v179, vcc
    v_cvt_pk_bf16_f32 v178, v176, v177
    v_lshlrev_b32 v176, 16, v178
    v_and_b32 v177, 0xffff0000, v178
    v_add_f32 v100, 0x358637bd, v176
    v_add_f32 v101, 0x358637bd, v177
    v_cvt_pk_bf16_f32 v178, v100, v101
    v_lshlrev_b32 v100, 16, v178
    v_and_b32 v101, 0xffff0000, v178
    v_cvt_pk_bf16_f32 v176, v102, v103
    v_lshlrev_b32 v102, 16, v176
    v_and_b32 v103, 0xffff0000, v176
    v_mul_f32 v176, 1069066811, v102
    v_mul_f32 v177, 1069066811, v103
    v_exp_f32 v176, v176
    v_exp_f32 v177, v177
    v_add_f32 v178, 1.0, v102
    v_add_f32 v179, 1.0, v103
    v_cmp_lt_f32 vcc, 0, v102
    s_nop 1
    v_cndmask_b32 v176, v176, v178, vcc
    v_cmp_lt_f32 vcc, 0, v103
    s_nop 1
    v_cndmask_b32 v177, v177, v179, vcc
    v_cvt_pk_bf16_f32 v178, v176, v177
    v_lshlrev_b32 v176, 16, v178
    v_and_b32 v177, 0xffff0000, v178
    v_add_f32 v102, 0x358637bd, v176
    v_add_f32 v103, 0x358637bd, v177
    v_cvt_pk_bf16_f32 v178, v102, v103
    v_lshlrev_b32 v102, 16, v178
    v_and_b32 v103, 0xffff0000, v178
    v_cvt_pk_bf16_f32 v176, v104, v105
    v_lshlrev_b32 v104, 16, v176
    v_and_b32 v105, 0xffff0000, v176
    v_mul_f32 v176, 1069066811, v104
    v_mul_f32 v177, 1069066811, v105
    v_exp_f32 v176, v176
    v_exp_f32 v177, v177
    v_add_f32 v178, 1.0, v104
    v_add_f32 v179, 1.0, v105
    v_cmp_lt_f32 vcc, 0, v104
    s_nop 1
    v_cndmask_b32 v176, v176, v178, vcc
    v_cmp_lt_f32 vcc, 0, v105
    s_nop 1
    v_cndmask_b32 v177, v177, v179, vcc
    v_cvt_pk_bf16_f32 v178, v176, v177
    v_lshlrev_b32 v176, 16, v178
    v_and_b32 v177, 0xffff0000, v178
    v_add_f32 v104, 0x358637bd, v176
    v_add_f32 v105, 0x358637bd, v177
    v_cvt_pk_bf16_f32 v178, v104, v105
    v_lshlrev_b32 v104, 16, v178
    v_and_b32 v105, 0xffff0000, v178
    v_cvt_pk_bf16_f32 v176, v106, v107
    v_lshlrev_b32 v106, 16, v176
    v_and_b32 v107, 0xffff0000, v176
    v_mul_f32 v176, 1069066811, v106
    v_mul_f32 v177, 1069066811, v107
    v_exp_f32 v176, v176
    v_exp_f32 v177, v177
    v_add_f32 v178, 1.0, v106
    v_add_f32 v179, 1.0, v107
    v_cmp_lt_f32 vcc, 0, v106
    s_nop 1
    v_cndmask_b32 v176, v176, v178, vcc
    v_cmp_lt_f32 vcc, 0, v107
    s_nop 1
    v_cndmask_b32 v177, v177, v179, vcc
    v_cvt_pk_bf16_f32 v178, v176, v177
    v_lshlrev_b32 v176, 16, v178
    v_and_b32 v177, 0xffff0000, v178
    v_add_f32 v106, 0x358637bd, v176
    v_add_f32 v107, 0x358637bd, v177
    v_cvt_pk_bf16_f32 v178, v106, v107
    v_lshlrev_b32 v106, 16, v178
    v_and_b32 v107, 0xffff0000, v178
    v_cvt_pk_bf16_f32 v176, v108, v109
    v_lshlrev_b32 v108, 16, v176
    v_and_b32 v109, 0xffff0000, v176
    v_mul_f32 v176, 1069066811, v108
    v_mul_f32 v177, 1069066811, v109
    v_exp_f32 v176, v176
    v_exp_f32 v177, v177
    v_add_f32 v178, 1.0, v108
    v_add_f32 v179, 1.0, v109
    v_cmp_lt_f32 vcc, 0, v108
    s_nop 1
    v_cndmask_b32 v176, v176, v178, vcc
    v_cmp_lt_f32 vcc, 0, v109
    s_nop 1
    v_cndmask_b32 v177, v177, v179, vcc
    v_cvt_pk_bf16_f32 v178, v176, v177
    v_lshlrev_b32 v176, 16, v178
    v_and_b32 v177, 0xffff0000, v178
    v_add_f32 v108, 0x358637bd, v176
    v_add_f32 v109, 0x358637bd, v177
    v_cvt_pk_bf16_f32 v178, v108, v109
    v_lshlrev_b32 v108, 16, v178
    v_and_b32 v109, 0xffff0000, v178
    v_cvt_pk_bf16_f32 v176, v110, v111
    v_lshlrev_b32 v110, 16, v176
    v_and_b32 v111, 0xffff0000, v176
    v_mul_f32 v176, 1069066811, v110
    v_mul_f32 v177, 1069066811, v111
    v_exp_f32 v176, v176
    v_exp_f32 v177, v177
    v_add_f32 v178, 1.0, v110
    v_add_f32 v179, 1.0, v111
    v_cmp_lt_f32 vcc, 0, v110
    s_nop 1
    v_cndmask_b32 v176, v176, v178, vcc
    v_cmp_lt_f32 vcc, 0, v111
    s_nop 1
    v_cndmask_b32 v177, v177, v179, vcc
    v_cvt_pk_bf16_f32 v178, v176, v177
    v_lshlrev_b32 v176, 16, v178
    v_and_b32 v177, 0xffff0000, v178
    v_add_f32 v110, 0x358637bd, v176
    v_add_f32 v111, 0x358637bd, v177
    v_cvt_pk_bf16_f32 v178, v110, v111
    v_lshlrev_b32 v110, 16, v178
    v_and_b32 v111, 0xffff0000, v178
    v_and_b32 v176, 31, v2
    v_lshlrev_b32 v176, 11, v176
    v_lshrrev_b32 v177, 5, v2
    v_lshlrev_b32 v177, 4, v177
    v_add_u32 v176, v176, v177
    s_lshl_b32 s27, s20, 18
    s_lshl_b32 s28, s22, 17
    s_add_u32 s27, s27, s28
    s_lshl_b32 s28, s21, 7
    s_add_u32 s27, s27, s28
    s_lshl_b32 s28, s23, 6
    s_add_u32 s27, s27, s28
    s_add_u32 s27, s27, 4194304
    v_cvt_pk_bf16_f32 v180, v32, v33
    v_cvt_pk_bf16_f32 v181, v34, v35
    v_cvt_pk_bf16_f32 v182, v36, v37
    v_cvt_pk_bf16_f32 v183, v38, v39
    v_cvt_pk_bf16_f32 v184, v40, v41
    v_cvt_pk_bf16_f32 v185, v42, v43
    v_cvt_pk_bf16_f32 v186, v44, v45
    v_cvt_pk_bf16_f32 v187, v46, v47
    s_nop 1
    v_permlane32_swap_b32 v180, v182
    v_permlane32_swap_b32 v181, v183
    v_permlane32_swap_b32 v184, v186
    v_permlane32_swap_b32 v185, v187
    s_add_u32 s28, s27, 0
    buffer_store_dwordx4 v[180:183], v176, s[16:19], s28 offen
    buffer_store_dwordx4 v[184:187], v176, s[16:19], s28 offen offset:32
    s_nop 1
    v_cvt_pk_bf16_f32 v180, v80, v81
    v_cvt_pk_bf16_f32 v181, v82, v83
    v_cvt_pk_bf16_f32 v182, v84, v85
    v_cvt_pk_bf16_f32 v183, v86, v87
    v_cvt_pk_bf16_f32 v184, v88, v89
    v_cvt_pk_bf16_f32 v185, v90, v91
    v_cvt_pk_bf16_f32 v186, v92, v93
    v_cvt_pk_bf16_f32 v187, v94, v95
    s_nop 1
    v_permlane32_swap_b32 v180, v182
    v_permlane32_swap_b32 v181, v183
    v_permlane32_swap_b32 v184, v186
    v_permlane32_swap_b32 v185, v187
    s_add_u32 s28, s27, 65536
    buffer_store_dwordx4 v[180:183], v176, s[16:19], s28 offen
    buffer_store_dwordx4 v[184:187], v176, s[16:19], s28 offen offset:32
    s_nop 1
    v_mov_b32 v128, 0
    v_mov_b32 v129, 0
    v_mov_b32 v130, 0
    v_mov_b32 v131, 0
    v_mov_b32 v132, 0
    v_mov_b32 v133, 0
    v_mov_b32 v134, 0
    v_mov_b32 v135, 0
    v_mov_b32 v136, 0
    v_mov_b32 v137, 0
    v_mov_b32 v138, 0
    v_mov_b32 v139, 0
    v_mov_b32 v140, 0
    v_mov_b32 v141, 0
    v_mov_b32 v142, 0
    v_mov_b32 v143, 0
    v_mov_b32 v144, 0
    v_mov_b32 v145, 0
    v_mov_b32 v146, 0
    v_mov_b32 v147, 0
    v_mov_b32 v148, 0
    v_mov_b32 v149, 0
    v_mov_b32 v150, 0
    v_mov_b32 v151, 0
    v_mov_b32 v152, 0
    v_mov_b32 v153, 0
    v_mov_b32 v154, 0
    v_mov_b32 v155, 0
    v_mov_b32 v156, 0
    v_mov_b32 v157, 0
    v_mov_b32 v158, 0
    v_mov_b32 v159, 0
    v_mov_b32 v188, 0x3f803f80
    v_mov_b32 v189, 0x3f803f80
    v_mov_b32 v190, 0x3f803f80
    v_mov_b32 v191, 0x3f803f80
    v_cvt_pk_bf16_f32 v160, v48, v49
    v_cvt_pk_bf16_f32 v168, v64, v65
    v_cvt_pk_bf16_f32 v161, v50, v51
    v_cvt_pk_bf16_f32 v169, v66, v67
    v_cvt_pk_bf16_f32 v162, v52, v53
    v_cvt_pk_bf16_f32 v170, v68, v69
    v_cvt_pk_bf16_f32 v163, v54, v55
    v_cvt_pk_bf16_f32 v171, v70, v71
    v_cvt_pk_bf16_f32 v164, v56, v57
    v_cvt_pk_bf16_f32 v172, v72, v73
    v_cvt_pk_bf16_f32 v165, v58, v59
    v_cvt_pk_bf16_f32 v173, v74, v75
    v_cvt_pk_bf16_f32 v166, v60, v61
    v_cvt_pk_bf16_f32 v174, v76, v77
    v_cvt_pk_bf16_f32 v167, v62, v63
    v_cvt_pk_bf16_f32 v175, v78, v79
    s_nop 1
    v_mfma_f32_32x32x16_bf16 v[128:143], v[168:171], v[160:163], v[128:143]
    v_mfma_f32_32x32x16_bf16 v[144:159], v[188:191], v[160:163], v[144:159]
    v_mfma_f32_32x32x16_bf16 v[128:143], v[172:175], v[164:167], v[128:143]
    v_mfma_f32_32x32x16_bf16 v[144:159], v[188:191], v[164:167], v[144:159]
    s_nop 7
    s_nop 7
    v_cvt_pk_bf16_f32 v160, v96, v97
    v_cvt_pk_bf16_f32 v168, v112, v113
    v_cvt_pk_bf16_f32 v161, v98, v99
    v_cvt_pk_bf16_f32 v169, v114, v115
    v_cvt_pk_bf16_f32 v162, v100, v101
    v_cvt_pk_bf16_f32 v170, v116, v117
    v_cvt_pk_bf16_f32 v163, v102, v103
    v_cvt_pk_bf16_f32 v171, v118, v119
    v_cvt_pk_bf16_f32 v164, v104, v105
    v_cvt_pk_bf16_f32 v172, v120, v121
    v_cvt_pk_bf16_f32 v165, v106, v107
    v_cvt_pk_bf16_f32 v173, v122, v123
    v_cvt_pk_bf16_f32 v166, v108, v109
    v_cvt_pk_bf16_f32 v174, v124, v125
    v_cvt_pk_bf16_f32 v167, v110, v111
    v_cvt_pk_bf16_f32 v175, v126, v127
    s_nop 1
    v_mfma_f32_32x32x16_bf16 v[128:143], v[168:171], v[160:163], v[128:143]
    v_mfma_f32_32x32x16_bf16 v[144:159], v[188:191], v[160:163], v[144:159]
    v_mfma_f32_32x32x16_bf16 v[128:143], v[172:175], v[164:167], v[128:143]
    v_mfma_f32_32x32x16_bf16 v[144:159], v[188:191], v[164:167], v[144:159]
    s_nop 7
    s_nop 7
    s_barrier
    s_nop 15
    v_lshlrev_b32 v176, 2, v2
    s_lshl_b32 s28, s23, 13
    v_add_u32 v176, s28, v176
    s_cmp_eq_u32 s22, 0
    s_cbranch_scc1 L_k1_wm0_k1b_kernel
    ds_write_b32 v176, v128 offset:0
    ds_write_b32 v176, v129 offset:256
    ds_write_b32 v176, v130 offset:512
    ds_write_b32 v176, v131 offset:768
    ds_write_b32 v176, v132 offset:1024
    ds_write_b32 v176, v133 offset:1280
    ds_write_b32 v176, v134 offset:1536
    ds_write_b32 v176, v135 offset:1792
    ds_write_b32 v176, v136 offset:2048
    ds_write_b32 v176, v137 offset:2304
    ds_write_b32 v176, v138 offset:2560
    ds_write_b32 v176, v139 offset:2816
    ds_write_b32 v176, v140 offset:3072
    ds_write_b32 v176, v141 offset:3328
    ds_write_b32 v176, v142 offset:3584
    ds_write_b32 v176, v143 offset:3840
    ds_write_b32 v176, v144 offset:4096
    s_waitcnt lgkmcnt(0)
    s_barrier
    s_endpgm
L_k1_wm0_k1b_kernel:
    s_barrier
    ds_read_b32 v160, v176 offset:0
    ds_read_b32 v161, v176 offset:256
    ds_read_b32 v162, v176 offset:512
    ds_read_b32 v163, v176 offset:768
    ds_read_b32 v164, v176 offset:1024
    ds_read_b32 v165, v176 offset:1280
    ds_read_b32 v166, v176 offset:1536
    ds_read_b32 v167, v176 offset:1792
    ds_read_b32 v168, v176 offset:2048
    ds_read_b32 v169, v176 offset:2304
    ds_read_b32 v170, v176 offset:2560
    ds_read_b32 v171, v176 offset:2816
    ds_read_b32 v172, v176 offset:3072
    ds_read_b32 v173, v176 offset:3328
    ds_read_b32 v174, v176 offset:3584
    ds_read_b32 v175, v176 offset:3840
    ds_read_b32 v177, v176 offset:4096
    s_waitcnt lgkmcnt(0)
    v_add_f32 v128, v128, v160
    v_add_f32 v129, v129, v161
    v_add_f32 v130, v130, v162
    v_add_f32 v131, v131, v163
    v_add_f32 v132, v132, v164
    v_add_f32 v133, v133, v165
    v_add_f32 v134, v134, v166
    v_add_f32 v135, v135, v167
    v_add_f32 v136, v136, v168
    v_add_f32 v137, v137, v169
    v_add_f32 v138, v138, v170
    v_add_f32 v139, v139, v171
    v_add_f32 v140, v140, v172
    v_add_f32 v141, v141, v173
    v_add_f32 v142, v142, v174
    v_add_f32 v143, v143, v175
    v_add_f32 v144, v144, v177
    s_lshl_b32 s27, s21, 1
    s_add_u32 s27, s27, s23
    s_lshl_b32 s27, s27, 4
    s_add_u32 s27, s27, s20
    s_mul_i32 s27, s27, 4224
    s_add_u32 s27, s27, 20971520
    v_and_b32 v176, 31, v2
    v_lshlrev_b32 v176, 2, v176
    v_lshrrev_b32 v178, 5, v2
    v_lshlrev_b32 v178, 9, v178
    v_add_u32 v178, v176, v178
    buffer_store_dword v128, v178, s[16:19], s27 offen offset:0
    buffer_store_dword v129, v178, s[16:19], s27 offen offset:128
    buffer_store_dword v130, v178, s[16:19], s27 offen offset:256
    buffer_store_dword v131, v178, s[16:19], s27 offen offset:384
    buffer_store_dword v132, v178, s[16:19], s27 offen offset:1024
    buffer_store_dword v133, v178, s[16:19], s27 offen offset:1152
    buffer_store_dword v134, v178, s[16:19], s27 offen offset:1280
    buffer_store_dword v135, v178, s[16:19], s27 offen offset:1408
    buffer_store_dword v136, v178, s[16:19], s27 offen offset:2048
    buffer_store_dword v137, v178, s[16:19], s27 offen offset:2176
    buffer_store_dword v138, v178, s[16:19], s27 offen offset:2304
    buffer_store_dword v139, v178, s[16:19], s27 offen offset:2432
    buffer_store_dword v140, v178, s[16:19], s27 offen offset:3072
    buffer_store_dword v141, v178, s[16:19], s27 offen offset:3200
    buffer_store_dword v142, v178, s[16:19], s27 offen offset:3328
    buffer_store_dword v143, v178, s[16:19], s27 offen offset:3456
    s_add_u32 s28, s27, 4096
    buffer_store_dword v144, v176, s[16:19], s28 offen
    s_endpgm
L_end_k1b_kernel:
    s_endpgm
.text
.globl kmidb_kernel
.p2align 8
.type kmidb_kernel,@function
kmidb_kernel:
    s_cmp_ge_u32 s2, 256
    s_cbranch_scc1 L_end_kmidb_kernel
    s_load_dwordx2 s[4:5], s[0:1], 80
    s_load_dwordx2 s[6:7], s[0:1], 32
    v_lshrrev_b32 v1, 6, v0
    v_and_b32 v2, 63, v0
    s_nop 0
    v_readfirstlane_b32 s3, v1
    s_and_b32 s20, s2, 15
    s_lshr_b32 s21, s2, 4
    s_waitcnt lgkmcnt(0)
    s_mov_b32 s16, s4
    s_mov_b32 s17, s5
    s_mov_b32 s18, 29360128
    s_mov_b32 s19, 0x00020000
    s_mov_b32 s8, s6
    s_mov_b32 s9, s7
    s_mov_b32 s10, 2048
    s_mov_b32 s11, 0x00020000
    s_cmp_ge_u32 s2, 24
    s_cbranch_scc1 L_nz_kmidb_kernel
    v_lshlrev_b32 v4, 2, v0
    v_mov_b32 v5, 0
    s_lshl_b32 s22, s2, 10
    s_add_u32 s22, s22, 24117248
    buffer_store_dword v5, v4, s[16:19], s22 offen
L_nz_kmidb_kernel:
    s_cmp_lg_u32 s2, 255
    s_cbranch_scc1 L_nw_kmidb_kernel
    s_cmp_lg_u32 s3, 0
    s_cbranch_scc1 L_nw_kmidb_kernel
    v_lshlrev_b32 v4, 4, v2
    buffer_load_dwordx4 v[8:11], v4, s[8:11], 0 offen
    buffer_load_dwordx4 v[12:15], v4, s[8:11], 0 offen offset:1024
    s_waitcnt vmcnt(0)
    v_mov_b32 v5, 0
    v_lshlrev_b32 v6, 16, v8
    v_and_b32 v7, 0xffff0000, v8
    v_add_f32 v5, v5, v6
    v_add_f32 v5, v5, v7
    v_lshlrev_b32 v6, 16, v9
    v_and_b32 v7, 0xffff0000, v9
    v_add_f32 v5, v5, v6
    v_add_f32 v5, v5, v7
    v_lshlrev_b32 v6, 16, v10
    v_and_b32 v7, 0xffff0000, v10
    v_add_f32 v5, v5, v6
    v_add_f32 v5, v5, v7
    v_lshlrev_b32 v6, 16, v11
    v_and_b32 v7, 0xffff0000, v11
    v_add_f32 v5, v5, v6
    v_add_f32 v5, v5, v7
    v_lshlrev_b32 v6, 16, v12
    v_and_b32 v7, 0xffff0000, v12
    v_add_f32 v5, v5, v6
    v_add_f32 v5, v5, v7
    v_lshlrev_b32 v6, 16, v13
    v_and_b32 v7, 0xffff0000, v13
    v_add_f32 v5, v5, v6
    v_add_f32 v5, v5, v7
    v_lshlrev_b32 v6, 16, v14
    v_and_b32 v7, 0xffff0000, v14
    v_add_f32 v5, v5, v6
    v_add_f32 v5, v5, v7
    v_lshlrev_b32 v6, 16, v15
    v_and_b32 v7, 0xffff0000, v15
    v_add_f32 v5, v5, v6
    v_add_f32 v5, v5, v7
    s_nop 1
    v_add_f32_dpp v5, v5, v5 quad_perm:[1,0,3,2] row_mask:0xf bank_mask:0xf
    s_nop 1
    v_add_f32_dpp v5, v5, v5 quad_perm:[2,3,0,1] row_mask:0xf bank_mask:0xf
    s_nop 1
    v_add_f32_dpp v5, v5, v5 row_half_mirror row_mask:0xf bank_mask:0xf
    s_nop 1
    v_add_f32_dpp v5, v5, v5 row_mirror row_mask:0xf bank_mask:0xf
    s_nop 1
    v_readlane_b32 s60, v5, 0
    v_readlane_b32 s61, v5, 16
    v_readlane_b32 s62, v5, 32
    v_readlane_b32 s63, v5, 48
    s_nop 1
    v_mov_b32 v5, s60
    v_add_f32 v5, s61, v5
    v_add_f32 v5, s62, v5
    v_add_f32 v5, s63, v5
    v_mov_b32 v4, 0
    s_mov_b32 s22, 24182784
    buffer_store_dword v5, v4, s[16:19], s22 offen
L_nw_kmidb_kernel:
    v_lshlrev_b32 v4, 4, v0
    v_and_b32 v5, 31, v0
    v_lshlrev_b32 v5, 2, v5
    s_lshl_b32 s22, s20, 1
    s_add_u32 s22, s22, 0
    s_mul_i32 s22, s22, 67584
    s_add_u32 s22, s22, 20971520
    s_add_u32 s23, s22, 4096
    buffer_load_dwordx4 v[32:35], v4, s[16:19], s22 offen
    buffer_load_dword v96, v5, s[16:19], s23 offen
    s_add_u32 s22, s22, 4224
    s_add_u32 s23, s23, 4224
    buffer_load_dwordx4 v[36:39], v4, s[16:19], s22 offen
    buffer_load_dword v97, v5, s[16:19], s23 offen
    s_add_u32 s22, s22, 4224
    s_add_u32 s23, s23, 4224
    buffer_load_dwordx4 v[40:43], v4, s[16:19], s22 offen
    buffer_load_dword v98, v5, s[16:19], s23 offen
    s_add_u32 s22, s22, 4224
    s_add_u32 s23, s23, 4224
    buffer_load_dwordx4 v[44:47], v4, s[16:19], s22 offen
    buffer_load_dword v99, v5, s[16:19], s23 offen
    s_add_u32 s22, s22, 4224
    s_add_u32 s23, s23, 4224
    buffer_load_dwordx4 v[48:51], v4, s[16:19], s22 offen
    buffer_load_dword v100, v5, s[16:19], s23 offen
    s_add_u32 s22, s22, 4224
    s_add_u32 s23, s23, 4224
    buffer_load_dwordx4 v[52:55], v4, s[16:19], s22 offen
    buffer_load_dword v101, v5, s[16:19], s23 offen
    s_add_u32 s22, s22, 4224
    s_add_u32 s23, s23, 4224
    buffer_load_dwordx4 v[56:59], v4, s[16:19], s22 offen
    buffer_load_dword v102, v5, s[16:19], s23 offen
    s_add_u32 s22, s22, 4224
    s_add_u32 s23, s23, 4224
    buffer_load_dwordx4 v[60:63], v4, s[16:19], s22 offen
    buffer_load_dword v103, v5, s[16:19], s23 offen
    s_add_u32 s22, s22, 4224
    s_add_u32 s23, s23, 4224
    buffer_load_dwordx4 v[64:67], v4, s[16:19], s22 offen
    buffer_load_dword v104, v5, s[16:19], s23 offen
    s_add_u32 s22, s22, 4224
    s_add_u32 s23, s23, 4224
    buffer_load_dwordx4 v[68:71], v4, s[16:19], s22 offen
    buffer_load_dword v105, v5, s[16:19], s23 offen
    s_add_u32 s22, s22, 4224
    s_add_u32 s23, s23, 4224
    buffer_load_dwordx4 v[72:75], v4, s[16:19], s22 offen
    buffer_load_dword v106, v5, s[16:19], s23 offen
    s_add_u32 s22, s22, 4224
    s_add_u32 s23, s23, 4224
    buffer_load_dwordx4 v[76:79], v4, s[16:19], s22 offen
    buffer_load_dword v107, v5, s[16:19], s23 offen
    s_add_u32 s22, s22, 4224
    s_add_u32 s23, s23, 4224
    buffer_load_dwordx4 v[80:83], v4, s[16:19], s22 offen
    buffer_load_dword v108, v5, s[16:19], s23 offen
    s_add_u32 s22, s22, 4224
    s_add_u32 s23, s23, 4224
    buffer_load_dwordx4 v[84:87], v4, s[16:19], s22 offen
    buffer_load_dword v109, v5, s[16:19], s23 offen
    s_add_u32 s22, s22, 4224
    s_add_u32 s23, s23, 4224
    buffer_load_dwordx4 v[88:91], v4, s[16:19], s22 offen
    buffer_load_dword v110, v5, s[16:19], s23 offen
    s_add_u32 s22, s22, 4224
    s_add_u32 s23, s23, 4224
    buffer_load_dwordx4 v[92:95], v4, s[16:19], s22 offen
    buffer_load_dword v111, v5, s[16:19], s23 offen
    s_waitcnt vmcnt(0)
    v_add_f32 v32, v32, v36
    v_add_f32 v33, v33, v37
    v_add_f32 v34, v34, v38
    v_add_f32 v35, v35, v39
    v_add_f32 v96, v96, v97
    v_add_f32 v32, v32, v40
    v_add_f32 v33, v33, v41
    v_add_f32 v34, v34, v42
    v_add_f32 v35, v35, v43
    v_add_f32 v96, v96, v98
    v_add_f32 v32, v32, v44
    v_add_f32 v33, v33, v45
    v_add_f32 v34, v34, v46
    v_add_f32 v35, v35, v47
    v_add_f32 v96, v96, v99
    v_add_f32 v32, v32, v48
    v_add_f32 v33, v33, v49
    v_add_f32 v34, v34, v50
    v_add_f32 v35, v35, v51
    v_add_f32 v96, v96, v100
    v_add_f32 v32, v32, v52
    v_add_f32 v33, v33, v53
    v_add_f32 v34, v34, v54
    v_add_f32 v35, v35, v55
    v_add_f32 v96, v96, v101
    v_add_f32 v32, v32, v56
    v_add_f32 v33, v33, v57
    v_add_f32 v34, v34, v58
    v_add_f32 v35, v35, v59
    v_add_f32 v96, v96, v102
    v_add_f32 v32, v32, v60
    v_add_f32 v33, v33, v61
    v_add_f32 v34, v34, v62
    v_add_f32 v35, v35, v63
    v_add_f32 v96, v96, v103
    v_add_f32 v32, v32, v64
    v_add_f32 v33, v33, v65
    v_add_f32 v34, v34, v66
    v_add_f32 v35, v35, v67
    v_add_f32 v96, v96, v104
    v_add_f32 v32, v32, v68
    v_add_f32 v33, v33, v69
    v_add_f32 v34, v34, v70
    v_add_f32 v35, v35, v71
    v_add_f32 v96, v96, v105
    v_add_f32 v32, v32, v72
    v_add_f32 v33, v33, v73
    v_add_f32 v34, v34, v74
    v_add_f32 v35, v35, v75
    v_add_f32 v96, v96, v106
    v_add_f32 v32, v32, v76
    v_add_f32 v33, v33, v77
    v_add_f32 v34, v34, v78
    v_add_f32 v35, v35, v79
    v_add_f32 v96, v96, v107
    v_add_f32 v32, v32, v80
    v_add_f32 v33, v33, v81
    v_add_f32 v34, v34, v82
    v_add_f32 v35, v35, v83
    v_add_f32 v96, v96, v108
    v_add_f32 v32, v32, v84
    v_add_f32 v33, v33, v85
    v_add_f32 v34, v34, v86
    v_add_f32 v35, v35, v87
    v_add_f32 v96, v96, v109
    v_add_f32 v32, v32, v88
    v_add_f32 v33, v33, v89
    v_add_f32 v34, v34, v90
    v_add_f32 v35, v35, v91
    v_add_f32 v96, v96, v110
    v_add_f32 v32, v32, v92
    v_add_f32 v33, v33, v93
    v_add_f32 v34, v34, v94
    v_add_f32 v35, v35, v95
    v_add_f32 v96, v96, v111
    v_cvt_pk_bf16_f32 v8, v32, v33
    v_cvt_pk_bf16_f32 v9, v34, v35
    v_lshlrev_b32 v10, 3, v0
    ds_write_b64 v10, v[8:9] offset:0
    v_cvt_pk_bf16_f32 v8, v96, v96
    v_and_b32 v10, 31, v0
    v_lshlrev_b32 v10, 1, v10
    ds_write_b16 v10, v8 offset:4096
    s_lshl_b32 s22, s20, 1
    s_add_u32 s22, s22, 1
    s_mul_i32 s22, s22, 67584
    s_add_u32 s22, s22, 20971520
    s_add_u32 s23, s22, 4096
    buffer_load_dwordx4 v[32:35], v4, s[16:19], s22 offen
    buffer_load_dword v96, v5, s[16:19], s23 offen
    s_add_u32 s22, s22, 4224
    s_add_u32 s23, s23, 4224
    buffer_load_dwordx4 v[36:39], v4, s[16:19], s22 offen
    buffer_load_dword v97, v5, s[16:19], s23 offen
    s_add_u32 s22, s22, 4224
    s_add_u32 s23, s23, 4224
    buffer_load_dwordx4 v[40:43], v4, s[16:19], s22 offen
    buffer_load_dword v98, v5, s[16:19], s23 offen
    s_add_u32 s22, s22, 4224
    s_add_u32 s23, s23, 4224
    buffer_load_dwordx4 v[44:47], v4, s[16:19], s22 offen
    buffer_load_dword v99, v5, s[16:19], s23 offen
    s_add_u32 s22, s22, 4224
    s_add_u32 s23, s23, 4224
    buffer_load_dwordx4 v[48:51], v4, s[16:19], s22 offen
    buffer_load_dword v100, v5, s[16:19], s23 offen
    s_add_u32 s22, s22, 4224
    s_add_u32 s23, s23, 4224
    buffer_load_dwordx4 v[52:55], v4, s[16:19], s22 offen
    buffer_load_dword v101, v5, s[16:19], s23 offen
    s_add_u32 s22, s22, 4224
    s_add_u32 s23, s23, 4224
    buffer_load_dwordx4 v[56:59], v4, s[16:19], s22 offen
    buffer_load_dword v102, v5, s[16:19], s23 offen
    s_add_u32 s22, s22, 4224
    s_add_u32 s23, s23, 4224
    buffer_load_dwordx4 v[60:63], v4, s[16:19], s22 offen
    buffer_load_dword v103, v5, s[16:19], s23 offen
    s_add_u32 s22, s22, 4224
    s_add_u32 s23, s23, 4224
    buffer_load_dwordx4 v[64:67], v4, s[16:19], s22 offen
    buffer_load_dword v104, v5, s[16:19], s23 offen
    s_add_u32 s22, s22, 4224
    s_add_u32 s23, s23, 4224
    buffer_load_dwordx4 v[68:71], v4, s[16:19], s22 offen
    buffer_load_dword v105, v5, s[16:19], s23 offen
    s_add_u32 s22, s22, 4224
    s_add_u32 s23, s23, 4224
    buffer_load_dwordx4 v[72:75], v4, s[16:19], s22 offen
    buffer_load_dword v106, v5, s[16:19], s23 offen
    s_add_u32 s22, s22, 4224
    s_add_u32 s23, s23, 4224
    buffer_load_dwordx4 v[76:79], v4, s[16:19], s22 offen
    buffer_load_dword v107, v5, s[16:19], s23 offen
    s_add_u32 s22, s22, 4224
    s_add_u32 s23, s23, 4224
    buffer_load_dwordx4 v[80:83], v4, s[16:19], s22 offen
    buffer_load_dword v108, v5, s[16:19], s23 offen
    s_add_u32 s22, s22, 4224
    s_add_u32 s23, s23, 4224
    buffer_load_dwordx4 v[84:87], v4, s[16:19], s22 offen
    buffer_load_dword v109, v5, s[16:19], s23 offen
    s_add_u32 s22, s22, 4224
    s_add_u32 s23, s23, 4224
    buffer_load_dwordx4 v[88:91], v4, s[16:19], s22 offen
    buffer_load_dword v110, v5, s[16:19], s23 offen
    s_add_u32 s22, s22, 4224
    s_add_u32 s23, s23, 4224
    buffer_load_dwordx4 v[92:95], v4, s[16:19], s22 offen
    buffer_load_dword v111, v5, s[16:19], s23 offen
    s_waitcnt vmcnt(0)
    v_add_f32 v32, v32, v36
    v_add_f32 v33, v33, v37
    v_add_f32 v34, v34, v38
    v_add_f32 v35, v35, v39
    v_add_f32 v96, v96, v97
    v_add_f32 v32, v32, v40
    v_add_f32 v33, v33, v41
    v_add_f32 v34, v34, v42
    v_add_f32 v35, v35, v43
    v_add_f32 v96, v96, v98
    v_add_f32 v32, v32, v44
    v_add_f32 v33, v33, v45
    v_add_f32 v34, v34, v46
    v_add_f32 v35, v35, v47
    v_add_f32 v96, v96, v99
    v_add_f32 v32, v32, v48
    v_add_f32 v33, v33, v49
    v_add_f32 v34, v34, v50
    v_add_f32 v35, v35, v51
    v_add_f32 v96, v96, v100
    v_add_f32 v32, v32, v52
    v_add_f32 v33, v33, v53
    v_add_f32 v34, v34, v54
    v_add_f32 v35, v35, v55
    v_add_f32 v96, v96, v101
    v_add_f32 v32, v32, v56
    v_add_f32 v33, v33, v57
    v_add_f32 v34, v34, v58
    v_add_f32 v35, v35, v59
    v_add_f32 v96, v96, v102
    v_add_f32 v32, v32, v60
    v_add_f32 v33, v33, v61
    v_add_f32 v34, v34, v62
    v_add_f32 v35, v35, v63
    v_add_f32 v96, v96, v103
    v_add_f32 v32, v32, v64
    v_add_f32 v33, v33, v65
    v_add_f32 v34, v34, v66
    v_add_f32 v35, v35, v67
    v_add_f32 v96, v96, v104
    v_add_f32 v32, v32, v68
    v_add_f32 v33, v33, v69
    v_add_f32 v34, v34, v70
    v_add_f32 v35, v35, v71
    v_add_f32 v96, v96, v105
    v_add_f32 v32, v32, v72
    v_add_f32 v33, v33, v73
    v_add_f32 v34, v34, v74
    v_add_f32 v35, v35, v75
    v_add_f32 v96, v96, v106
    v_add_f32 v32, v32, v76
    v_add_f32 v33, v33, v77
    v_add_f32 v34, v34, v78
    v_add_f32 v35, v35, v79
    v_add_f32 v96, v96, v107
    v_add_f32 v32, v32, v80
    v_add_f32 v33, v33, v81
    v_add_f32 v34, v34, v82
    v_add_f32 v35, v35, v83
    v_add_f32 v96, v96, v108
    v_add_f32 v32, v32, v84
    v_add_f32 v33, v33, v85
    v_add_f32 v34, v34, v86
    v_add_f32 v35, v35, v87
    v_add_f32 v96, v96, v109
    v_add_f32 v32, v32, v88
    v_add_f32 v33, v33, v89
    v_add_f32 v34, v34, v90
    v_add_f32 v35, v35, v91
    v_add_f32 v96, v96, v110
    v_add_f32 v32, v32, v92
    v_add_f32 v33, v33, v93
    v_add_f32 v34, v34, v94
    v_add_f32 v35, v35, v95
    v_add_f32 v96, v96, v111
    v_cvt_pk_bf16_f32 v8, v32, v33
    v_cvt_pk_bf16_f32 v9, v34, v35
    v_lshlrev_b32 v10, 3, v0
    ds_write_b64 v10, v[8:9] offset:2048
    v_cvt_pk_bf16_f32 v8, v96, v96
    v_and_b32 v10, 31, v0
    v_lshlrev_b32 v10, 1, v10
    ds_write_b16 v10, v8 offset:4160
    v_and_b32 v4, 31, v2
    v_lshlrev_b32 v4, 11, v4
    v_lshrrev_b32 v5, 5, v2
    v_lshlrev_b32 v5, 4, v5
    v_add_u32 v4, v4, v5
    s_lshl_b32 s24, s21, 18
    s_lshl_b32 s25, s3, 16
    s_add_u32 s24, s24, s25
    s_lshl_b32 s25, s20, 7
    s_add_u32 s24, s24, s25
    s_add_u32 s26, s24, 4194304
    buffer_load_dwordx4 v[32:35], v4, s[16:19], s26 offen offset:0
    buffer_load_dwordx4 v[36:39], v4, s[16:19], s26 offen offset:32
    buffer_load_dwordx4 v[40:43], v4, s[16:19], s26 offen offset:64
    buffer_load_dwordx4 v[44:47], v4, s[16:19], s26 offen offset:96
    s_waitcnt lgkmcnt(0)
    s_barrier
    v_and_b32 v6, 31, v2
    v_lshlrev_b32 v6, 6, v6
    v_add_u32 v6, v6, v5
    ds_read_b128 v[48:51], v6 offset:0
    ds_read_b128 v[64:67], v5 offset:4096
    ds_read_b128 v[52:55], v6 offset:32
    ds_read_b128 v[68:71], v5 offset:4128
    ds_read_b128 v[56:59], v6 offset:2048
    ds_read_b128 v[72:75], v5 offset:4160
    ds_read_b128 v[60:63], v6 offset:2080
    ds_read_b128 v[76:79], v5 offset:4192
    v_mov_b32 v80, 0
    v_mov_b32 v81, 0
    v_mov_b32 v82, 0
    v_mov_b32 v83, 0
    v_mov_b32 v84, 0
    v_mov_b32 v85, 0
    v_mov_b32 v86, 0
    v_mov_b32 v87, 0
    v_mov_b32 v88, 0
    v_mov_b32 v89, 0
    v_mov_b32 v90, 0
    v_mov_b32 v91, 0
    v_mov_b32 v92, 0
    v_mov_b32 v93, 0
    v_mov_b32 v94, 0
    v_mov_b32 v95, 0
    v_mov_b32 v96, 0
    v_mov_b32 v97, 0
    v_mov_b32 v98, 0
    v_mov_b32 v99, 0
    v_mov_b32 v100, 0
    v_mov_b32 v101, 0
    v_mov_b32 v102, 0
    v_mov_b32 v103, 0
    v_mov_b32 v104, 0
    v_mov_b32 v105, 0
    v_mov_b32 v106, 0
    v_mov_b32 v107, 0
    v_mov_b32 v108, 0
    v_mov_b32 v109, 0
    v_mov_b32 v110, 0
    v_mov_b32 v111, 0
    v_mov_b32 v112, 0
    v_mov_b32 v113, 0
    v_mov_b32 v114, 0
    v_mov_b32 v115, 0
    v_mov_b32 v116, 0
    v_mov_b32 v117, 0
    v_mov_b32 v118, 0
    v_mov_b32 v119, 0
    v_mov_b32 v120, 0
    v_mov_b32 v121, 0
    v_mov_b32 v122, 0
    v_mov_b32 v123, 0
    v_mov_b32 v124, 0
    v_mov_b32 v125, 0
    v_mov_b32 v126, 0
    v_mov_b32 v127, 0
    v_mov_b32 v128, 0
    v_mov_b32 v129, 0
    v_mov_b32 v130, 0
    v_mov_b32 v131, 0
    v_mov_b32 v132, 0
    v_mov_b32 v133, 0
    v_mov_b32 v134, 0
    v_mov_b32 v135, 0
    v_mov_b32 v136, 0
    v_mov_b32 v137, 0
    v_mov_b32 v138, 0
    v_mov_b32 v139, 0
    v_mov_b32 v140, 0
    v_mov_b32 v141, 0
    v_mov_b32 v142, 0
    v_mov_b32 v143, 0
    s_waitcnt vmcnt(0) lgkmcnt(0)
    s_nop 1
    v_mfma_f32_32x32x16_bf16 v[80:95], v[48:51], v[32:35], v[80:95]
    v_mfma_f32_32x32x16_bf16 v[96:111], v[64:67], v[32:35], v[96:111]
    v_mfma_f32_32x32x16_bf16 v[80:95], v[52:55], v[36:39], v[80:95]
    v_mfma_f32_32x32x16_bf16 v[96:111], v[68:71], v[36:39], v[96:111]
    v_mfma_f32_32x32x16_bf16 v[112:127], v[56:59], v[40:43], v[112:127]
    v_mfma_f32_32x32x16_bf16 v[128:143], v[72:75], v[40:43], v[128:143]
    v_mfma_f32_32x32x16_bf16 v[112:127], v[60:63], v[44:47], v[112:127]
    v_mfma_f32_32x32x16_bf16 v[128:143], v[76:79], v[44:47], v[128:143]
    s_nop 15
    s_nop 3
    s_add_u32 s26, s24, 8388608
    v_cvt_pk_bf16_f32 v8, v96, v96
    v_lshlrev_b32 v96, 16, v8
    v_add_f32 v96, 0x358637bd, v96
    v_cvt_pk_bf16_f32 v8, v96, v96
    v_lshlrev_b32 v96, 16, v8
    v_rcp_f32 v96, v96
    s_nop 0
    v_cvt_pk_bf16_f32 v8, v80, v81
    v_lshlrev_b32 v80, 16, v8
    v_and_b32 v81, 0xffff0000, v8
    v_mul_f32 v80, v80, v96
    v_mul_f32 v81, v81, v96
    v_cvt_pk_bf16_f32 v8, v82, v83
    v_lshlrev_b32 v82, 16, v8
    v_and_b32 v83, 0xffff0000, v8
    v_mul_f32 v82, v82, v96
    v_mul_f32 v83, v83, v96
    v_cvt_pk_bf16_f32 v8, v84, v85
    v_lshlrev_b32 v84, 16, v8
    v_and_b32 v85, 0xffff0000, v8
    v_mul_f32 v84, v84, v96
    v_mul_f32 v85, v85, v96
    v_cvt_pk_bf16_f32 v8, v86, v87
    v_lshlrev_b32 v86, 16, v8
    v_and_b32 v87, 0xffff0000, v8
    v_mul_f32 v86, v86, v96
    v_mul_f32 v87, v87, v96
    v_cvt_pk_bf16_f32 v8, v88, v89
    v_lshlrev_b32 v88, 16, v8
    v_and_b32 v89, 0xffff0000, v8
    v_mul_f32 v88, v88, v96
    v_mul_f32 v89, v89, v96
    v_cvt_pk_bf16_f32 v8, v90, v91
    v_lshlrev_b32 v90, 16, v8
    v_and_b32 v91, 0xffff0000, v8
    v_mul_f32 v90, v90, v96
    v_mul_f32 v91, v91, v96
    v_cvt_pk_bf16_f32 v8, v92, v93
    v_lshlrev_b32 v92, 16, v8
    v_and_b32 v93, 0xffff0000, v8
    v_mul_f32 v92, v92, v96
    v_mul_f32 v93, v93, v96
    v_cvt_pk_bf16_f32 v8, v94, v95
    v_lshlrev_b32 v94, 16, v8
    v_and_b32 v95, 0xffff0000, v8
    v_mul_f32 v94, v94, v96
    v_mul_f32 v95, v95, v96
    v_cvt_pk_bf16_f32 v16, v80, v81
    v_cvt_pk_bf16_f32 v17, v82, v83
    v_cvt_pk_bf16_f32 v18, v84, v85
    v_cvt_pk_bf16_f32 v19, v86, v87
    v_cvt_pk_bf16_f32 v20, v88, v89
    v_cvt_pk_bf16_f32 v21, v90, v91
    v_cvt_pk_bf16_f32 v22, v92, v93
    v_cvt_pk_bf16_f32 v23, v94, v95
    s_nop 1
    v_permlane32_swap_b32 v16, v18
    v_permlane32_swap_b32 v17, v19
    v_permlane32_swap_b32 v20, v22
    v_permlane32_swap_b32 v21, v23
    buffer_store_dwordx4 v[16:19], v4, s[16:19], s26 offen offset:0
    buffer_store_dwordx4 v[20:23], v4, s[16:19], s26 offen offset:32
    v_cvt_pk_bf16_f32 v8, v128, v128
    v_lshlrev_b32 v128, 16, v8
    v_add_f32 v128, 0x358637bd, v128
    v_cvt_pk_bf16_f32 v8, v128, v128
    v_lshlrev_b32 v128, 16, v8
    v_rcp_f32 v128, v128
    s_nop 0
    v_cvt_pk_bf16_f32 v8, v112, v113
    v_lshlrev_b32 v112, 16, v8
    v_and_b32 v113, 0xffff0000, v8
    v_mul_f32 v112, v112, v128
    v_mul_f32 v113, v113, v128
    v_cvt_pk_bf16_f32 v8, v114, v115
    v_lshlrev_b32 v114, 16, v8
    v_and_b32 v115, 0xffff0000, v8
    v_mul_f32 v114, v114, v128
    v_mul_f32 v115, v115, v128
    v_cvt_pk_bf16_f32 v8, v116, v117
    v_lshlrev_b32 v116, 16, v8
    v_and_b32 v117, 0xffff0000, v8
    v_mul_f32 v116, v116, v128
    v_mul_f32 v117, v117, v128
    v_cvt_pk_bf16_f32 v8, v118, v119
    v_lshlrev_b32 v118, 16, v8
    v_and_b32 v119, 0xffff0000, v8
    v_mul_f32 v118, v118, v128
    v_mul_f32 v119, v119, v128
    v_cvt_pk_bf16_f32 v8, v120, v121
    v_lshlrev_b32 v120, 16, v8
    v_and_b32 v121, 0xffff0000, v8
    v_mul_f32 v120, v120, v128
    v_mul_f32 v121, v121, v128
    v_cvt_pk_bf16_f32 v8, v122, v123
    v_lshlrev_b32 v122, 16, v8
    v_and_b32 v123, 0xffff0000, v8
    v_mul_f32 v122, v122, v128
    v_mul_f32 v123, v123, v128
    v_cvt_pk_bf16_f32 v8, v124, v125
    v_lshlrev_b32 v124, 16, v8
    v_and_b32 v125, 0xffff0000, v8
    v_mul_f32 v124, v124, v128
    v_mul_f32 v125, v125, v128
    v_cvt_pk_bf16_f32 v8, v126, v127
    v_lshlrev_b32 v126, 16, v8
    v_and_b32 v127, 0xffff0000, v8
    v_mul_f32 v126, v126, v128
    v_mul_f32 v127, v127, v128
    v_cvt_pk_bf16_f32 v16, v112, v113
    v_cvt_pk_bf16_f32 v17, v114, v115
    v_cvt_pk_bf16_f32 v18, v116, v117
    v_cvt_pk_bf16_f32 v19, v118, v119
    v_cvt_pk_bf16_f32 v20, v120, v121
    v_cvt_pk_bf16_f32 v21, v122, v123
    v_cvt_pk_bf16_f32 v22, v124, v125
    v_cvt_pk_bf16_f32 v23, v126, v127
    s_nop 1
    v_permlane32_swap_b32 v16, v18
    v_permlane32_swap_b32 v17, v19
    v_permlane32_swap_b32 v20, v22
    v_permlane32_swap_b32 v21, v23
    buffer_store_dwordx4 v[16:19], v4, s[16:19], s26 offen offset:64
    buffer_store_dwordx4 v[20:23], v4, s[16:19], s26 offen offset:96
    s_endpgm
L_end_kmidb_kernel:
    s_endpgm
.text
.globl k2b_kernel
.p2align 8
.type k2b_kernel,@function
k2b_kernel:
    s_cmp_ge_u32 s2, 256
    s_cbranch_scc1 L_end_k2b_kernel
    s_load_dwordx2 s[4:5], s[0:1], 80
    s_load_dwordx2 s[6:7], s[0:1], 16
    s_load_dwordx2 s[28:29], s[0:1], 0
    s_load_dwordx2 s[30:31], s[0:1], 32
    v_lshrrev_b32 v1, 6, v0
    v_and_b32 v2, 63, v0
    s_nop 0
    v_readfirstlane_b32 s3, v1
    s_lshr_b32 s20, s2, 4
    s_and_b32 s21, s2, 15
    s_lshl_b32 s24, s3, 12
    s_mov_b32 s25, 0
    s_lshl_b32 s26, s21, 7
    s_waitcnt lgkmcnt(0)
    s_add_u32 s8, s4, 8388608
    s_addc_u32 s9, s5, 0
    s_mov_b32 s10, 4194304
    s_mov_b32 s11, 0x00020000
    s_mov_b32 s12, s6
    s_mov_b32 s13, s7
    s_mov_b32 s14, 2097152
    s_mov_b32 s15, 0x00020000
    s_mov_b32 s16, s4
    s_mov_b32 s17, s5
    s_mov_b32 s18, 29360128
    s_mov_b32 s19, 0x00020000
    v_mov_b32 v32, 0
    v_mov_b32 v33, 0
    v_mov_b32 v34, 0
    v_mov_b32 v35, 0
    v_mov_b32 v36, 0
    v_mov_b32 v37, 0
    v_mov_b32 v38, 0
    v_mov_b32 v39, 0
    v_mov_b32 v40, 0
    v_mov_b32 v41, 0
    v_mov_b32 v42, 0
    v_mov_b32 v43, 0
    v_mov_b32 v44, 0
    v_mov_b32 v45, 0
    v_mov_b32 v46, 0
    v_mov_b32 v47, 0
    v_mov_b32 v48, 0
    v_mov_b32 v49, 0
    v_mov_b32 v50, 0
    v_mov_b32 v51, 0
    v_mov_b32 v52, 0
    v_mov_b32 v53, 0
    v_mov_b32 v54, 0
    v_mov_b32 v55, 0
    v_mov_b32 v56, 0
    v_mov_b32 v57, 0
    v_mov_b32 v58, 0
    v_mov_b32 v59, 0
    v_mov_b32 v60, 0
    v_mov_b32 v61, 0
    v_mov_b32 v62, 0
    v_mov_b32 v63, 0
    v_lshrrev_b32 v101, 4, v2
    v_add_u32 v101, 0, v101
    v_and_b32 v101, 7, v101
    v_and_b32 v102, 7, v2
    v_xor_b32 v101, v101, v102
    v_lshlrev_b32 v101, 4, v101
    v_lshrrev_b32 v102, 3, v2
    v_add_u32 v102, 0, v102
    v_lshlrev_b32 v102, 11, v102
    v_add_u32 v96, v101, v102
    v_lshrrev_b32 v101, 4, v2
    v_add_u32 v101, 4, v101
    v_and_b32 v101, 7, v101
    v_and_b32 v102, 7, v2
    v_xor_b32 v101, v101, v102
    v_lshlrev_b32 v101, 4, v101
    v_lshrrev_b32 v102, 3, v2
    v_add_u32 v102, 8, v102
    v_lshlrev_b32 v102, 11, v102
    v_add_u32 v97, v101, v102
    v_lshrrev_b32 v101, 4, v2
    v_add_u32 v101, 8, v101
    v_and_b32 v101, 7, v101
    v_and_b32 v102, 7, v2
    v_xor_b32 v101, v101, v102
    v_lshlrev_b32 v101, 4, v101
    v_lshrrev_b32 v102, 3, v2
    v_add_u32 v102, 16, v102
    v_lshlrev_b32 v102, 11, v102
    v_add_u32 v98, v101, v102
    v_lshrrev_b32 v101, 4, v2
    v_add_u32 v101, 12, v101
    v_and_b32 v101, 7, v101
    v_and_b32 v102, 7, v2
    v_xor_b32 v101, v101, v102
    v_lshlrev_b32 v101, 4, v101
    v_lshrrev_b32 v102, 3, v2
    v_add_u32 v102, 24, v102
    v_lshlrev_b32 v102, 11, v102
    v_add_u32 v99, v101, v102
    v_lshrrev_b32 v101, 4, v2
    v_and_b32 v101, 1, v101
    v_lshlrev_b32 v101, 2, v101
    v_and_b32 v102, 7, v2
    v_xor_b32 v101, v101, v102
    v_lshlrev_b32 v101, 4, v101
    v_lshrrev_b32 v102, 3, v2
    s_mov_b32 s40, 2048
    v_mul_lo_u32 v102, v102, s40
    v_add_u32 v100, v101, v102
    s_lshl_b32 s41, s20, 18
    s_lshl_b32 s43, s3, 16
    s_add_u32 s41, s41, s43
    s_mul_i32 s43, s3, 2
    s_add_u32 s43, s43, 0
    s_lshr_b32 s44, s43, 3
    s_and_b32 s43, s43, 7
    s_lshl_b32 s47, s44, 13
    s_lshl_b32 s45, s43, 10
    s_add_u32 s47, s47, s45
    s_add_u32 s47, s47, 16384
    s_mul_i32 s45, s43, 16384
    s_mul_i32 s44, s44, 0
    s_add_u32 s45, s45, s44
    s_add_u32 s45, s45, s26
    s_mul_i32 s43, s3, 2
    s_add_u32 s43, s43, 1
    s_lshr_b32 s44, s43, 3
    s_and_b32 s43, s43, 7
    s_lshl_b32 s48, s44, 13
    s_lshl_b32 s46, s43, 10
    s_add_u32 s48, s48, s46
    s_add_u32 s48, s48, 16384
    s_mul_i32 s46, s43, 16384
    s_mul_i32 s44, s44, 0
    s_add_u32 s46, s46, s44
    s_add_u32 s46, s46, s26
    s_lshl_b32 s49, s3, 12
    v_lshrrev_b32 v101, 5, v2
    v_add_u32 v101, 0, v101
    v_lshrrev_b32 v102, 1, v2
    v_and_b32 v102, 7, v102
    v_xor_b32 v101, v101, v102
    v_lshlrev_b32 v101, 4, v101
    v_and_b32 v102, 31, v2
    v_lshlrev_b32 v102, 7, v102
    v_add_u32 v101, v101, v102
    v_add_u32 v104, s24, v101
    v_add_u32 v108, 24576, v104
    v_add_u32 v112, 49152, v104
    v_add_u32 v116, 73728, v104
    v_lshrrev_b32 v101, 5, v2
    v_add_u32 v101, 2, v101
    v_lshrrev_b32 v102, 1, v2
    v_and_b32 v102, 7, v102
    v_xor_b32 v101, v101, v102
    v_lshlrev_b32 v101, 4, v101
    v_and_b32 v102, 31, v2
    v_lshlrev_b32 v102, 7, v102
    v_add_u32 v101, v101, v102
    v_add_u32 v105, s24, v101
    v_add_u32 v109, 24576, v105
    v_add_u32 v113, 49152, v105
    v_add_u32 v117, 73728, v105
    v_lshrrev_b32 v101, 5, v2
    v_add_u32 v101, 4, v101
    v_lshrrev_b32 v102, 1, v2
    v_and_b32 v102, 7, v102
    v_xor_b32 v101, v101, v102
    v_lshlrev_b32 v101, 4, v101
    v_and_b32 v102, 31, v2
    v_lshlrev_b32 v102, 7, v102
    v_add_u32 v101, v101, v102
    v_add_u32 v106, s24, v101
    v_add_u32 v110, 24576, v106
    v_add_u32 v114, 49152, v106
    v_add_u32 v118, 73728, v106
    v_lshrrev_b32 v101, 5, v2
    v_add_u32 v101, 6, v101
    v_lshrrev_b32 v102, 1, v2
    v_and_b32 v102, 7, v102
    v_xor_b32 v101, v101, v102
    v_lshlrev_b32 v101, 4, v101
    v_and_b32 v102, 31, v2
    v_lshlrev_b32 v102, 7, v102
    v_add_u32 v101, v101, v102
    v_add_u32 v107, s24, v101
    v_add_u32 v111, 24576, v107
    v_add_u32 v115, 49152, v107
    v_add_u32 v119, 73728, v107
    v_lshrrev_b32 v101, 5, v2
    v_lshlrev_b32 v101, 3, v101
    v_lshrrev_b32 v102, 2, v2
    v_and_b32 v102, 3, v102
    v_add_u32 v101, v101, v102
    v_lshlrev_b32 v120, 7, v101
    v_lshrrev_b32 v101, 4, v2
    v_and_b32 v101, 1, v101
    v_lshlrev_b32 v101, 1, v101
    v_lshrrev_b32 v102, 1, v2
    v_and_b32 v102, 1, v102
    v_add_u32 v101, v101, v102
    v_add_u32 v101, s25, v101
    v_lshrrev_b32 v102, 3, v2
    v_and_b32 v102, 1, v102
    v_lshlrev_b32 v102, 2, v102
    v_xor_b32 v101, v101, v102
    v_lshlrev_b32 v101, 4, v101
    v_add_u32 v120, v120, v101
    v_and_b32 v101, 1, v2
    v_lshlrev_b32 v101, 3, v101
    v_add_u32 v120, v120, v101
    v_add_u32 v120, 16384, v120
    v_add_u32 v121, 24576, v120
    v_add_u32 v122, 49152, v120
    v_add_u32 v123, 73728, v120
    v_xor_b32 v134, 64, v120
    v_xor_b32 v135, 64, v121
    v_xor_b32 v136, 64, v122
    v_xor_b32 v137, 64, v123
    s_mov_b32 s52, 0
    s_mov_b32 s53, 0
    s_add_u32 s50, s49, 0
    s_mov_b32 m0, s50
    s_add_u32 s51, s41, s52
    buffer_load_dwordx4 v96, s[8:11], s51 offen lds
    s_add_u32 s50, s49, 1024
    s_mov_b32 m0, s50
    s_add_u32 s51, s41, s52
    buffer_load_dwordx4 v97, s[8:11], s51 offen lds
    s_add_u32 s50, s49, 2048
    s_mov_b32 m0, s50
    s_add_u32 s51, s41, s52
    buffer_load_dwordx4 v98, s[8:11], s51 offen lds
    s_add_u32 s50, s49, 3072
    s_mov_b32 m0, s50
    s_add_u32 s51, s41, s52
    buffer_load_dwordx4 v99, s[8:11], s51 offen lds
    s_add_u32 s50, s47, 0
    s_mov_b32 m0, s50
    s_add_u32 s51, s45, s53
    buffer_load_dwordx4 v100, s[12:15], s51 offen lds
    s_add_u32 s50, s48, 0
    s_mov_b32 m0, s50
    s_add_u32 s51, s46, s53
    buffer_load_dwordx4 v100, s[12:15], s51 offen lds
    s_add_u32 s52, s52, 128
    s_add_u32 s53, s53, 131072
    s_add_u32 s50, s49, 24576
    s_mov_b32 m0, s50
    s_add_u32 s51, s41, s52
    buffer_load_dwordx4 v96, s[8:11], s51 offen lds
    s_add_u32 s50, s49, 25600
    s_mov_b32 m0, s50
    s_add_u32 s51, s41, s52
    buffer_load_dwordx4 v97, s[8:11], s51 offen lds
    s_add_u32 s50, s49, 26624
    s_mov_b32 m0, s50
    s_add_u32 s51, s41, s52
    buffer_load_dwordx4 v98, s[8:11], s51 offen lds
    s_add_u32 s50, s49, 27648
    s_mov_b32 m0, s50
    s_add_u32 s51, s41, s52
    buffer_load_dwordx4 v99, s[8:11], s51 offen lds
    s_add_u32 s50, s47, 24576
    s_mov_b32 m0, s50
    s_add_u32 s51, s45, s53
    buffer_load_dwordx4 v100, s[12:15], s51 offen lds
    s_add_u32 s50, s48, 24576
    s_mov_b32 m0, s50
    s_add_u32 s51, s46, s53
    buffer_load_dwordx4 v100, s[12:15], s51 offen lds
    s_add_u32 s52, s52, 128
    s_add_u32 s53, s53, 131072
    s_add_u32 s50, s49, 49152
    s_mov_b32 m0, s50
    s_add_u32 s51, s41, s52
    buffer_load_dwordx4 v96, s[8:11], s51 offen lds
    s_add_u32 s50, s49, 50176
    s_mov_b32 m0, s50
    s_add_u32 s51, s41, s52
    buffer_load_dwordx4 v97, s[8:11], s51 offen lds
    s_add_u32 s50, s49, 51200
    s_mov_b32 m0, s50
    s_add_u32 s51, s41, s52
    buffer_load_dwordx4 v98, s[8:11], s51 offen lds
    s_add_u32 s50, s49, 52224
    s_mov_b32 m0, s50
    s_add_u32 s51, s41, s52
    buffer_load_dwordx4 v99, s[8:11], s51 offen lds
    s_add_u32 s50, s47, 49152
    s_mov_b32 m0, s50
    s_add_u32 s51, s45, s53
    buffer_load_dwordx4 v100, s[12:15], s51 offen lds
    s_add_u32 s50, s48, 49152
    s_mov_b32 m0, s50
    s_add_u32 s51, s46, s53
    buffer_load_dwordx4 v100, s[12:15], s51 offen lds
    s_add_u32 s52, s52, 128
    s_add_u32 s53, s53, 131072
    s_waitcnt vmcnt(12)
    s_barrier
    s_mov_b32 s54, 0
L_gl_k2b_kernel:
    s_add_u32 s50, s49, 73728
    s_mov_b32 m0, s50
    s_add_u32 s51, s41, s52
    buffer_load_dwordx4 v96, s[8:11], s51 offen lds
    s_add_u32 s50, s49, 74752
    s_mov_b32 m0, s50
    s_add_u32 s51, s41, s52
    buffer_load_dwordx4 v97, s[8:11], s51 offen lds
    s_add_u32 s50, s49, 75776
    s_mov_b32 m0, s50
    s_add_u32 s51, s41, s52
    buffer_load_dwordx4 v98, s[8:11], s51 offen lds
    s_add_u32 s50, s49, 76800
    s_mov_b32 m0, s50
    s_add_u32 s51, s41, s52
    buffer_load_dwordx4 v99, s[8:11], s51 offen lds
    s_add_u32 s50, s47, 73728
    s_mov_b32 m0, s50
    s_add_u32 s51, s45, s53
    buffer_load_dwordx4 v100, s[12:15], s51 offen lds
    s_add_u32 s50, s48, 73728
    s_mov_b32 m0, s50
    s_add_u32 s51, s46, s53
    buffer_load_dwordx4 v100, s[12:15], s51 offen lds
    s_add_u32 s52, s52, 128
    s_add_u32 s53, s53, 131072
    ds_read_b128 v[64:67], v104 offset:0
    ds_read_b64_tr_b16 v[68:69], v120 offset:0
    ds_read_b64_tr_b16 v[70:71], v120 offset:512
    ds_read_b64_tr_b16 v[72:73], v134 offset:0
    ds_read_b64_tr_b16 v[74:75], v134 offset:512
    ds_read_b128 v[76:79], v105 offset:0
    ds_read_b64_tr_b16 v[80:81], v120 offset:2048
    ds_read_b64_tr_b16 v[82:83], v120 offset:2560
    ds_read_b64_tr_b16 v[84:85], v134 offset:2048
    ds_read_b64_tr_b16 v[86:87], v134 offset:2560
    s_waitcnt lgkmcnt(5)
    v_mfma_f32_32x32x16_bf16 v[32:47], v[68:71], v[64:67], v[32:47]
    v_mfma_f32_32x32x16_bf16 v[48:63], v[72:75], v[64:67], v[48:63]
    ds_read_b128 v[64:67], v106 offset:0
    ds_read_b64_tr_b16 v[68:69], v120 offset:4096
    ds_read_b64_tr_b16 v[70:71], v120 offset:4608
    ds_read_b64_tr_b16 v[72:73], v134 offset:4096
    ds_read_b64_tr_b16 v[74:75], v134 offset:4608
    s_waitcnt lgkmcnt(5)
    v_mfma_f32_32x32x16_bf16 v[32:47], v[80:83], v[76:79], v[32:47]
    v_mfma_f32_32x32x16_bf16 v[48:63], v[84:87], v[76:79], v[48:63]
    ds_read_b128 v[76:79], v107 offset:0
    ds_read_b64_tr_b16 v[80:81], v120 offset:6144
    ds_read_b64_tr_b16 v[82:83], v120 offset:6656
    ds_read_b64_tr_b16 v[84:85], v134 offset:6144
    ds_read_b64_tr_b16 v[86:87], v134 offset:6656
    s_waitcnt lgkmcnt(5)
    v_mfma_f32_32x32x16_bf16 v[32:47], v[68:71], v[64:67], v[32:47]
    v_mfma_f32_32x32x16_bf16 v[48:63], v[72:75], v[64:67], v[48:63]
    s_waitcnt lgkmcnt(0)
    v_mfma_f32_32x32x16_bf16 v[32:47], v[80:83], v[76:79], v[32:47]
    v_mfma_f32_32x32x16_bf16 v[48:63], v[84:87], v[76:79], v[48:63]
    s_waitcnt vmcnt(12)
    s_barrier
    s_add_u32 s50, s49, 0
    s_mov_b32 m0, s50
    s_add_u32 s51, s41, s52
    buffer_load_dwordx4 v96, s[8:11], s51 offen lds
    s_add_u32 s50, s49, 1024
    s_mov_b32 m0, s50
    s_add_u32 s51, s41, s52
    buffer_load_dwordx4 v97, s[8:11], s51 offen lds
    s_add_u32 s50, s49, 2048
    s_mov_b32 m0, s50
    s_add_u32 s51, s41, s52
    buffer_load_dwordx4 v98, s[8:11], s51 offen lds
    s_add_u32 s50, s49, 3072
    s_mov_b32 m0, s50
    s_add_u32 s51, s41, s52
    buffer_load_dwordx4 v99, s[8:11], s51 offen lds
    s_add_u32 s50, s47, 0
    s_mov_b32 m0, s50
    s_add_u32 s51, s45, s53
    buffer_load_dwordx4 v100, s[12:15], s51 offen lds
    s_add_u32 s50, s48, 0
    s_mov_b32 m0, s50
    s_add_u32 s51, s46, s53
    buffer_load_dwordx4 v100, s[12:15], s51 offen lds
    s_add_u32 s52, s52, 128
    s_add_u32 s53, s53, 131072
    ds_read_b128 v[64:67], v108 offset:0
    ds_read_b64_tr_b16 v[68:69], v121 offset:0
    ds_read_b64_tr_b16 v[70:71], v121 offset:512
    ds_read_b64_tr_b16 v[72:73], v135 offset:0
    ds_read_b64_tr_b16 v[74:75], v135 offset:512
    ds_read_b128 v[76:79], v109 offset:0
    ds_read_b64_tr_b16 v[80:81], v121 offset:2048
    ds_read_b64_tr_b16 v[82:83], v121 offset:2560
    ds_read_b64_tr_b16 v[84:85], v135 offset:2048
    ds_read_b64_tr_b16 v[86:87], v135 offset:2560
    s_waitcnt lgkmcnt(5)
    v_mfma_f32_32x32x16_bf16 v[32:47], v[68:71], v[64:67], v[32:47]
    v_mfma_f32_32x32x16_bf16 v[48:63], v[72:75], v[64:67], v[48:63]
    ds_read_b128 v[64:67], v110 offset:0
    ds_read_b64_tr_b16 v[68:69], v121 offset:4096
    ds_read_b64_tr_b16 v[70:71], v121 offset:4608
    ds_read_b64_tr_b16 v[72:73], v135 offset:4096
    ds_read_b64_tr_b16 v[74:75], v135 offset:4608
    s_waitcnt lgkmcnt(5)
    v_mfma_f32_32x32x16_bf16 v[32:47], v[80:83], v[76:79], v[32:47]
    v_mfma_f32_32x32x16_bf16 v[48:63], v[84:87], v[76:79], v[48:63]
    ds_read_b128 v[76:79], v111 offset:0
    ds_read_b64_tr_b16 v[80:81], v121 offset:6144
    ds_read_b64_tr_b16 v[82:83], v121 offset:6656
    ds_read_b64_tr_b16 v[84:85], v135 offset:6144
    ds_read_b64_tr_b16 v[86:87], v135 offset:6656
    s_waitcnt lgkmcnt(5)
    v_mfma_f32_32x32x16_bf16 v[32:47], v[68:71], v[64:67], v[32:47]
    v_mfma_f32_32x32x16_bf16 v[48:63], v[72:75], v[64:67], v[48:63]
    s_waitcnt lgkmcnt(0)
    v_mfma_f32_32x32x16_bf16 v[32:47], v[80:83], v[76:79], v[32:47]
    v_mfma_f32_32x32x16_bf16 v[48:63], v[84:87], v[76:79], v[48:63]
    s_waitcnt vmcnt(12)
    s_barrier
    s_add_u32 s50, s49, 24576
    s_mov_b32 m0, s50
    s_add_u32 s51, s41, s52
    buffer_load_dwordx4 v96, s[8:11], s51 offen lds
    s_add_u32 s50, s49, 25600
    s_mov_b32 m0, s50
    s_add_u32 s51, s41, s52
    buffer_load_dwordx4 v97, s[8:11], s51 offen lds
    s_add_u32 s50, s49, 26624
    s_mov_b32 m0, s50
    s_add_u32 s51, s41, s52
    buffer_load_dwordx4 v98, s[8:11], s51 offen lds
    s_add_u32 s50, s49, 27648
    s_mov_b32 m0, s50
    s_add_u32 s51, s41, s52
    buffer_load_dwordx4 v99, s[8:11], s51 offen lds
    s_add_u32 s50, s47, 24576
    s_mov_b32 m0, s50
    s_add_u32 s51, s45, s53
    buffer_load_dwordx4 v100, s[12:15], s51 offen lds
    s_add_u32 s50, s48, 24576
    s_mov_b32 m0, s50
    s_add_u32 s51, s46, s53
    buffer_load_dwordx4 v100, s[12:15], s51 offen lds
    s_add_u32 s52, s52, 128
    s_add_u32 s53, s53, 131072
    ds_read_b128 v[64:67], v112 offset:0
    ds_read_b64_tr_b16 v[68:69], v122 offset:0
    ds_read_b64_tr_b16 v[70:71], v122 offset:512
    ds_read_b64_tr_b16 v[72:73], v136 offset:0
    ds_read_b64_tr_b16 v[74:75], v136 offset:512
    ds_read_b128 v[76:79], v113 offset:0
    ds_read_b64_tr_b16 v[80:81], v122 offset:2048
    ds_read_b64_tr_b16 v[82:83], v122 offset:2560
    ds_read_b64_tr_b16 v[84:85], v136 offset:2048
    ds_read_b64_tr_b16 v[86:87], v136 offset:2560
    s_waitcnt lgkmcnt(5)
    v_mfma_f32_32x32x16_bf16 v[32:47], v[68:71], v[64:67], v[32:47]
    v_mfma_f32_32x32x16_bf16 v[48:63], v[72:75], v[64:67], v[48:63]
    ds_read_b128 v[64:67], v114 offset:0
    ds_read_b64_tr_b16 v[68:69], v122 offset:4096
    ds_read_b64_tr_b16 v[70:71], v122 offset:4608
    ds_read_b64_tr_b16 v[72:73], v136 offset:4096
    ds_read_b64_tr_b16 v[74:75], v136 offset:4608
    s_waitcnt lgkmcnt(5)
    v_mfma_f32_32x32x16_bf16 v[32:47], v[80:83], v[76:79], v[32:47]
    v_mfma_f32_32x32x16_bf16 v[48:63], v[84:87], v[76:79], v[48:63]
    ds_read_b128 v[76:79], v115 offset:0
    ds_read_b64_tr_b16 v[80:81], v122 offset:6144
    ds_read_b64_tr_b16 v[82:83], v122 offset:6656
    ds_read_b64_tr_b16 v[84:85], v136 offset:6144
    ds_read_b64_tr_b16 v[86:87], v136 offset:6656
    s_waitcnt lgkmcnt(5)
    v_mfma_f32_32x32x16_bf16 v[32:47], v[68:71], v[64:67], v[32:47]
    v_mfma_f32_32x32x16_bf16 v[48:63], v[72:75], v[64:67], v[48:63]
    s_waitcnt lgkmcnt(0)
    v_mfma_f32_32x32x16_bf16 v[32:47], v[80:83], v[76:79], v[32:47]
    v_mfma_f32_32x32x16_bf16 v[48:63], v[84:87], v[76:79], v[48:63]
    s_waitcnt vmcnt(12)
    s_barrier
    s_add_u32 s50, s49, 49152
    s_mov_b32 m0, s50
    s_add_u32 s51, s41, s52
    buffer_load_dwordx4 v96, s[8:11], s51 offen lds
    s_add_u32 s50, s49, 50176
    s_mov_b32 m0, s50
    s_add_u32 s51, s41, s52
    buffer_load_dwordx4 v97, s[8:11], s51 offen lds
    s_add_u32 s50, s49, 51200
    s_mov_b32 m0, s50
    s_add_u32 s51, s41, s52
    buffer_load_dwordx4 v98, s[8:11], s51 offen lds
    s_add_u32 s50, s49, 52224
    s_mov_b32 m0, s50
    s_add_u32 s51, s41, s52
    buffer_load_dwordx4 v99, s[8:11], s51 offen lds
    s_add_u32 s50, s47, 49152
    s_mov_b32 m0, s50
    s_add_u32 s51, s45, s53
    buffer_load_dwordx4 v100, s[12:15], s51 offen lds
    s_add_u32 s50, s48, 49152
    s_mov_b32 m0, s50
    s_add_u32 s51, s46, s53
    buffer_load_dwordx4 v100, s[12:15], s51 offen lds
    s_add_u32 s52, s52, 128
    s_add_u32 s53, s53, 131072
    ds_read_b128 v[64:67], v116 offset:0
    ds_read_b64_tr_b16 v[68:69], v123 offset:0
    ds_read_b64_tr_b16 v[70:71], v123 offset:512
    ds_read_b64_tr_b16 v[72:73], v137 offset:0
    ds_read_b64_tr_b16 v[74:75], v137 offset:512
    ds_read_b128 v[76:79], v117 offset:0
    ds_read_b64_tr_b16 v[80:81], v123 offset:2048
    ds_read_b64_tr_b16 v[82:83], v123 offset:2560
    ds_read_b64_tr_b16 v[84:85], v137 offset:2048
    ds_read_b64_tr_b16 v[86:87], v137 offset:2560
    s_waitcnt lgkmcnt(5)
    v_mfma_f32_32x32x16_bf16 v[32:47], v[68:71], v[64:67], v[32:47]
    v_mfma_f32_32x32x16_bf16 v[48:63], v[72:75], v[64:67], v[48:63]
    ds_read_b128 v[64:67], v118 offset:0
    ds_read_b64_tr_b16 v[68:69], v123 offset:4096
    ds_read_b64_tr_b16 v[70:71], v123 offset:4608
    ds_read_b64_tr_b16 v[72:73], v137 offset:4096
    ds_read_b64_tr_b16 v[74:75], v137 offset:4608
    s_waitcnt lgkmcnt(5)
    v_mfma_f32_32x32x16_bf16 v[32:47], v[80:83], v[76:79], v[32:47]
    v_mfma_f32_32x32x16_bf16 v[48:63], v[84:87], v[76:79], v[48:63]
    ds_read_b128 v[76:79], v119 offset:0
    ds_read_b64_tr_b16 v[80:81], v123 offset:6144
    ds_read_b64_tr_b16 v[82:83], v123 offset:6656
    ds_read_b64_tr_b16 v[84:85], v137 offset:6144
    ds_read_b64_tr_b16 v[86:87], v137 offset:6656
    s_waitcnt lgkmcnt(5)
    v_mfma_f32_32x32x16_bf16 v[32:47], v[68:71], v[64:67], v[32:47]
    v_mfma_f32_32x32x16_bf16 v[48:63], v[72:75], v[64:67], v[48:63]
    s_waitcnt lgkmcnt(0)
    v_mfma_f32_32x32x16_bf16 v[32:47], v[80:83], v[76:79], v[32:47]
    v_mfma_f32_32x32x16_bf16 v[48:63], v[84:87], v[76:79], v[48:63]
    s_waitcnt vmcnt(12)
    s_barrier
    s_add_u32 s54, s54, 1
    s_cmp_lt_u32 s54, 3
    s_cbranch_scc1 L_gl_k2b_kernel
    s_add_u32 s50, s49, 73728
    s_mov_b32 m0, s50
    s_add_u32 s51, s41, s52
    buffer_load_dwordx4 v96, s[8:11], s51 offen lds
    s_add_u32 s50, s49, 74752
    s_mov_b32 m0, s50
    s_add_u32 s51, s41, s52
    buffer_load_dwordx4 v97, s[8:11], s51 offen lds
    s_add_u32 s50, s49, 75776
    s_mov_b32 m0, s50
    s_add_u32 s51, s41, s52
    buffer_load_dwordx4 v98, s[8:11], s51 offen lds
    s_add_u32 s50, s49, 76800
    s_mov_b32 m0, s50
    s_add_u32 s51, s41, s52
    buffer_load_dwordx4 v99, s[8:11], s51 offen lds
    s_add_u32 s50, s47, 73728
    s_mov_b32 m0, s50
    s_add_u32 s51, s45, s53
    buffer_load_dwordx4 v100, s[12:15], s51 offen lds
    s_add_u32 s50, s48, 73728
    s_mov_b32 m0, s50
    s_add_u32 s51, s46, s53
    buffer_load_dwordx4 v100, s[12:15], s51 offen lds
    s_add_u32 s52, s52, 128
    s_add_u32 s53, s53, 131072
    ds_read_b128 v[64:67], v104 offset:0
    ds_read_b64_tr_b16 v[68:69], v120 offset:0
    ds_read_b64_tr_b16 v[70:71], v120 offset:512
    ds_read_b64_tr_b16 v[72:73], v134 offset:0
    ds_read_b64_tr_b16 v[74:75], v134 offset:512
    ds_read_b128 v[76:79], v105 offset:0
    ds_read_b64_tr_b16 v[80:81], v120 offset:2048
    ds_read_b64_tr_b16 v[82:83], v120 offset:2560
    ds_read_b64_tr_b16 v[84:85], v134 offset:2048
    ds_read_b64_tr_b16 v[86:87], v134 offset:2560
    s_waitcnt lgkmcnt(5)
    v_mfma_f32_32x32x16_bf16 v[32:47], v[68:71], v[64:67], v[32:47]
    v_mfma_f32_32x32x16_bf16 v[48:63], v[72:75], v[64:67], v[48:63]
    ds_read_b128 v[64:67], v106 offset:0
    ds_read_b64_tr_b16 v[68:69], v120 offset:4096
    ds_read_b64_tr_b16 v[70:71], v120 offset:4608
    ds_read_b64_tr_b16 v[72:73], v134 offset:4096
    ds_read_b64_tr_b16 v[74:75], v134 offset:4608
    s_waitcnt lgkmcnt(5)
    v_mfma_f32_32x32x16_bf16 v[32:47], v[80:83], v[76:79], v[32:47]
    v_mfma_f32_32x32x16_bf16 v[48:63], v[84:87], v[76:79], v[48:63]
    ds_read_b128 v[76:79], v107 offset:0
    ds_read_b64_tr_b16 v[80:81], v120 offset:6144
    ds_read_b64_tr_b16 v[82:83], v120 offset:6656
    ds_read_b64_tr_b16 v[84:85], v134 offset:6144
    ds_read_b64_tr_b16 v[86:87], v134 offset:6656
    s_waitcnt lgkmcnt(5)
    v_mfma_f32_32x32x16_bf16 v[32:47], v[68:71], v[64:67], v[32:47]
    v_mfma_f32_32x32x16_bf16 v[48:63], v[72:75], v[64:67], v[48:63]
    s_waitcnt lgkmcnt(0)
    v_mfma_f32_32x32x16_bf16 v[32:47], v[80:83], v[76:79], v[32:47]
    v_mfma_f32_32x32x16_bf16 v[48:63], v[84:87], v[76:79], v[48:63]
    s_waitcnt vmcnt(12)
    s_barrier
    ds_read_b128 v[64:67], v108 offset:0
    ds_read_b64_tr_b16 v[68:69], v121 offset:0
    ds_read_b64_tr_b16 v[70:71], v121 offset:512
    ds_read_b64_tr_b16 v[72:73], v135 offset:0
    ds_read_b64_tr_b16 v[74:75], v135 offset:512
    ds_read_b128 v[76:79], v109 offset:0
    ds_read_b64_tr_b16 v[80:81], v121 offset:2048
    ds_read_b64_tr_b16 v[82:83], v121 offset:2560
    ds_read_b64_tr_b16 v[84:85], v135 offset:2048
    ds_read_b64_tr_b16 v[86:87], v135 offset:2560
    s_waitcnt lgkmcnt(5)
    v_mfma_f32_32x32x16_bf16 v[32:47], v[68:71], v[64:67], v[32:47]
    v_mfma_f32_32x32x16_bf16 v[48:63], v[72:75], v[64:67], v[48:63]
    ds_read_b128 v[64:67], v110 offset:0
    ds_read_b64_tr_b16 v[68:69], v121 offset:4096
    ds_read_b64_tr_b16 v[70:71], v121 offset:4608
    ds_read_b64_tr_b16 v[72:73], v135 offset:4096
    ds_read_b64_tr_b16 v[74:75], v135 offset:4608
    s_waitcnt lgkmcnt(5)
    v_mfma_f32_32x32x16_bf16 v[32:47], v[80:83], v[76:79], v[32:47]
    v_mfma_f32_32x32x16_bf16 v[48:63], v[84:87], v[76:79], v[48:63]
    ds_read_b128 v[76:79], v111 offset:0
    ds_read_b64_tr_b16 v[80:81], v121 offset:6144
    ds_read_b64_tr_b16 v[82:83], v121 offset:6656
    ds_read_b64_tr_b16 v[84:85], v135 offset:6144
    ds_read_b64_tr_b16 v[86:87], v135 offset:6656
    s_waitcnt lgkmcnt(5)
    v_mfma_f32_32x32x16_bf16 v[32:47], v[68:71], v[64:67], v[32:47]
    v_mfma_f32_32x32x16_bf16 v[48:63], v[72:75], v[64:67], v[48:63]
    s_waitcnt lgkmcnt(0)
    v_mfma_f32_32x32x16_bf16 v[32:47], v[80:83], v[76:79], v[32:47]
    v_mfma_f32_32x32x16_bf16 v[48:63], v[84:87], v[76:79], v[48:63]
    s_waitcnt vmcnt(6)
    s_barrier
    ds_read_b128 v[64:67], v112 offset:0
    ds_read_b64_tr_b16 v[68:69], v122 offset:0
    ds_read_b64_tr_b16 v[70:71], v122 offset:512
    ds_read_b64_tr_b16 v[72:73], v136 offset:0
    ds_read_b64_tr_b16 v[74:75], v136 offset:512
    ds_read_b128 v[76:79], v113 offset:0
    ds_read_b64_tr_b16 v[80:81], v122 offset:2048
    ds_read_b64_tr_b16 v[82:83], v122 offset:2560
    ds_read_b64_tr_b16 v[84:85], v136 offset:2048
    ds_read_b64_tr_b16 v[86:87], v136 offset:2560
    s_waitcnt lgkmcnt(5)
    v_mfma_f32_32x32x16_bf16 v[32:47], v[68:71], v[64:67], v[32:47]
    v_mfma_f32_32x32x16_bf16 v[48:63], v[72:75], v[64:67], v[48:63]
    ds_read_b128 v[64:67], v114 offset:0
    ds_read_b64_tr_b16 v[68:69], v122 offset:4096
    ds_read_b64_tr_b16 v[70:71], v122 offset:4608
    ds_read_b64_tr_b16 v[72:73], v136 offset:4096
    ds_read_b64_tr_b16 v[74:75], v136 offset:4608
    s_waitcnt lgkmcnt(5)
    v_mfma_f32_32x32x16_bf16 v[32:47], v[80:83], v[76:79], v[32:47]
    v_mfma_f32_32x32x16_bf16 v[48:63], v[84:87], v[76:79], v[48:63]
    ds_read_b128 v[76:79], v115 offset:0
    ds_read_b64_tr_b16 v[80:81], v122 offset:6144
    ds_read_b64_tr_b16 v[82:83], v122 offset:6656
    ds_read_b64_tr_b16 v[84:85], v136 offset:6144
    ds_read_b64_tr_b16 v[86:87], v136 offset:6656
    s_waitcnt lgkmcnt(5)
    v_mfma_f32_32x32x16_bf16 v[32:47], v[68:71], v[64:67], v[32:47]
    v_mfma_f32_32x32x16_bf16 v[48:63], v[72:75], v[64:67], v[48:63]
    s_waitcnt lgkmcnt(0)
    v_mfma_f32_32x32x16_bf16 v[32:47], v[80:83], v[76:79], v[32:47]
    v_mfma_f32_32x32x16_bf16 v[48:63], v[84:87], v[76:79], v[48:63]
    s_waitcnt vmcnt(0)
    s_barrier
    ds_read_b128 v[64:67], v116 offset:0
    ds_read_b64_tr_b16 v[68:69], v123 offset:0
    ds_read_b64_tr_b16 v[70:71], v123 offset:512
    ds_read_b64_tr_b16 v[72:73], v137 offset:0
    ds_read_b64_tr_b16 v[74:75], v137 offset:512
    ds_read_b128 v[76:79], v117 offset:0
    ds_read_b64_tr_b16 v[80:81], v123 offset:2048
    ds_read_b64_tr_b16 v[82:83], v123 offset:2560
    ds_read_b64_tr_b16 v[84:85], v137 offset:2048
    ds_read_b64_tr_b16 v[86:87], v137 offset:2560
    s_waitcnt lgkmcnt(5)
    v_mfma_f32_32x32x16_bf16 v[32:47], v[68:71], v[64:67], v[32:47]
    v_mfma_f32_32x32x16_bf16 v[48:63], v[72:75], v[64:67], v[48:63]
    ds_read_b128 v[64:67], v118 offset:0
    ds_read_b64_tr_b16 v[68:69], v123 offset:4096
    ds_read_b64_tr_b16 v[70:71], v123 offset:4608
    ds_read_b64_tr_b16 v[72:73], v137 offset:4096
    ds_read_b64_tr_b16 v[74:75], v137 offset:4608
    s_waitcnt lgkmcnt(5)
    v_mfma_f32_32x32x16_bf16 v[32:47], v[80:83], v[76:79], v[32:47]
    v_mfma_f32_32x32x16_bf16 v[48:63], v[84:87], v[76:79], v[48:63]
    ds_read_b128 v[76:79], v119 offset:0
    ds_read_b64_tr_b16 v[80:81], v123 offset:6144
    ds_read_b64_tr_b16 v[82:83], v123 offset:6656
    ds_read_b64_tr_b16 v[84:85], v137 offset:6144
    ds_read_b64_tr_b16 v[86:87], v137 offset:6656
    s_waitcnt lgkmcnt(5)
    v_mfma_f32_32x32x16_bf16 v[32:47], v[68:71], v[64:67], v[32:47]
    v_mfma_f32_32x32x16_bf16 v[48:63], v[72:75], v[64:67], v[48:63]
    s_waitcnt lgkmcnt(0)
    v_mfma_f32_32x32x16_bf16 v[32:47], v[80:83], v[76:79], v[32:47]
    v_mfma_f32_32x32x16_bf16 v[48:63], v[84:87], v[76:79], v[48:63]
    s_add_u32 s8, s4, 16777216
    s_addc_u32 s9, s5, 0
    s_mov_b32 s10, 4194304
    s_mov_b32 s11, 0x00020000
    s_mov_b32 s12, s30
    s_mov_b32 s13, s31
    s_mov_b32 s14, 2048
    s_mov_b32 s15, 0x00020000
    v_and_b32 v96, 31, v2
    v_lshlrev_b32 v96, 11, v96
    v_lshrrev_b32 v97, 5, v2
    v_lshlrev_b32 v97, 4, v97
    v_add_u32 v96, v96, v97
    s_lshl_b32 s27, s20, 18
    s_lshl_b32 s28, s3, 16
    s_add_u32 s27, s27, s28
    s_add_u32 s27, s27, s26
    s_add_u32 s28, s27, 12582912
    buffer_load_dwordx4 v[112:115], v96, s[8:11], s27 offen offset:0
    buffer_load_dwordx4 v[128:131], v97, s[12:15], s26 offen offset:0
    buffer_load_dwordx4 v[116:119], v96, s[8:11], s27 offen offset:32
    buffer_load_dwordx4 v[132:135], v97, s[12:15], s26 offen offset:32
    buffer_load_dwordx4 v[120:123], v96, s[8:11], s27 offen offset:64
    buffer_load_dwordx4 v[136:139], v97, s[12:15], s26 offen offset:64
    buffer_load_dwordx4 v[124:127], v96, s[8:11], s27 offen offset:96
    buffer_load_dwordx4 v[140:143], v97, s[12:15], s26 offen offset:96
    s_nop 15
    s_nop 3
    v_cvt_pk_bf16_f32 v144, v32, v33
    v_cvt_pk_bf16_f32 v145, v34, v35
    v_cvt_pk_bf16_f32 v146, v36, v37
    v_cvt_pk_bf16_f32 v147, v38, v39
    v_cvt_pk_bf16_f32 v148, v40, v41
    v_cvt_pk_bf16_f32 v149, v42, v43
    v_cvt_pk_bf16_f32 v150, v44, v45
    v_cvt_pk_bf16_f32 v151, v46, v47
    s_nop 1
    v_permlane32_swap_b32 v144, v146
    v_permlane32_swap_b32 v145, v147
    v_permlane32_swap_b32 v148, v150
    v_permlane32_swap_b32 v149, v151
    v_cvt_pk_bf16_f32 v152, v48, v49
    v_cvt_pk_bf16_f32 v153, v50, v51
    v_cvt_pk_bf16_f32 v154, v52, v53
    v_cvt_pk_bf16_f32 v155, v54, v55
    v_cvt_pk_bf16_f32 v156, v56, v57
    v_cvt_pk_bf16_f32 v157, v58, v59
    v_cvt_pk_bf16_f32 v158, v60, v61
    v_cvt_pk_bf16_f32 v159, v62, v63
    s_nop 1
    v_permlane32_swap_b32 v152, v154
    v_permlane32_swap_b32 v153, v155
    v_permlane32_swap_b32 v156, v158
    v_permlane32_swap_b32 v157, v159
    v_mov_b32 v160, 0
    v_mov_b32 v161, 0
    v_mov_b32 v162, 0
    s_waitcnt vmcnt(0)
    v_lshlrev_b32 v164, 16, v144
    v_and_b32 v165, 0xffff0000, v144
    v_lshlrev_b32 v166, 16, v112
    v_and_b32 v167, 0xffff0000, v112
    v_add_f32 v164, v164, v166
    v_add_f32 v165, v165, v167
    v_cvt_pk_bf16_f32 v168, v164, v165
    v_lshlrev_b32 v164, 16, v168
    v_and_b32 v165, 0xffff0000, v168
    v_cvt_pk_bf16_f32 v144, v164, v165
    v_lshlrev_b32 v166, 16, v128
    v_and_b32 v167, 0xffff0000, v128
    v_add_f32 v160, v160, v164
    v_add_f32 v160, v160, v165
    v_fmac_f32 v161, v164, v164
    v_fmac_f32 v161, v165, v165
    v_fmac_f32 v162, v164, v166
    v_fmac_f32 v162, v165, v167
    v_lshlrev_b32 v164, 16, v145
    v_and_b32 v165, 0xffff0000, v145
    v_lshlrev_b32 v166, 16, v113
    v_and_b32 v167, 0xffff0000, v113
    v_add_f32 v164, v164, v166
    v_add_f32 v165, v165, v167
    v_cvt_pk_bf16_f32 v168, v164, v165
    v_lshlrev_b32 v164, 16, v168
    v_and_b32 v165, 0xffff0000, v168
    v_cvt_pk_bf16_f32 v145, v164, v165
    v_lshlrev_b32 v166, 16, v129
    v_and_b32 v167, 0xffff0000, v129
    v_add_f32 v160, v160, v164
    v_add_f32 v160, v160, v165
    v_fmac_f32 v161, v164, v164
    v_fmac_f32 v161, v165, v165
    v_fmac_f32 v162, v164, v166
    v_fmac_f32 v162, v165, v167
    v_lshlrev_b32 v164, 16, v146
    v_and_b32 v165, 0xffff0000, v146
    v_lshlrev_b32 v166, 16, v114
    v_and_b32 v167, 0xffff0000, v114
    v_add_f32 v164, v164, v166
    v_add_f32 v165, v165, v167
    v_cvt_pk_bf16_f32 v168, v164, v165
    v_lshlrev_b32 v164, 16, v168
    v_and_b32 v165, 0xffff0000, v168
    v_cvt_pk_bf16_f32 v146, v164, v165
    v_lshlrev_b32 v166, 16, v130
    v_and_b32 v167, 0xffff0000, v130
    v_add_f32 v160, v160, v164
    v_add_f32 v160, v160, v165
    v_fmac_f32 v161, v164, v164
    v_fmac_f32 v161, v165, v165
    v_fmac_f32 v162, v164, v166
    v_fmac_f32 v162, v165, v167
    v_lshlrev_b32 v164, 16, v147
    v_and_b32 v165, 0xffff0000, v147
    v_lshlrev_b32 v166, 16, v115
    v_and_b32 v167, 0xffff0000, v115
    v_add_f32 v164, v164, v166
    v_add_f32 v165, v165, v167
    v_cvt_pk_bf16_f32 v168, v164, v165
    v_lshlrev_b32 v164, 16, v168
    v_and_b32 v165, 0xffff0000, v168
    v_cvt_pk_bf16_f32 v147, v164, v165
    v_lshlrev_b32 v166, 16, v131
    v_and_b32 v167, 0xffff0000, v131
    v_add_f32 v160, v160, v164
    v_add_f32 v160, v160, v165
    v_fmac_f32 v161, v164, v164
    v_fmac_f32 v161, v165, v165
    v_fmac_f32 v162, v164, v166
    v_fmac_f32 v162, v165, v167
    buffer_store_dwordx4 v[144:147], v96, s[16:19], s28 offen offset:0
    v_lshlrev_b32 v164, 16, v148
    v_and_b32 v165, 0xffff0000, v148
    v_lshlrev_b32 v166, 16, v116
    v_and_b32 v167, 0xffff0000, v116
    v_add_f32 v164, v164, v166
    v_add_f32 v165, v165, v167
    v_cvt_pk_bf16_f32 v168, v164, v165
    v_lshlrev_b32 v164, 16, v168
    v_and_b32 v165, 0xffff0000, v168
    v_cvt_pk_bf16_f32 v148, v164, v165
    v_lshlrev_b32 v166, 16, v132
    v_and_b32 v167, 0xffff0000, v132
    v_add_f32 v160, v160, v164
    v_add_f32 v160, v160, v165
    v_fmac_f32 v161, v164, v164
    v_fmac_f32 v161, v165, v165
    v_fmac_f32 v162, v164, v166
    v_fmac_f32 v162, v165, v167
    v_lshlrev_b32 v164, 16, v149
    v_and_b32 v165, 0xffff0000, v149
    v_lshlrev_b32 v166, 16, v117
    v_and_b32 v167, 0xffff0000, v117
    v_add_f32 v164, v164, v166
    v_add_f32 v165, v165, v167
    v_cvt_pk_bf16_f32 v168, v164, v165
    v_lshlrev_b32 v164, 16, v168
    v_and_b32 v165, 0xffff0000, v168
    v_cvt_pk_bf16_f32 v149, v164, v165
    v_lshlrev_b32 v166, 16, v133
    v_and_b32 v167, 0xffff0000, v133
    v_add_f32 v160, v160, v164
    v_add_f32 v160, v160, v165
    v_fmac_f32 v161, v164, v164
    v_fmac_f32 v161, v165, v165
    v_fmac_f32 v162, v164, v166
    v_fmac_f32 v162, v165, v167
    v_lshlrev_b32 v164, 16, v150
    v_and_b32 v165, 0xffff0000, v150
    v_lshlrev_b32 v166, 16, v118
    v_and_b32 v167, 0xffff0000, v118
    v_add_f32 v164, v164, v166
    v_add_f32 v165, v165, v167
    v_cvt_pk_bf16_f32 v168, v164, v165
    v_lshlrev_b32 v164, 16, v168
    v_and_b32 v165, 0xffff0000, v168
    v_cvt_pk_bf16_f32 v150, v164, v165
    v_lshlrev_b32 v166, 16, v134
    v_and_b32 v167, 0xffff0000, v134
    v_add_f32 v160, v160, v164
    v_add_f32 v160, v160, v165
    v_fmac_f32 v161, v164, v164
    v_fmac_f32 v161, v165, v165
    v_fmac_f32 v162, v164, v166
    v_fmac_f32 v162, v165, v167
    v_lshlrev_b32 v164, 16, v151
    v_and_b32 v165, 0xffff0000, v151
    v_lshlrev_b32 v166, 16, v119
    v_and_b32 v167, 0xffff0000, v119
    v_add_f32 v164, v164, v166
    v_add_f32 v165, v165, v167
    v_cvt_pk_bf16_f32 v168, v164, v165
    v_lshlrev_b32 v164, 16, v168
    v_and_b32 v165, 0xffff0000, v168
    v_cvt_pk_bf16_f32 v151, v164, v165
    v_lshlrev_b32 v166, 16, v135
    v_and_b32 v167, 0xffff0000, v135
    v_add_f32 v160, v160, v164
    v_add_f32 v160, v160, v165
    v_fmac_f32 v161, v164, v164
    v_fmac_f32 v161, v165, v165
    v_fmac_f32 v162, v164, v166
    v_fmac_f32 v162, v165, v167
    buffer_store_dwordx4 v[148:151], v96, s[16:19], s28 offen offset:32
    v_lshlrev_b32 v164, 16, v152
    v_and_b32 v165, 0xffff0000, v152
    v_lshlrev_b32 v166, 16, v120
    v_and_b32 v167, 0xffff0000, v120
    v_add_f32 v164, v164, v166
    v_add_f32 v165, v165, v167
    v_cvt_pk_bf16_f32 v168, v164, v165
    v_lshlrev_b32 v164, 16, v168
    v_and_b32 v165, 0xffff0000, v168
    v_cvt_pk_bf16_f32 v152, v164, v165
    v_lshlrev_b32 v166, 16, v136
    v_and_b32 v167, 0xffff0000, v136
    v_add_f32 v160, v160, v164
    v_add_f32 v160, v160, v165
    v_fmac_f32 v161, v164, v164
    v_fmac_f32 v161, v165, v165
    v_fmac_f32 v162, v164, v166
    v_fmac_f32 v162, v165, v167
    v_lshlrev_b32 v164, 16, v153
    v_and_b32 v165, 0xffff0000, v153
    v_lshlrev_b32 v166, 16, v121
    v_and_b32 v167, 0xffff0000, v121
    v_add_f32 v164, v164, v166
    v_add_f32 v165, v165, v167
    v_cvt_pk_bf16_f32 v168, v164, v165
    v_lshlrev_b32 v164, 16, v168
    v_and_b32 v165, 0xffff0000, v168
    v_cvt_pk_bf16_f32 v153, v164, v165
    v_lshlrev_b32 v166, 16, v137
    v_and_b32 v167, 0xffff0000, v137
    v_add_f32 v160, v160, v164
    v_add_f32 v160, v160, v165
    v_fmac_f32 v161, v164, v164
    v_fmac_f32 v161, v165, v165
    v_fmac_f32 v162, v164, v166
    v_fmac_f32 v162, v165, v167
    v_lshlrev_b32 v164, 16, v154
    v_and_b32 v165, 0xffff0000, v154
    v_lshlrev_b32 v166, 16, v122
    v_and_b32 v167, 0xffff0000, v122
    v_add_f32 v164, v164, v166
    v_add_f32 v165, v165, v167
    v_cvt_pk_bf16_f32 v168, v164, v165
    v_lshlrev_b32 v164, 16, v168
    v_and_b32 v165, 0xffff0000, v168
    v_cvt_pk_bf16_f32 v154, v164, v165
    v_lshlrev_b32 v166, 16, v138
    v_and_b32 v167, 0xffff0000, v138
    v_add_f32 v160, v160, v164
    v_add_f32 v160, v160, v165
    v_fmac_f32 v161, v164, v164
    v_fmac_f32 v161, v165, v165
    v_fmac_f32 v162, v164, v166
    v_fmac_f32 v162, v165, v167
    v_lshlrev_b32 v164, 16, v155
    v_and_b32 v165, 0xffff0000, v155
    v_lshlrev_b32 v166, 16, v123
    v_and_b32 v167, 0xffff0000, v123
    v_add_f32 v164, v164, v166
    v_add_f32 v165, v165, v167
    v_cvt_pk_bf16_f32 v168, v164, v165
    v_lshlrev_b32 v164, 16, v168
    v_and_b32 v165, 0xffff0000, v168
    v_cvt_pk_bf16_f32 v155, v164, v165
    v_lshlrev_b32 v166, 16, v139
    v_and_b32 v167, 0xffff0000, v139
    v_add_f32 v160, v160, v164
    v_add_f32 v160, v160, v165
    v_fmac_f32 v161, v164, v164
    v_fmac_f32 v161, v165, v165
    v_fmac_f32 v162, v164, v166
    v_fmac_f32 v162, v165, v167
    buffer_store_dwordx4 v[152:155], v96, s[16:19], s28 offen offset:64
    v_lshlrev_b32 v164, 16, v156
    v_and_b32 v165, 0xffff0000, v156
    v_lshlrev_b32 v166, 16, v124
    v_and_b32 v167, 0xffff0000, v124
    v_add_f32 v164, v164, v166
    v_add_f32 v165, v165, v167
    v_cvt_pk_bf16_f32 v168, v164, v165
    v_lshlrev_b32 v164, 16, v168
    v_and_b32 v165, 0xffff0000, v168
    v_cvt_pk_bf16_f32 v156, v164, v165
    v_lshlrev_b32 v166, 16, v140
    v_and_b32 v167, 0xffff0000, v140
    v_add_f32 v160, v160, v164
    v_add_f32 v160, v160, v165
    v_fmac_f32 v161, v164, v164
    v_fmac_f32 v161, v165, v165
    v_fmac_f32 v162, v164, v166
    v_fmac_f32 v162, v165, v167
    v_lshlrev_b32 v164, 16, v157
    v_and_b32 v165, 0xffff0000, v157
    v_lshlrev_b32 v166, 16, v125
    v_and_b32 v167, 0xffff0000, v125
    v_add_f32 v164, v164, v166
    v_add_f32 v165, v165, v167
    v_cvt_pk_bf16_f32 v168, v164, v165
    v_lshlrev_b32 v164, 16, v168
    v_and_b32 v165, 0xffff0000, v168
    v_cvt_pk_bf16_f32 v157, v164, v165
    v_lshlrev_b32 v166, 16, v141
    v_and_b32 v167, 0xffff0000, v141
    v_add_f32 v160, v160, v164
    v_add_f32 v160, v160, v165
    v_fmac_f32 v161, v164, v164
    v_fmac_f32 v161, v165, v165
    v_fmac_f32 v162, v164, v166
    v_fmac_f32 v162, v165, v167
    v_lshlrev_b32 v164, 16, v158
    v_and_b32 v165, 0xffff0000, v158
    v_lshlrev_b32 v166, 16, v126
    v_and_b32 v167, 0xffff0000, v126
    v_add_f32 v164, v164, v166
    v_add_f32 v165, v165, v167
    v_cvt_pk_bf16_f32 v168, v164, v165
    v_lshlrev_b32 v164, 16, v168
    v_and_b32 v165, 0xffff0000, v168
    v_cvt_pk_bf16_f32 v158, v164, v165
    v_lshlrev_b32 v166, 16, v142
    v_and_b32 v167, 0xffff0000, v142
    v_add_f32 v160, v160, v164
    v_add_f32 v160, v160, v165
    v_fmac_f32 v161, v164, v164
    v_fmac_f32 v161, v165, v165
    v_fmac_f32 v162, v164, v166
    v_fmac_f32 v162, v165, v167
    v_lshlrev_b32 v164, 16, v159
    v_and_b32 v165, 0xffff0000, v159
    v_lshlrev_b32 v166, 16, v127
    v_and_b32 v167, 0xffff0000, v127
    v_add_f32 v164, v164, v166
    v_add_f32 v165, v165, v167
    v_cvt_pk_bf16_f32 v168, v164, v165
    v_lshlrev_b32 v164, 16, v168
    v_and_b32 v165, 0xffff0000, v168
    v_cvt_pk_bf16_f32 v159, v164, v165
    v_lshlrev_b32 v166, 16, v143
    v_and_b32 v167, 0xffff0000, v143
    v_add_f32 v160, v160, v164
    v_add_f32 v160, v160, v165
    v_fmac_f32 v161, v164, v164
    v_fmac_f32 v161, v165, v165
    v_fmac_f32 v162, v164, v166
    v_fmac_f32 v162, v165, v167
    buffer_store_dwordx4 v[156:159], v96, s[16:19], s28 offen offset:96
    v_mov_b32 v164, v160
    v_mov_b32 v165, v160
    s_nop 1
    v_permlane32_swap_b32 v164, v165
    v_add_f32 v160, v164, v165
    v_mov_b32 v164, v161
    v_mov_b32 v165, v161
    s_nop 1
    v_permlane32_swap_b32 v164, v165
    v_add_f32 v161, v164, v165
    v_mov_b32 v164, v162
    v_mov_b32 v165, v162
    s_nop 1
    v_permlane32_swap_b32 v164, v165
    v_add_f32 v162, v164, v165
    v_and_b32 v96, 31, v2
    v_lshlrev_b32 v96, 2, v96
    s_lshl_b32 s27, s20, 9
    s_lshl_b32 s28, s3, 7
    s_add_u32 s27, s27, s28
    s_add_u32 s27, s27, 24117248
    s_mov_b64 exec, 0xffffffff
    buffer_atomic_add_f32 v160, v96, s[16:19], s27 offen
    s_add_u32 s27, s27, 8192
    buffer_atomic_add_f32 v161, v96, s[16:19], s27 offen
    s_add_u32 s27, s27, 8192
    buffer_atomic_add_f32 v162, v96, s[16:19], s27 offen
    s_endpgm
L_end_k2b_kernel:
    s_endpgm
.text
.globl k3b_kernel
.p2align 8
.type k3b_kernel,@function
k3b_kernel:
    s_cmp_ge_u32 s2, 224
    s_cbranch_scc1 L_end_k3b_kernel
    s_load_dwordx2 s[4:5], s[0:1], 80
    s_load_dwordx2 s[6:7], s[0:1], 40
    s_load_dwordx2 s[28:29], s[0:1], 48
    v_lshrrev_b32 v1, 6, v0
    v_and_b32 v2, 63, v0
    s_nop 0
    v_readfirstlane_b32 s3, v1
    s_mul_hi_u32 s20, s2, 0x924924a
    s_mul_i32 s21, s20, 28
    s_sub_u32 s21, s2, s21
    s_waitcnt lgkmcnt(0)
    s_mov_b32 s16, s4
    s_mov_b32 s17, s5
    s_mov_b32 s18, 29360128
    s_mov_b32 s19, 0x00020000
    s_mov_b32 s8, s6
    s_mov_b32 s9, s7
    s_mov_b32 s10, 7340032
    s_mov_b32 s11, 0x00020000
    s_mov_b32 s12, s28
    s_mov_b32 s13, s29
    s_mov_b32 s14, 7340032
    s_mov_b32 s15, 0x00020000
    v_lshlrev_b32 v4, 2, v0
    s_mov_b32 s22, 24117248
    buffer_load_dword v32, v4, s[16:19], s22 offen
    s_mov_b32 s22, 24118272
    buffer_load_dword v33, v4, s[16:19], s22 offen
    s_mov_b32 s22, 24119296
    buffer_load_dword v34, v4, s[16:19], s22 offen
    s_mov_b32 s22, 24120320
    buffer_load_dword v35, v4, s[16:19], s22 offen
    s_mov_b32 s22, 24121344
    buffer_load_dword v36, v4, s[16:19], s22 offen
    s_mov_b32 s22, 24122368
    buffer_load_dword v37, v4, s[16:19], s22 offen
    s_mov_b32 s22, 24123392
    buffer_load_dword v38, v4, s[16:19], s22 offen
    s_mov_b32 s22, 24124416
    buffer_load_dword v39, v4, s[16:19], s22 offen
    s_mov_b32 s22, 24125440
    buffer_load_dword v40, v4, s[16:19], s22 offen
    s_mov_b32 s22, 24126464
    buffer_load_dword v41, v4, s[16:19], s22 offen
    s_mov_b32 s22, 24127488
    buffer_load_dword v42, v4, s[16:19], s22 offen
    s_mov_b32 s22, 24128512
    buffer_load_dword v43, v4, s[16:19], s22 offen
    s_mov_b32 s22, 24129536
    buffer_load_dword v44, v4, s[16:19], s22 offen
    s_mov_b32 s22, 24130560
    buffer_load_dword v45, v4, s[16:19], s22 offen
    s_mov_b32 s22, 24131584
    buffer_load_dword v46, v4, s[16:19], s22 offen
    s_mov_b32 s22, 24132608
    buffer_load_dword v47, v4, s[16:19], s22 offen
    s_mov_b32 s22, 24133632
    buffer_load_dword v48, v4, s[16:19], s22 offen
    s_mov_b32 s22, 24134656
    buffer_load_dword v49, v4, s[16:19], s22 offen
    s_mov_b32 s22, 24135680
    buffer_load_dword v50, v4, s[16:19], s22 offen
    s_mov_b32 s22, 24136704
    buffer_load_dword v51, v4, s[16:19], s22 offen
    s_mov_b32 s22, 24137728
    buffer_load_dword v52, v4, s[16:19], s22 offen
    s_mov_b32 s22, 24138752
    buffer_load_dword v53, v4, s[16:19], s22 offen
    s_mov_b32 s22, 24139776
    buffer_load_dword v54, v4, s[16:19], s22 offen
    s_mov_b32 s22, 24140800
    buffer_load_dword v55, v4, s[16:19], s22 offen
    v_mov_b32 v5, 0
    s_mov_b32 s22, 24182784
    buffer_load_dword v56, v5, s[16:19], s22 offen
    v_lshrrev_b32 v6, 4, v2
    v_lshlrev_b32 v7, 2, v6
    v_and_b32 v8, 15, v2
    v_xor_b32 v7, v7, v8
    v_lshlrev_b32 v7, 4, v7
    s_mov_b32 s22, 7168
    v_mul_lo_u32 v6, v6, s22
    v_add_u32 v6, v6, v7
    s_mul_i32 s22, s20, 917504
    s_lshl_b32 s23, s21, 8
    s_add_u32 s22, s22, s23
    s_mul_i32 s23, s3, 229376
    s_add_u32 s22, s22, s23
    s_lshl_b32 s23, s3, 13
    s_add_u32 s24, s23, 0
    s_mov_b32 m0, s24
    s_add_u32 s25, s22, 0
    buffer_load_dwordx4 v6, s[8:11], s25 offen lds
    s_add_u32 s24, s23, 1024
    s_mov_b32 m0, s24
    s_add_u32 s25, s22, 28672
    buffer_load_dwordx4 v6, s[8:11], s25 offen lds
    s_add_u32 s24, s23, 2048
    s_mov_b32 m0, s24
    s_add_u32 s25, s22, 57344
    buffer_load_dwordx4 v6, s[8:11], s25 offen lds
    s_add_u32 s24, s23, 3072
    s_mov_b32 m0, s24
    s_add_u32 s25, s22, 86016
    buffer_load_dwordx4 v6, s[8:11], s25 offen lds
    s_add_u32 s24, s23, 4096
    s_mov_b32 m0, s24
    s_add_u32 s25, s22, 114688
    buffer_load_dwordx4 v6, s[8:11], s25 offen lds
    s_add_u32 s24, s23, 5120
    s_mov_b32 m0, s24
    s_add_u32 s25, s22, 143360
    buffer_load_dwordx4 v6, s[8:11], s25 offen lds
    s_add_u32 s24, s23, 6144
    s_mov_b32 m0, s24
    s_add_u32 s25, s22, 172032
    buffer_load_dwordx4 v6, s[8:11], s25 offen lds
    s_add_u32 s24, s23, 7168
    s_mov_b32 m0, s24
    s_add_u32 s25, s22, 200704
    buffer_load_dwordx4 v6, s[8:11], s25 offen lds
    s_add_u32 s24, s23, 32768
    s_mov_b32 m0, s24
    s_add_u32 s25, s22, 0
    buffer_load_dwordx4 v6, s[12:15], s25 offen lds
    s_add_u32 s24, s23, 33792
    s_mov_b32 m0, s24
    s_add_u32 s25, s22, 28672
    buffer_load_dwordx4 v6, s[12:15], s25 offen lds
    s_add_u32 s24, s23, 34816
    s_mov_b32 m0, s24
    s_add_u32 s25, s22, 57344
    buffer_load_dwordx4 v6, s[12:15], s25 offen lds
    s_add_u32 s24, s23, 35840
    s_mov_b32 m0, s24
    s_add_u32 s25, s22, 86016
    buffer_load_dwordx4 v6, s[12:15], s25 offen lds
    s_add_u32 s24, s23, 36864
    s_mov_b32 m0, s24
    s_add_u32 s25, s22, 114688
    buffer_load_dwordx4 v6, s[12:15], s25 offen lds
    s_add_u32 s24, s23, 37888
    s_mov_b32 m0, s24
    s_add_u32 s25, s22, 143360
    buffer_load_dwordx4 v6, s[12:15], s25 offen lds
    s_add_u32 s24, s23, 38912
    s_mov_b32 m0, s24
    s_add_u32 s25, s22, 172032
    buffer_load_dwordx4 v6, s[12:15], s25 offen lds
    s_add_u32 s24, s23, 39936
    s_mov_b32 m0, s24
    s_add_u32 s25, s22, 200704
    buffer_load_dwordx4 v6, s[12:15], s25 offen lds
    s_waitcnt vmcnt(16)
    v_mul_f32 v32, 0x3a800000, v32
    v_mul_f32 v40, 0x3a800000, v40
    v_fma_f32 v40, -v32, v32, v40
    v_max_f32 v40, 0, v40
    v_cvt_pk_bf16_f32 v60, v32, v32
    v_lshlrev_b32 v32, 16, v60
    v_cvt_pk_bf16_f32 v60, v40, v40
    v_lshlrev_b32 v40, 16, v60
    v_add_f32 v40, 0x3727c5ac, v40
    v_cvt_pk_bf16_f32 v60, v40, v40
    v_lshlrev_b32 v40, 16, v60
    v_sqrt_f32 v40, v40
    s_nop 0
    v_cvt_pk_bf16_f32 v60, v40, v40
    v_lshlrev_b32 v40, 16, v60
    v_rcp_f32 v40, v40
    v_fma_f32 v48, -v32, v56, v48
    v_mul_f32 v48, v48, v40
    v_cvt_pk_bf16_f32 v60, v48, v48
    v_lshlrev_b32 v48, 16, v60
    v_not_b32 v60, v48
    v_or_b32 v61, 0x80000000, v48
    v_cmp_gt_i32 vcc, 0, v48
    s_nop 1
    v_cndmask_b32 v60, v61, v60, vcc
    v_and_b32 v60, 0xffff0000, v60
    v_sub_u32 v61, 65535, v0
    v_or_b32 v32, v60, v61
    v_mul_f32 v33, 0x3a800000, v33
    v_mul_f32 v41, 0x3a800000, v41
    v_fma_f32 v41, -v33, v33, v41
    v_max_f32 v41, 0, v41
    v_cvt_pk_bf16_f32 v60, v33, v33
    v_lshlrev_b32 v33, 16, v60
    v_cvt_pk_bf16_f32 v60, v41, v41
    v_lshlrev_b32 v41, 16, v60
    v_add_f32 v41, 0x3727c5ac, v41
    v_cvt_pk_bf16_f32 v60, v41, v41
    v_lshlrev_b32 v41, 16, v60
    v_sqrt_f32 v41, v41
    s_nop 0
    v_cvt_pk_bf16_f32 v60, v41, v41
    v_lshlrev_b32 v41, 16, v60
    v_rcp_f32 v41, v41
    v_fma_f32 v49, -v33, v56, v49
    v_mul_f32 v49, v49, v41
    v_cvt_pk_bf16_f32 v60, v49, v49
    v_lshlrev_b32 v49, 16, v60
    v_not_b32 v60, v49
    v_or_b32 v61, 0x80000000, v49
    v_cmp_gt_i32 vcc, 0, v49
    s_nop 1
    v_cndmask_b32 v60, v61, v60, vcc
    v_and_b32 v60, 0xffff0000, v60
    v_sub_u32 v61, 65279, v0
    v_or_b32 v33, v60, v61
    v_mul_f32 v34, 0x3a800000, v34
    v_mul_f32 v42, 0x3a800000, v42
    v_fma_f32 v42, -v34, v34, v42
    v_max_f32 v42, 0, v42
    v_cvt_pk_bf16_f32 v60, v34, v34
    v_lshlrev_b32 v34, 16, v60
    v_cvt_pk_bf16_f32 v60, v42, v42
    v_lshlrev_b32 v42, 16, v60
    v_add_f32 v42, 0x3727c5ac, v42
    v_cvt_pk_bf16_f32 v60, v42, v42
    v_lshlrev_b32 v42, 16, v60
    v_sqrt_f32 v42, v42
    s_nop 0
    v_cvt_pk_bf16_f32 v60, v42, v42
    v_lshlrev_b32 v42, 16, v60
    v_rcp_f32 v42, v42
    v_fma_f32 v50, -v34, v56, v50
    v_mul_f32 v50, v50, v42
    v_cvt_pk_bf16_f32 v60, v50, v50
    v_lshlrev_b32 v50, 16, v60
    v_not_b32 v60, v50
    v_or_b32 v61, 0x80000000, v50
    v_cmp_gt_i32 vcc, 0, v50
    s_nop 1
    v_cndmask_b32 v60, v61, v60, vcc
    v_and_b32 v60, 0xffff0000, v60
    v_sub_u32 v61, 65023, v0
    v_or_b32 v34, v60, v61
    v_mul_f32 v35, 0x3a800000, v35
    v_mul_f32 v43, 0x3a800000, v43
    v_fma_f32 v43, -v35, v35, v43
    v_max_f32 v43, 0, v43
    v_cvt_pk_bf16_f32 v60, v35, v35
    v_lshlrev_b32 v35, 16, v60
    v_cvt_pk_bf16_f32 v60, v43, v43
    v_lshlrev_b32 v43, 16, v60
    v_add_f32 v43, 0x3727c5ac, v43
    v_cvt_pk_bf16_f32 v60, v43, v43
    v_lshlrev_b32 v43, 16, v60
    v_sqrt_f32 v43, v43
    s_nop 0
    v_cvt_pk_bf16_f32 v60, v43, v43
    v_lshlrev_b32 v43, 16, v60
    v_rcp_f32 v43, v43
    v_fma_f32 v51, -v35, v56, v51
    v_mul_f32 v51, v51, v43
    v_cvt_pk_bf16_f32 v60, v51, v51
    v_lshlrev_b32 v51, 16, v60
    v_not_b32 v60, v51
    v_or_b32 v61, 0x80000000, v51
    v_cmp_gt_i32 vcc, 0, v51
    s_nop 1
    v_cndmask_b32 v60, v61, v60, vcc
    v_and_b32 v60, 0xffff0000, v60
    v_sub_u32 v61, 64767, v0
    v_or_b32 v35, v60, v61
    v_mul_f32 v36, 0x3a800000, v36
    v_mul_f32 v44, 0x3a800000, v44
    v_fma_f32 v44, -v36, v36, v44
    v_max_f32 v44, 0, v44
    v_cvt_pk_bf16_f32 v60, v36, v36
    v_lshlrev_b32 v36, 16, v60
    v_cvt_pk_bf16_f32 v60, v44, v44
    v_lshlrev_b32 v44, 16, v60
    v_add_f32 v44, 0x3727c5ac, v44
    v_cvt_pk_bf16_f32 v60, v44, v44
    v_lshlrev_b32 v44, 16, v60
    v_sqrt_f32 v44, v44
    s_nop 0
    v_cvt_pk_bf16_f32 v60, v44, v44
    v_lshlrev_b32 v44, 16, v60
    v_rcp_f32 v44, v44
    v_fma_f32 v52, -v36, v56, v52
    v_mul_f32 v52, v52, v44
    v_cvt_pk_bf16_f32 v60, v52, v52
    v_lshlrev_b32 v52, 16, v60
    v_not_b32 v60, v52
    v_or_b32 v61, 0x80000000, v52
    v_cmp_gt_i32 vcc, 0, v52
    s_nop 1
    v_cndmask_b32 v60, v61, v60, vcc
    v_and_b32 v60, 0xffff0000, v60
    v_sub_u32 v61, 64511, v0
    v_or_b32 v36, v60, v61
    v_mul_f32 v37, 0x3a800000, v37
    v_mul_f32 v45, 0x3a800000, v45
    v_fma_f32 v45, -v37, v37, v45
    v_max_f32 v45, 0, v45
    v_cvt_pk_bf16_f32 v60, v37, v37
    v_lshlrev_b32 v37, 16, v60
    v_cvt_pk_bf16_f32 v60, v45, v45
    v_lshlrev_b32 v45, 16, v60
    v_add_f32 v45, 0x3727c5ac, v45
    v_cvt_pk_bf16_f32 v60, v45, v45
    v_lshlrev_b32 v45, 16, v60
    v_sqrt_f32 v45, v45
    s_nop 0
    v_cvt_pk_bf16_f32 v60, v45, v45
    v_lshlrev_b32 v45, 16, v60
    v_rcp_f32 v45, v45
    v_fma_f32 v53, -v37, v56, v53
    v_mul_f32 v53, v53, v45
    v_cvt_pk_bf16_f32 v60, v53, v53
    v_lshlrev_b32 v53, 16, v60
    v_not_b32 v60, v53
    v_or_b32 v61, 0x80000000, v53
    v_cmp_gt_i32 vcc, 0, v53
    s_nop 1
    v_cndmask_b32 v60, v61, v60, vcc
    v_and_b32 v60, 0xffff0000, v60
    v_sub_u32 v61, 64255, v0
    v_or_b32 v37, v60, v61
    v_mul_f32 v38, 0x3a800000, v38
    v_mul_f32 v46, 0x3a800000, v46
    v_fma_f32 v46, -v38, v38, v46
    v_max_f32 v46, 0, v46
    v_cvt_pk_bf16_f32 v60, v38, v38
    v_lshlrev_b32 v38, 16, v60
    v_cvt_pk_bf16_f32 v60, v46, v46
    v_lshlrev_b32 v46, 16, v60
    v_add_f32 v46, 0x3727c5ac, v46
    v_cvt_pk_bf16_f32 v60, v46, v46
    v_lshlrev_b32 v46, 16, v60
    v_sqrt_f32 v46, v46
    s_nop 0
    v_cvt_pk_bf16_f32 v60, v46, v46
    v_lshlrev_b32 v46, 16, v60
    v_rcp_f32 v46, v46
    v_fma_f32 v54, -v38, v56, v54
    v_mul_f32 v54, v54, v46
    v_cvt_pk_bf16_f32 v60, v54, v54
    v_lshlrev_b32 v54, 16, v60
    v_not_b32 v60, v54
    v_or_b32 v61, 0x80000000, v54
    v_cmp_gt_i32 vcc, 0, v54
    s_nop 1
    v_cndmask_b32 v60, v61, v60, vcc
    v_and_b32 v60, 0xffff0000, v60
    v_sub_u32 v61, 63999, v0
    v_or_b32 v38, v60, v61
    v_mul_f32 v39, 0x3a800000, v39
    v_mul_f32 v47, 0x3a800000, v47
    v_fma_f32 v47, -v39, v39, v47
    v_max_f32 v47, 0, v47
    v_cvt_pk_bf16_f32 v60, v39, v39
    v_lshlrev_b32 v39, 16, v60
    v_cvt_pk_bf16_f32 v60, v47, v47
    v_lshlrev_b32 v47, 16, v60
    v_add_f32 v47, 0x3727c5ac, v47
    v_cvt_pk_bf16_f32 v60, v47, v47
    v_lshlrev_b32 v47, 16, v60
    v_sqrt_f32 v47, v47
    s_nop 0
    v_cvt_pk_bf16_f32 v60, v47, v47
    v_lshlrev_b32 v47, 16, v60
    v_rcp_f32 v47, v47
    v_fma_f32 v55, -v39, v56, v55
    v_mul_f32 v55, v55, v47
    v_cvt_pk_bf16_f32 v60, v55, v55
    v_lshlrev_b32 v55, 16, v60
    v_not_b32 v60, v55
    v_or_b32 v61, 0x80000000, v55
    v_cmp_gt_i32 vcc, 0, v55
    s_nop 1
    v_cndmask_b32 v60, v61, v60, vcc
    v_and_b32 v60, 0xffff0000, v60
    v_sub_u32 v61, 63743, v0
    v_or_b32 v39, v60, v61
    v_max_u32 v60, v32, v33
    v_max_u32 v60, v60, v34
    v_max_u32 v60, v60, v35
    v_max_u32 v60, v60, v36
    v_max_u32 v60, v60, v37
    v_max_u32 v60, v60, v38
    v_max_u32 v60, v60, v39
    s_nop 1
    v_max_u32_dpp v60, v60, v60 quad_perm:[1,0,3,2] row_mask:0xf bank_mask:0xf
    s_nop 1
    v_max_u32_dpp v60, v60, v60 quad_perm:[2,3,0,1] row_mask:0xf bank_mask:0xf
    s_nop 1
    v_max_u32_dpp v60, v60, v60 row_half_mirror row_mask:0xf bank_mask:0xf
    s_nop 1
    v_max_u32_dpp v60, v60, v60 row_mirror row_mask:0xf bank_mask:0xf
    s_nop 1
    v_readlane_b32 s70, v60, 0
    v_readlane_b32 s71, v60, 16
    v_readlane_b32 s72, v60, 32
    v_readlane_b32 s73, v60, 48
    s_nop 3
    s_max_u32 s70, s70, s71
    s_max_u32 s72, s72, s73
    s_max_u32 s70, s70, s72
    s_mov_b32 s60, s70
    v_cmp_eq_u32 vcc, s70, v32
    s_nop 1
    v_cndmask_b32 v32, v32, 0, vcc
    v_cmp_eq_u32 vcc, s70, v33
    s_nop 1
    v_cndmask_b32 v33, v33, 0, vcc
    v_cmp_eq_u32 vcc, s70, v34
    s_nop 1
    v_cndmask_b32 v34, v34, 0, vcc
    v_cmp_eq_u32 vcc, s70, v35
    s_nop 1
    v_cndmask_b32 v35, v35, 0, vcc
    v_cmp_eq_u32 vcc, s70, v36
    s_nop 1
    v_cndmask_b32 v36, v36, 0, vcc
    v_cmp_eq_u32 vcc, s70, v37
    s_nop 1
    v_cndmask_b32 v37, v37, 0, vcc
    v_cmp_eq_u32 vcc, s70, v38
    s_nop 1
    v_cndmask_b32 v38, v38, 0, vcc
    v_cmp_eq_u32 vcc, s70, v39
    s_nop 1
    v_cndmask_b32 v39, v39, 0, vcc
    v_max_u32 v60, v32, v33
    v_max_u32 v60, v60, v34
    v_max_u32 v60, v60, v35
    v_max_u32 v60, v60, v36
    v_max_u32 v60, v60, v37
    v_max_u32 v60, v60, v38
    v_max_u32 v60, v60, v39
    s_nop 1
    v_max_u32_dpp v60, v60, v60 quad_perm:[1,0,3,2] row_mask:0xf bank_mask:0xf
    s_nop 1
    v_max_u32_dpp v60, v60, v60 quad_perm:[2,3,0,1] row_mask:0xf bank_mask:0xf
    s_nop 1
    v_max_u32_dpp v60, v60, v60 row_half_mirror row_mask:0xf bank_mask:0xf
    s_nop 1
    v_max_u32_dpp v60, v60, v60 row_mirror row_mask:0xf bank_mask:0xf
    s_nop 1
    v_readlane_b32 s70, v60, 0
    v_readlane_b32 s71, v60, 16
    v_readlane_b32 s72, v60, 32
    v_readlane_b32 s73, v60, 48
    s_nop 3
    s_max_u32 s70, s70, s71
    s_max_u32 s72, s72, s73
    s_max_u32 s70, s70, s72
    s_mov_b32 s61, s70
    v_cmp_eq_u32 vcc, s70, v32
    s_nop 1
    v_cndmask_b32 v32, v32, 0, vcc
    v_cmp_eq_u32 vcc, s70, v33
    s_nop 1
    v_cndmask_b32 v33, v33, 0, vcc
    v_cmp_eq_u32 vcc, s70, v34
    s_nop 1
    v_cndmask_b32 v34, v34, 0, vcc
    v_cmp_eq_u32 vcc, s70, v35
    s_nop 1
    v_cndmask_b32 v35, v35, 0, vcc
    v_cmp_eq_u32 vcc, s70, v36
    s_nop 1
    v_cndmask_b32 v36, v36, 0, vcc
    v_cmp_eq_u32 vcc, s70, v37
    s_nop 1
    v_cndmask_b32 v37, v37, 0, vcc
    v_cmp_eq_u32 vcc, s70, v38
    s_nop 1
    v_cndmask_b32 v38, v38, 0, vcc
    v_cmp_eq_u32 vcc, s70, v39
    s_nop 1
    v_cndmask_b32 v39, v39, 0, vcc
    v_max_u32 v60, v32, v33
    v_max_u32 v60, v60, v34
    v_max_u32 v60, v60, v35
    v_max_u32 v60, v60, v36
    v_max_u32 v60, v60, v37
    v_max_u32 v60, v60, v38
    v_max_u32 v60, v60, v39
    s_nop 1
    v_max_u32_dpp v60, v60, v60 quad_perm:[1,0,3,2] row_mask:0xf bank_mask:0xf
    s_nop 1
    v_max_u32_dpp v60, v60, v60 quad_perm:[2,3,0,1] row_mask:0xf bank_mask:0xf
    s_nop 1
    v_max_u32_dpp v60, v60, v60 row_half_mirror row_mask:0xf bank_mask:0xf
    s_nop 1
    v_max_u32_dpp v60, v60, v60 row_mirror row_mask:0xf bank_mask:0xf
    s_nop 1
    v_readlane_b32 s70, v60, 0
    v_readlane_b32 s71, v60, 16
    v_readlane_b32 s72, v60, 32
    v_readlane_b32 s73, v60, 48
    s_nop 3
    s_max_u32 s70, s70, s71
    s_max_u32 s72, s72, s73
    s_max_u32 s70, s70, s72
    s_mov_b32 s62, s70
    v_cmp_eq_u32 vcc, s70, v32
    s_nop 1
    v_cndmask_b32 v32, v32, 0, vcc
    v_cmp_eq_u32 vcc, s70, v33
    s_nop 1
    v_cndmask_b32 v33, v33, 0, vcc
    v_cmp_eq_u32 vcc, s70, v34
    s_nop 1
    v_cndmask_b32 v34, v34, 0, vcc
    v_cmp_eq_u32 vcc, s70, v35
    s_nop 1
    v_cndmask_b32 v35, v35, 0, vcc
    v_cmp_eq_u32 vcc, s70, v36
    s_nop 1
    v_cndmask_b32 v36, v36, 0, vcc
    v_cmp_eq_u32 vcc, s70, v37
    s_nop 1
    v_cndmask_b32 v37, v37, 0, vcc
    v_cmp_eq_u32 vcc, s70, v38
    s_nop 1
    v_cndmask_b32 v38, v38, 0, vcc
    v_cmp_eq_u32 vcc, s70, v39
    s_nop 1
    v_cndmask_b32 v39, v39, 0, vcc
    v_max_u32 v60, v32, v33
    v_max_u32 v60, v60, v34
    v_max_u32 v60, v60, v35
    v_max_u32 v60, v60, v36
    v_max_u32 v60, v60, v37
    v_max_u32 v60, v60, v38
    v_max_u32 v60, v60, v39
    s_nop 1
    v_max_u32_dpp v60, v60, v60 quad_perm:[1,0,3,2] row_mask:0xf bank_mask:0xf
    s_nop 1
    v_max_u32_dpp v60, v60, v60 quad_perm:[2,3,0,1] row_mask:0xf bank_mask:0xf
    s_nop 1
    v_max_u32_dpp v60, v60, v60 row_half_mirror row_mask:0xf bank_mask:0xf
    s_nop 1
    v_max_u32_dpp v60, v60, v60 row_mirror row_mask:0xf bank_mask:0xf
    s_nop 1
    v_readlane_b32 s70, v60, 0
    v_readlane_b32 s71, v60, 16
    v_readlane_b32 s72, v60, 32
    v_readlane_b32 s73, v60, 48
    s_nop 3
    s_max_u32 s70, s70, s71
    s_max_u32 s72, s72, s73
    s_max_u32 s70, s70, s72
    s_mov_b32 s63, s70
    v_cmp_eq_u32 vcc, s70, v32
    s_nop 1
    v_cndmask_b32 v32, v32, 0, vcc
    v_cmp_eq_u32 vcc, s70, v33
    s_nop 1
    v_cndmask_b32 v33, v33, 0, vcc
    v_cmp_eq_u32 vcc, s70, v34
    s_nop 1
    v_cndmask_b32 v34, v34, 0, vcc
    v_cmp_eq_u32 vcc, s70, v35
    s_nop 1
    v_cndmask_b32 v35, v35, 0, vcc
    v_cmp_eq_u32 vcc, s70, v36
    s_nop 1
    v_cndmask_b32 v36, v36, 0, vcc
    v_cmp_eq_u32 vcc, s70, v37
    s_nop 1
    v_cndmask_b32 v37, v37, 0, vcc
    v_cmp_eq_u32 vcc, s70, v38
    s_nop 1
    v_cndmask_b32 v38, v38, 0, vcc
    v_cmp_eq_u32 vcc, s70, v39
    s_nop 1
    v_cndmask_b32 v39, v39, 0, vcc
    v_max_u32 v60, v32, v33
    v_max_u32 v60, v60, v34
    v_max_u32 v60, v60, v35
    v_max_u32 v60, v60, v36
    v_max_u32 v60, v60, v37
    v_max_u32 v60, v60, v38
    v_max_u32 v60, v60, v39
    s_nop 1
    v_max_u32_dpp v60, v60, v60 quad_perm:[1,0,3,2] row_mask:0xf bank_mask:0xf
    s_nop 1
    v_max_u32_dpp v60, v60, v60 quad_perm:[2,3,0,1] row_mask:0xf bank_mask:0xf
    s_nop 1
    v_max_u32_dpp v60, v60, v60 row_half_mirror row_mask:0xf bank_mask:0xf
    s_nop 1
    v_max_u32_dpp v60, v60, v60 row_mirror row_mask:0xf bank_mask:0xf
    s_nop 1
    v_readlane_b32 s70, v60, 0
    v_readlane_b32 s71, v60, 16
    v_readlane_b32 s72, v60, 32
    v_readlane_b32 s73, v60, 48
    s_nop 3
    s_max_u32 s70, s70, s71
    s_max_u32 s72, s72, s73
    s_max_u32 s70, s70, s72
    s_mov_b32 s64, s70
    v_cmp_eq_u32 vcc, s70, v32
    s_nop 1
    v_cndmask_b32 v32, v32, 0, vcc
    v_cmp_eq_u32 vcc, s70, v33
    s_nop 1
    v_cndmask_b32 v33, v33, 0, vcc
    v_cmp_eq_u32 vcc, s70, v34
    s_nop 1
    v_cndmask_b32 v34, v34, 0, vcc
    v_cmp_eq_u32 vcc, s70, v35
    s_nop 1
    v_cndmask_b32 v35, v35, 0, vcc
    v_cmp_eq_u32 vcc, s70, v36
    s_nop 1
    v_cndmask_b32 v36, v36, 0, vcc
    v_cmp_eq_u32 vcc, s70, v37
    s_nop 1
    v_cndmask_b32 v37, v37, 0, vcc
    v_cmp_eq_u32 vcc, s70, v38
    s_nop 1
    v_cndmask_b32 v38, v38, 0, vcc
    v_cmp_eq_u32 vcc, s70, v39
    s_nop 1
    v_cndmask_b32 v39, v39, 0, vcc
    v_max_u32 v60, v32, v33
    v_max_u32 v60, v60, v34
    v_max_u32 v60, v60, v35
    v_max_u32 v60, v60, v36
    v_max_u32 v60, v60, v37
    v_max_u32 v60, v60, v38
    v_max_u32 v60, v60, v39
    s_nop 1
    v_max_u32_dpp v60, v60, v60 quad_perm:[1,0,3,2] row_mask:0xf bank_mask:0xf
    s_nop 1
    v_max_u32_dpp v60, v60, v60 quad_perm:[2,3,0,1] row_mask:0xf bank_mask:0xf
    s_nop 1
    v_max_u32_dpp v60, v60, v60 row_half_mirror row_mask:0xf bank_mask:0xf
    s_nop 1
    v_max_u32_dpp v60, v60, v60 row_mirror row_mask:0xf bank_mask:0xf
    s_nop 1
    v_readlane_b32 s70, v60, 0
    v_readlane_b32 s71, v60, 16
    v_readlane_b32 s72, v60, 32
    v_readlane_b32 s73, v60, 48
    s_nop 3
    s_max_u32 s70, s70, s71
    s_max_u32 s72, s72, s73
    s_max_u32 s70, s70, s72
    s_mov_b32 s65, s70
    v_cmp_eq_u32 vcc, s70, v32
    s_nop 1
    v_cndmask_b32 v32, v32, 0, vcc
    v_cmp_eq_u32 vcc, s70, v33
    s_nop 1
    v_cndmask_b32 v33, v33, 0, vcc
    v_cmp_eq_u32 vcc, s70, v34
    s_nop 1
    v_cndmask_b32 v34, v34, 0, vcc
    v_cmp_eq_u32 vcc, s70, v35
    s_nop 1
    v_cndmask_b32 v35, v35, 0, vcc
    v_cmp_eq_u32 vcc, s70, v36
    s_nop 1
    v_cndmask_b32 v36, v36, 0, vcc
    v_cmp_eq_u32 vcc, s70, v37
    s_nop 1
    v_cndmask_b32 v37, v37, 0, vcc
    v_cmp_eq_u32 vcc, s70, v38
    s_nop 1
    v_cndmask_b32 v38, v38, 0, vcc
    v_cmp_eq_u32 vcc, s70, v39
    s_nop 1
    v_cndmask_b32 v39, v39, 0, vcc
    v_max_u32 v60, v32, v33
    v_max_u32 v60, v60, v34
    v_max_u32 v60, v60, v35
    v_max_u32 v60, v60, v36
    v_max_u32 v60, v60, v37
    v_max_u32 v60, v60, v38
    v_max_u32 v60, v60, v39
    s_nop 1
    v_max_u32_dpp v60, v60, v60 quad_perm:[1,0,3,2] row_mask:0xf bank_mask:0xf
    s_nop 1
    v_max_u32_dpp v60, v60, v60 quad_perm:[2,3,0,1] row_mask:0xf bank_mask:0xf
    s_nop 1
    v_max_u32_dpp v60, v60, v60 row_half_mirror row_mask:0xf bank_mask:0xf
    s_nop 1
    v_max_u32_dpp v60, v60, v60 row_mirror row_mask:0xf bank_mask:0xf
    s_nop 1
    v_readlane_b32 s70, v60, 0
    v_readlane_b32 s71, v60, 16
    v_readlane_b32 s72, v60, 32
    v_readlane_b32 s73, v60, 48
    s_nop 3
    s_max_u32 s70, s70, s71
    s_max_u32 s72, s72, s73
    s_max_u32 s70, s70, s72
    s_mov_b32 s66, s70
    v_cmp_eq_u32 vcc, s70, v32
    s_nop 1
    v_cndmask_b32 v32, v32, 0, vcc
    v_cmp_eq_u32 vcc, s70, v33
    s_nop 1
    v_cndmask_b32 v33, v33, 0, vcc
    v_cmp_eq_u32 vcc, s70, v34
    s_nop 1
    v_cndmask_b32 v34, v34, 0, vcc
    v_cmp_eq_u32 vcc, s70, v35
    s_nop 1
    v_cndmask_b32 v35, v35, 0, vcc
    v_cmp_eq_u32 vcc, s70, v36
    s_nop 1
    v_cndmask_b32 v36, v36, 0, vcc
    v_cmp_eq_u32 vcc, s70, v37
    s_nop 1
    v_cndmask_b32 v37, v37, 0, vcc
    v_cmp_eq_u32 vcc, s70, v38
    s_nop 1
    v_cndmask_b32 v38, v38, 0, vcc
    v_cmp_eq_u32 vcc, s70, v39
    s_nop 1
    v_cndmask_b32 v39, v39, 0, vcc
    v_max_u32 v60, v32, v33
    v_max_u32 v60, v60, v34
    v_max_u32 v60, v60, v35
    v_max_u32 v60, v60, v36
    v_max_u32 v60, v60, v37
    v_max_u32 v60, v60, v38
    v_max_u32 v60, v60, v39
    s_nop 1
    v_max_u32_dpp v60, v60, v60 quad_perm:[1,0,3,2] row_mask:0xf bank_mask:0xf
    s_nop 1
    v_max_u32_dpp v60, v60, v60 quad_perm:[2,3,0,1] row_mask:0xf bank_mask:0xf
    s_nop 1
    v_max_u32_dpp v60, v60, v60 row_half_mirror row_mask:0xf bank_mask:0xf
    s_nop 1
    v_max_u32_dpp v60, v60, v60 row_mirror row_mask:0xf bank_mask:0xf
    s_nop 1
    v_readlane_b32 s70, v60, 0
    v_readlane_b32 s71, v60, 16
    v_readlane_b32 s72, v60, 32
    v_readlane_b32 s73, v60, 48
    s_nop 3
    s_max_u32 s70, s70, s71
    s_max_u32 s72, s72, s73
    s_max_u32 s70, s70, s72
    s_mov_b32 s67, s70
    v_cmp_eq_u32 vcc, s70, v32
    s_nop 1
    v_cndmask_b32 v32, v32, 0, vcc
    v_cmp_eq_u32 vcc, s70, v33
    s_nop 1
    v_cndmask_b32 v33, v33, 0, vcc
    v_cmp_eq_u32 vcc, s70, v34
    s_nop 1
    v_cndmask_b32 v34, v34, 0, vcc
    v_cmp_eq_u32 vcc, s70, v35
    s_nop 1
    v_cndmask_b32 v35, v35, 0, vcc
    v_cmp_eq_u32 vcc, s70, v36
    s_nop 1
    v_cndmask_b32 v36, v36, 0, vcc
    v_cmp_eq_u32 vcc, s70, v37
    s_nop 1
    v_cndmask_b32 v37, v37, 0, vcc
    v_cmp_eq_u32 vcc, s70, v38
    s_nop 1
    v_cndmask_b32 v38, v38, 0, vcc
    v_cmp_eq_u32 vcc, s70, v39
    s_nop 1
    v_cndmask_b32 v39, v39, 0, vcc
    v_mov_b32 v60, 0
    v_writelane_b32 v60, s60, 0
    v_writelane_b32 v60, s61, 1
    v_writelane_b32 v60, s62, 2
    v_writelane_b32 v60, s63, 3
    v_writelane_b32 v60, s64, 4
    v_writelane_b32 v60, s65, 5
    v_writelane_b32 v60, s66, 6
    v_writelane_b32 v60, s67, 7
    v_lshlrev_b32 v61, 2, v2
    s_lshl_b32 s24, s3, 5
    v_add_u32 v61, s24, v61
    v_add_u32 v61, 73728, v61
    s_mov_b64 exec, 0xff
    ds_write_b32 v61, v60
    s_mov_b64 exec, -1
    s_waitcnt lgkmcnt(0)
    s_barrier
    v_lshlrev_b32 v61, 2, v2
    v_and_b32 v61, 127, v61
    v_add_u32 v61, 73728, v61
    ds_read_b32 v62, v61
    s_waitcnt lgkmcnt(0)
    v_cmp_gt_u32 vcc, 32, v2
    s_nop 1
    v_cndmask_b32 v62, 0, v62, vcc
    v_mov_b32 v60, v62
    s_nop 1
    v_max_u32_dpp v60, v60, v60 quad_perm:[1,0,3,2] row_mask:0xf bank_mask:0xf
    s_nop 1
    v_max_u32_dpp v60, v60, v60 quad_perm:[2,3,0,1] row_mask:0xf bank_mask:0xf
    s_nop 1
    v_max_u32_dpp v60, v60, v60 row_half_mirror row_mask:0xf bank_mask:0xf
    s_nop 1
    v_max_u32_dpp v60, v60, v60 row_mirror row_mask:0xf bank_mask:0xf
    s_nop 1
    v_readlane_b32 s70, v60, 0
    v_readlane_b32 s71, v60, 16
    v_readlane_b32 s72, v60, 32
    v_readlane_b32 s73, v60, 48
    s_nop 3
    s_max_u32 s70, s70, s71
    s_max_u32 s72, s72, s73
    s_max_u32 s70, s70, s72
    s_mov_b32 s60, s70
    v_cmp_eq_u32 vcc, s70, v62
    s_nop 1
    v_cndmask_b32 v62, v62, 0, vcc
    v_mov_b32 v60, v62
    s_nop 1
    v_max_u32_dpp v60, v60, v60 quad_perm:[1,0,3,2] row_mask:0xf bank_mask:0xf
    s_nop 1
    v_max_u32_dpp v60, v60, v60 quad_perm:[2,3,0,1] row_mask:0xf bank_mask:0xf
    s_nop 1
    v_max_u32_dpp v60, v60, v60 row_half_mirror row_mask:0xf bank_mask:0xf
    s_nop 1
    v_max_u32_dpp v60, v60, v60 row_mirror row_mask:0xf bank_mask:0xf
    s_nop 1
    v_readlane_b32 s70, v60, 0
    v_readlane_b32 s71, v60, 16
    v_readlane_b32 s72, v60, 32
    v_readlane_b32 s73, v60, 48
    s_nop 3
    s_max_u32 s70, s70, s71
    s_max_u32 s72, s72, s73
    s_max_u32 s70, s70, s72
    s_mov_b32 s61, s70
    v_cmp_eq_u32 vcc, s70, v62
    s_nop 1
    v_cndmask_b32 v62, v62, 0, vcc
    v_mov_b32 v60, v62
    s_nop 1
    v_max_u32_dpp v60, v60, v60 quad_perm:[1,0,3,2] row_mask:0xf bank_mask:0xf
    s_nop 1
    v_max_u32_dpp v60, v60, v60 quad_perm:[2,3,0,1] row_mask:0xf bank_mask:0xf
    s_nop 1
    v_max_u32_dpp v60, v60, v60 row_half_mirror row_mask:0xf bank_mask:0xf
    s_nop 1
    v_max_u32_dpp v60, v60, v60 row_mirror row_mask:0xf bank_mask:0xf
    s_nop 1
    v_readlane_b32 s70, v60, 0
    v_readlane_b32 s71, v60, 16
    v_readlane_b32 s72, v60, 32
    v_readlane_b32 s73, v60, 48
    s_nop 3
    s_max_u32 s70, s70, s71
    s_max_u32 s72, s72, s73
    s_max_u32 s70, s70, s72
    s_mov_b32 s62, s70
    v_cmp_eq_u32 vcc, s70, v62
    s_nop 1
    v_cndmask_b32 v62, v62, 0, vcc
    v_mov_b32 v60, v62
    s_nop 1
    v_max_u32_dpp v60, v60, v60 quad_perm:[1,0,3,2] row_mask:0xf bank_mask:0xf
    s_nop 1
    v_max_u32_dpp v60, v60, v60 quad_perm:[2,3,0,1] row_mask:0xf bank_mask:0xf
    s_nop 1
    v_max_u32_dpp v60, v60, v60 row_half_mirror row_mask:0xf bank_mask:0xf
    s_nop 1
    v_max_u32_dpp v60, v60, v60 row_mirror row_mask:0xf bank_mask:0xf
    s_nop 1
    v_readlane_b32 s70, v60, 0
    v_readlane_b32 s71, v60, 16
    v_readlane_b32 s72, v60, 32
    v_readlane_b32 s73, v60, 48
    s_nop 3
    s_max_u32 s70, s70, s71
    s_max_u32 s72, s72, s73
    s_max_u32 s70, s70, s72
    s_mov_b32 s63, s70
    v_cmp_eq_u32 vcc, s70, v62
    s_nop 1
    v_cndmask_b32 v62, v62, 0, vcc
    v_mov_b32 v60, v62
    s_nop 1
    v_max_u32_dpp v60, v60, v60 quad_perm:[1,0,3,2] row_mask:0xf bank_mask:0xf
    s_nop 1
    v_max_u32_dpp v60, v60, v60 quad_perm:[2,3,0,1] row_mask:0xf bank_mask:0xf
    s_nop 1
    v_max_u32_dpp v60, v60, v60 row_half_mirror row_mask:0xf bank_mask:0xf
    s_nop 1
    v_max_u32_dpp v60, v60, v60 row_mirror row_mask:0xf bank_mask:0xf
    s_nop 1
    v_readlane_b32 s70, v60, 0
    v_readlane_b32 s71, v60, 16
    v_readlane_b32 s72, v60, 32
    v_readlane_b32 s73, v60, 48
    s_nop 3
    s_max_u32 s70, s70, s71
    s_max_u32 s72, s72, s73
    s_max_u32 s70, s70, s72
    s_mov_b32 s64, s70
    v_cmp_eq_u32 vcc, s70, v62
    s_nop 1
    v_cndmask_b32 v62, v62, 0, vcc
    v_mov_b32 v60, v62
    s_nop 1
    v_max_u32_dpp v60, v60, v60 quad_perm:[1,0,3,2] row_mask:0xf bank_mask:0xf
    s_nop 1
    v_max_u32_dpp v60, v60, v60 quad_perm:[2,3,0,1] row_mask:0xf bank_mask:0xf
    s_nop 1
    v_max_u32_dpp v60, v60, v60 row_half_mirror row_mask:0xf bank_mask:0xf
    s_nop 1
    v_max_u32_dpp v60, v60, v60 row_mirror row_mask:0xf bank_mask:0xf
    s_nop 1
    v_readlane_b32 s70, v60, 0
    v_readlane_b32 s71, v60, 16
    v_readlane_b32 s72, v60, 32
    v_readlane_b32 s73, v60, 48
    s_nop 3
    s_max_u32 s70, s70, s71
    s_max_u32 s72, s72, s73
    s_max_u32 s70, s70, s72
    s_mov_b32 s65, s70
    v_cmp_eq_u32 vcc, s70, v62
    s_nop 1
    v_cndmask_b32 v62, v62, 0, vcc
    v_mov_b32 v60, v62
    s_nop 1
    v_max_u32_dpp v60, v60, v60 quad_perm:[1,0,3,2] row_mask:0xf bank_mask:0xf
    s_nop 1
    v_max_u32_dpp v60, v60, v60 quad_perm:[2,3,0,1] row_mask:0xf bank_mask:0xf
    s_nop 1
    v_max_u32_dpp v60, v60, v60 row_half_mirror row_mask:0xf bank_mask:0xf
    s_nop 1
    v_max_u32_dpp v60, v60, v60 row_mirror row_mask:0xf bank_mask:0xf
    s_nop 1
    v_readlane_b32 s70, v60, 0
    v_readlane_b32 s71, v60, 16
    v_readlane_b32 s72, v60, 32
    v_readlane_b32 s73, v60, 48
    s_nop 3
    s_max_u32 s70, s70, s71
    s_max_u32 s72, s72, s73
    s_max_u32 s70, s70, s72
    s_mov_b32 s66, s70
    v_cmp_eq_u32 vcc, s70, v62
    s_nop 1
    v_cndmask_b32 v62, v62, 0, vcc
    v_mov_b32 v60, v62
    s_nop 1
    v_max_u32_dpp v60, v60, v60 quad_perm:[1,0,3,2] row_mask:0xf bank_mask:0xf
    s_nop 1
    v_max_u32_dpp v60, v60, v60 quad_perm:[2,3,0,1] row_mask:0xf bank_mask:0xf
    s_nop 1
    v_max_u32_dpp v60, v60, v60 row_half_mirror row_mask:0xf bank_mask:0xf
    s_nop 1
    v_max_u32_dpp v60, v60, v60 row_mirror row_mask:0xf bank_mask:0xf
    s_nop 1
    v_readlane_b32 s70, v60, 0
    v_readlane_b32 s71, v60, 16
    v_readlane_b32 s72, v60, 32
    v_readlane_b32 s73, v60, 48
    s_nop 3
    s_max_u32 s70, s70, s71
    s_max_u32 s72, s72, s73
    s_max_u32 s70, s70, s72
    s_mov_b32 s67, s70
    v_cmp_eq_u32 vcc, s70, v62
    s_nop 1
    v_cndmask_b32 v62, v62, 0, vcc
    s_and_b32 s72, s60, 0xffff
    s_sub_u32 s72, 0xffff, s72
    s_and_b32 s73, s61, 0xffff
    s_sub_u32 s73, 0xffff, s73
    s_and_b32 s74, s62, 0xffff
    s_sub_u32 s74, 0xffff, s74
    s_and_b32 s75, s63, 0xffff
    s_sub_u32 s75, 0xffff, s75
    s_and_b32 s76, s64, 0xffff
    s_sub_u32 s76, 0xffff, s76
    s_and_b32 s77, s65, 0xffff
    s_sub_u32 s77, 0xffff, s77
    s_and_b32 s78, s66, 0xffff
    s_sub_u32 s78, 0xffff, s78
    s_and_b32 s79, s67, 0xffff
    s_sub_u32 s79, 0xffff, s79
    s_cmp_lg_u32 s2, 0
    s_cbranch_scc1 L_nosel_k3b_kernel
    s_cmp_lg_u32 s3, 0
    s_cbranch_scc1 L_nosel_k3b_kernel
    v_mov_b32 v60, 0
    v_mov_b32 v61, 0
    v_writelane_b32 v60, s72, 0
    v_writelane_b32 v61, s60, 0
    v_writelane_b32 v60, s73, 1
    v_writelane_b32 v61, s61, 1
    v_writelane_b32 v60, s74, 2
    v_writelane_b32 v61, s62, 2
    v_writelane_b32 v60, s75, 3
    v_writelane_b32 v61, s63, 3
    v_writelane_b32 v60, s76, 4
    v_writelane_b32 v61, s64, 4
    v_writelane_b32 v60, s77, 5
    v_writelane_b32 v61, s65, 5
    v_writelane_b32 v60, s78, 6
    v_writelane_b32 v61, s66, 6
    v_writelane_b32 v60, s79, 7
    v_writelane_b32 v61, s67, 7
    v_and_b32 v61, 0xffff0000, v61
    v_xor_b32 v62, 0x80000000, v61
    v_not_b32 v63, v61
    v_and_b32 v63, 0xffff0000, v63
    v_cmp_gt_i32 vcc, 0, v61
    s_nop 1
    v_cndmask_b32 v61, v63, v62, vcc
    v_mul_f32 v61, 0xbfb8aa3b, v61
    v_exp_f32 v61, v61
    s_nop 0
    v_add_f32 v61, 1.0, v61
    v_rcp_f32 v61, v61
    s_nop 0
    v_cvt_pk_bf16_f32 v62, v61, v61
    v_lshlrev_b32 v61, 16, v62
    v_lshlrev_b32 v62, 2, v2
    s_mov_b64 exec, 0xff
    s_mov_b32 s24, 24183808
    buffer_store_dword v60, v62, s[16:19], s24 offen
    buffer_store_dword v61, v62, s[16:19], s24 offen offset:32
    s_mov_b64 exec, -1
L_nosel_k3b_kernel:
    s_mov_b32 s24, s72
    s_mov_b32 s25, s73
    s_cmp_eq_u32 s3, 1
    s_cselect_b32 s24, s74, s24
    s_cselect_b32 s25, s75, s25
    s_cmp_eq_u32 s3, 2
    s_cselect_b32 s24, s76, s24
    s_cselect_b32 s25, s77, s25
    s_cmp_eq_u32 s3, 3
    s_cselect_b32 s24, s78, s24
    s_cselect_b32 s25, s79, s25
    v_mov_b32 v60, s24
    v_mov_b32 v61, s25
    v_cmp_gt_u32 vcc, 32, v2
    s_nop 1
    v_cndmask_b32 v60, v61, v60, vcc
    v_lshlrev_b32 v61, 2, v60
    s_mov_b32 s24, 24117248
    buffer_load_dword v32, v61, s[16:19], s24 offen
    s_mov_b32 s24, 24125440
    buffer_load_dword v33, v61, s[16:19], s24 offen
    v_lshlrev_b32 v61, 11, v60
    v_and_b32 v62, 31, v2
    v_lshlrev_b32 v62, 3, v62
    v_add_u32 v61, v61, v62
    s_lshl_b32 s24, s20, 8
    s_add_u32 s24, s24, 12582912
    buffer_load_dwordx2 v[34:35], v61, s[16:19], s24 offen
    s_waitcnt vmcnt(0)
    v_mul_f32 v32, 0x3a800000, v32
    v_mul_f32 v33, 0x3a800000, v33
    v_fma_f32 v33, -v32, v32, v33
    v_max_f32 v33, 0, v33
    v_cvt_pk_bf16_f32 v60, v32, v32
    v_lshlrev_b32 v32, 16, v60
    v_cvt_pk_bf16_f32 v60, v33, v33
    v_lshlrev_b32 v33, 16, v60
    v_add_f32 v33, 0x3727c5ac, v33
    v_cvt_pk_bf16_f32 v60, v33, v33
    v_lshlrev_b32 v33, 16, v60
    v_sqrt_f32 v33, v33
    s_nop 0
    v_cvt_pk_bf16_f32 v60, v33, v33
    v_lshlrev_b32 v33, 16, v60
    v_rcp_f32 v33, v33
    s_nop 0
    v_lshlrev_b32 v36, 16, v34
    v_and_b32 v37, 0xffff0000, v34
    v_lshlrev_b32 v38, 16, v35
    v_and_b32 v39, 0xffff0000, v35
    v_sub_f32 v36, v36, v32
    v_sub_f32 v37, v37, v32
    v_cvt_pk_bf16_f32 v60, v36, v37
    v_lshlrev_b32 v36, 16, v60
    v_and_b32 v37, 0xffff0000, v60
    v_mul_f32 v36, v36, v33
    v_mul_f32 v37, v37, v33
    v_sub_f32 v38, v38, v32
    v_sub_f32 v39, v39, v32
    v_cvt_pk_bf16_f32 v60, v38, v39
    v_lshlrev_b32 v38, 16, v60
    v_and_b32 v39, 0xffff0000, v60
    v_mul_f32 v38, v38, v33
    v_mul_f32 v39, v39, v33
    v_cvt_pk_bf16_f32 v34, v36, v37
    v_cvt_pk_bf16_f32 v35, v38, v39
    v_lshrrev_b32 v60, 5, v2
    s_lshl_b32 s24, s3, 1
    v_add_u32 v60, s24, v60
    v_lshlrev_b32 v60, 8, v60
    v_add_u32 v60, v60, v62
    v_add_u32 v60, 65536, v60
    ds_write_b64 v60, v[34:35]
    s_waitcnt lgkmcnt(0)
    s_barrier
    v_lshrrev_b32 v60, 5, v2
    v_lshlrev_b32 v60, 3, v60
    v_lshrrev_b32 v61, 2, v2
    v_and_b32 v61, 3, v61
    v_add_u32 v60, v60, v61
    v_lshlrev_b32 v60, 8, v60
    v_lshrrev_b32 v62, 4, v2
    v_and_b32 v62, 1, v62
    v_lshlrev_b32 v62, 1, v62
    v_lshrrev_b32 v63, 1, v2
    v_and_b32 v63, 1, v63
    v_add_u32 v62, v62, v63
    s_lshl_b32 s24, s3, 2
    v_add_u32 v62, s24, v62
    v_lshlrev_b32 v61, 2, v61
    v_xor_b32 v62, v62, v61
    v_lshlrev_b32 v62, 4, v62
    v_add_u32 v60, v60, v62
    v_and_b32 v62, 1, v2
    v_lshlrev_b32 v62, 3, v62
    v_add_u32 v60, v60, v62
    v_and_b32 v61, 31, v2
    v_lshlrev_b32 v61, 8, v61
    v_lshrrev_b32 v62, 5, v2
    v_lshlrev_b32 v62, 4, v62
    v_add_u32 v61, v61, v62
    v_add_u32 v61, 65536, v61
    v_add_u32 v63, 32768, v60
    v_mov_b32 v96, 0
    v_mov_b32 v97, 0
    v_mov_b32 v98, 0
    v_mov_b32 v99, 0
    v_mov_b32 v100, 0
    v_mov_b32 v101, 0
    v_mov_b32 v102, 0
    v_mov_b32 v103, 0
    v_mov_b32 v104, 0
    v_mov_b32 v105, 0
    v_mov_b32 v106, 0
    v_mov_b32 v107, 0
    v_mov_b32 v108, 0
    v_mov_b32 v109, 0
    v_mov_b32 v110, 0
    v_mov_b32 v111, 0
    v_mov_b32 v112, 0
    v_mov_b32 v113, 0
    v_mov_b32 v114, 0
    v_mov_b32 v115, 0
    v_mov_b32 v116, 0
    v_mov_b32 v117, 0
    v_mov_b32 v118, 0
    v_mov_b32 v119, 0
    v_mov_b32 v120, 0
    v_mov_b32 v121, 0
    v_mov_b32 v122, 0
    v_mov_b32 v123, 0
    v_mov_b32 v124, 0
    v_mov_b32 v125, 0
    v_mov_b32 v126, 0
    v_mov_b32 v127, 0
    ds_read_b128 v[64:67], v61 offset:0
    ds_read_b128 v[68:71], v61 offset:32
    ds_read_b128 v[72:75], v61 offset:64
    ds_read_b128 v[76:79], v61 offset:96
    ds_read_b128 v[80:83], v61 offset:128
    ds_read_b128 v[84:87], v61 offset:160
    ds_read_b128 v[88:91], v61 offset:192
    ds_read_b128 v[92:95], v61 offset:224
    ds_read_b64_tr_b16 v[128:129], v60 offset:0
    ds_read_b64_tr_b16 v[130:131], v60 offset:1024
    ds_read_b64_tr_b16 v[132:133], v60 offset:4096
    ds_read_b64_tr_b16 v[134:135], v60 offset:5120
    ds_read_b64_tr_b16 v[136:137], v60 offset:8192
    ds_read_b64_tr_b16 v[138:139], v60 offset:9216
    ds_read_b64_tr_b16 v[140:141], v60 offset:12288
    ds_read_b64_tr_b16 v[142:143], v60 offset:13312
    ds_read_b64_tr_b16 v[144:145], v60 offset:16384
    ds_read_b64_tr_b16 v[146:147], v60 offset:17408
    ds_read_b64_tr_b16 v[148:149], v60 offset:20480
    ds_read_b64_tr_b16 v[150:151], v60 offset:21504
    ds_read_b64_tr_b16 v[152:153], v60 offset:24576
    ds_read_b64_tr_b16 v[154:155], v60 offset:25600
    ds_read_b64_tr_b16 v[156:157], v60 offset:28672
    ds_read_b64_tr_b16 v[158:159], v60 offset:29696
    ds_read_b64_tr_b16 v[160:161], v63 offset:0
    ds_read_b64_tr_b16 v[162:163], v63 offset:1024
    ds_read_b64_tr_b16 v[164:165], v63 offset:4096
    ds_read_b64_tr_b16 v[166:167], v63 offset:5120
    ds_read_b64_tr_b16 v[168:169], v63 offset:8192
    ds_read_b64_tr_b16 v[170:171], v63 offset:9216
    ds_read_b64_tr_b16 v[172:173], v63 offset:12288
    ds_read_b64_tr_b16 v[174:175], v63 offset:13312
    ds_read_b64_tr_b16 v[176:177], v63 offset:16384
    ds_read_b64_tr_b16 v[178:179], v63 offset:17408
    ds_read_b64_tr_b16 v[180:181], v63 offset:20480
    ds_read_b64_tr_b16 v[182:183], v63 offset:21504
    ds_read_b64_tr_b16 v[184:185], v63 offset:24576
    ds_read_b64_tr_b16 v[186:187], v63 offset:25600
    ds_read_b64_tr_b16 v[188:189], v63 offset:28672
    ds_read_b64_tr_b16 v[190:191], v63 offset:29696
    s_waitcnt lgkmcnt(0)
    s_nop 1
    v_mfma_f32_32x32x16_bf16 v[96:111], v[128:131], v[64:67], v[96:111]
    v_mfma_f32_32x32x16_bf16 v[96:111], v[132:135], v[68:71], v[96:111]
    v_mfma_f32_32x32x16_bf16 v[96:111], v[136:139], v[72:75], v[96:111]
    v_mfma_f32_32x32x16_bf16 v[96:111], v[140:143], v[76:79], v[96:111]
    v_mfma_f32_32x32x16_bf16 v[96:111], v[144:147], v[80:83], v[96:111]
    v_mfma_f32_32x32x16_bf16 v[96:111], v[148:151], v[84:87], v[96:111]
    v_mfma_f32_32x32x16_bf16 v[96:111], v[152:155], v[88:91], v[96:111]
    v_mfma_f32_32x32x16_bf16 v[96:111], v[156:159], v[92:95], v[96:111]
    v_mfma_f32_32x32x16_bf16 v[112:127], v[160:163], v[64:67], v[112:127]
    v_mfma_f32_32x32x16_bf16 v[112:127], v[164:167], v[68:71], v[112:127]
    v_mfma_f32_32x32x16_bf16 v[112:127], v[168:171], v[72:75], v[112:127]
    v_mfma_f32_32x32x16_bf16 v[112:127], v[172:175], v[76:79], v[112:127]
    v_mfma_f32_32x32x16_bf16 v[112:127], v[176:179], v[80:83], v[112:127]
    v_mfma_f32_32x32x16_bf16 v[112:127], v[180:183], v[84:87], v[112:127]
    v_mfma_f32_32x32x16_bf16 v[112:127], v[184:187], v[88:91], v[112:127]
    v_mfma_f32_32x32x16_bf16 v[112:127], v[188:191], v[92:95], v[112:127]
    s_nop 15
    s_nop 3
    v_and_b32 v60, 31, v2
    v_cmp_gt_u32 vcc, 8, v60
    s_nop 1
    s_and_b64 exec, exec, vcc
    s_mov_b32 s24, 14336
    v_mul_lo_u32 v60, v60, s24
    v_lshrrev_b32 v61, 5, v2
    v_lshlrev_b32 v61, 4, v61
    v_add_u32 v60, v60, v61
    s_lshl_b32 s24, s20, 1
    s_add_u32 s24, s24, 0
    s_mul_i32 s24, s24, 114688
    s_lshl_b32 s25, s21, 9
    s_add_u32 s24, s24, s25
    s_lshl_b32 s25, s3, 7
    s_add_u32 s24, s24, s25
    s_add_u32 s24, s24, 25165824
    buffer_store_dwordx4 v[96:99], v60, s[16:19], s24 offen offset:0
    buffer_store_dwordx4 v[100:103], v60, s[16:19], s24 offen offset:32
    buffer_store_dwordx4 v[104:107], v60, s[16:19], s24 offen offset:64
    buffer_store_dwordx4 v[108:111], v60, s[16:19], s24 offen offset:96
    s_lshl_b32 s24, s20, 1
    s_add_u32 s24, s24, 1
    s_mul_i32 s24, s24, 114688
    s_lshl_b32 s25, s21, 9
    s_add_u32 s24, s24, s25
    s_lshl_b32 s25, s3, 7
    s_add_u32 s24, s24, s25
    s_add_u32 s24, s24, 25165824
    buffer_store_dwordx4 v[112:115], v60, s[16:19], s24 offen offset:0
    buffer_store_dwordx4 v[116:119], v60, s[16:19], s24 offen offset:32
    buffer_store_dwordx4 v[120:123], v60, s[16:19], s24 offen offset:64
    buffer_store_dwordx4 v[124:127], v60, s[16:19], s24 offen offset:96
    s_endpgm
L_end_k3b_kernel:
    s_endpgm
.text
.globl k4b_kernel
.p2align 8
.type k4b_kernel,@function
k4b_kernel:
    s_cmp_ge_u32 s2, 224
    s_cbranch_scc1 L_end_k4b_kernel
    s_load_dwordx2 s[4:5], s[0:1], 80
    s_load_dwordx2 s[6:7], s[0:1], 56
    v_lshrrev_b32 v1, 6, v0
    v_and_b32 v2, 63, v0
    s_nop 0
    v_readfirstlane_b32 s3, v1
    s_lshr_b32 s20, s2, 4
    s_and_b32 s21, s2, 15
    s_waitcnt lgkmcnt(0)
    s_mov_b32 s16, s4
    s_mov_b32 s17, s5
    s_mov_b32 s18, 29360128
    s_mov_b32 s19, 0x00020000
    s_mov_b32 s8, s6
    s_mov_b32 s9, s7
    s_mov_b32 s10, 7340032
    s_mov_b32 s11, 0x00020000
    v_lshrrev_b32 v4, 5, v0
    s_mov_b32 s22, 14336
    v_mul_lo_u32 v4, v4, s22
    v_and_b32 v5, 31, v0
    v_lshlrev_b32 v5, 5, v5
    v_add_u32 v4, v4, v5
    s_lshl_b32 s22, s20, 10
    s_add_u32 s22, s22, 25165824
    s_add_u32 s23, s22, 0
    buffer_load_dwordx4 v[32:35], v4, s[16:19], s23 offen
    buffer_load_dwordx4 v[36:39], v4, s[16:19], s23 offen offset:16
    s_add_u32 s23, s22, 114688
    buffer_load_dwordx4 v[40:43], v4, s[16:19], s23 offen
    buffer_load_dwordx4 v[44:47], v4, s[16:19], s23 offen offset:16
    s_add_u32 s23, s22, 229376
    buffer_load_dwordx4 v[48:51], v4, s[16:19], s23 offen
    buffer_load_dwordx4 v[52:55], v4, s[16:19], s23 offen offset:16
    s_add_u32 s23, s22, 344064
    buffer_load_dwordx4 v[56:59], v4, s[16:19], s23 offen
    buffer_load_dwordx4 v[60:63], v4, s[16:19], s23 offen offset:16
    s_add_u32 s23, s22, 458752
    buffer_load_dwordx4 v[64:67], v4, s[16:19], s23 offen
    buffer_load_dwordx4 v[68:71], v4, s[16:19], s23 offen offset:16
    s_add_u32 s23, s22, 573440
    buffer_load_dwordx4 v[72:75], v4, s[16:19], s23 offen
    buffer_load_dwordx4 v[76:79], v4, s[16:19], s23 offen offset:16
    s_add_u32 s23, s22, 688128
    buffer_load_dwordx4 v[80:83], v4, s[16:19], s23 offen
    buffer_load_dwordx4 v[84:87], v4, s[16:19], s23 offen offset:16
    s_add_u32 s23, s22, 802816
    buffer_load_dwordx4 v[88:91], v4, s[16:19], s23 offen
    buffer_load_dwordx4 v[92:95], v4, s[16:19], s23 offen offset:16
    s_add_u32 s23, s22, 917504
    buffer_load_dwordx4 v[96:99], v4, s[16:19], s23 offen
    buffer_load_dwordx4 v[100:103], v4, s[16:19], s23 offen offset:16
    s_add_u32 s23, s22, 1032192
    buffer_load_dwordx4 v[104:107], v4, s[16:19], s23 offen
    buffer_load_dwordx4 v[108:111], v4, s[16:19], s23 offen offset:16
    s_add_u32 s23, s22, 1146880
    buffer_load_dwordx4 v[112:115], v4, s[16:19], s23 offen
    buffer_load_dwordx4 v[116:119], v4, s[16:19], s23 offen offset:16
    s_add_u32 s23, s22, 1261568
    buffer_load_dwordx4 v[120:123], v4, s[16:19], s23 offen
    buffer_load_dwordx4 v[124:127], v4, s[16:19], s23 offen offset:16
    s_add_u32 s23, s22, 1376256
    buffer_load_dwordx4 v[128:131], v4, s[16:19], s23 offen
    buffer_load_dwordx4 v[132:135], v4, s[16:19], s23 offen offset:16
    s_add_u32 s23, s22, 1490944
    buffer_load_dwordx4 v[136:139], v4, s[16:19], s23 offen
    buffer_load_dwordx4 v[140:143], v4, s[16:19], s23 offen offset:16
    s_add_u32 s23, s22, 1605632
    buffer_load_dwordx4 v[144:147], v4, s[16:19], s23 offen
    buffer_load_dwordx4 v[148:151], v4, s[16:19], s23 offen offset:16
    s_add_u32 s23, s22, 1720320
    buffer_load_dwordx4 v[152:155], v4, s[16:19], s23 offen
    buffer_load_dwordx4 v[156:159], v4, s[16:19], s23 offen offset:16
    v_lshrrev_b32 v6, 4, v2
    v_and_b32 v6, 1, v6
    v_lshlrev_b32 v6, 2, v6
    v_and_b32 v7, 7, v2
    v_xor_b32 v6, v6, v7
    v_lshlrev_b32 v6, 4, v6
    v_lshrrev_b32 v7, 3, v2
    v_lshlrev_b32 v7, 11, v7
    v_add_u32 v6, v6, v7
    s_lshl_b32 s22, s20, 19
    s_lshl_b32 s23, s21, 7
    s_add_u32 s22, s22, s23
    s_lshl_b32 s23, s3, 17
    s_add_u32 s22, s22, s23
    s_lshl_b32 s23, s3, 13
    s_add_u32 s24, s23, 0
    s_mov_b32 m0, s24
    s_add_u32 s25, s22, 0
    buffer_load_dwordx4 v6, s[8:11], s25 offen lds
    s_add_u32 s24, s23, 1024
    s_mov_b32 m0, s24
    s_add_u32 s25, s22, 16384
    buffer_load_dwordx4 v6, s[8:11], s25 offen lds
    s_add_u32 s24, s23, 2048
    s_mov_b32 m0, s24
    s_add_u32 s25, s22, 32768
    buffer_load_dwordx4 v6, s[8:11], s25 offen lds
    s_add_u32 s24, s23, 3072
    s_mov_b32 m0, s24
    s_add_u32 s25, s22, 49152
    buffer_load_dwordx4 v6, s[8:11], s25 offen lds
    s_add_u32 s24, s23, 4096
    s_mov_b32 m0, s24
    s_add_u32 s25, s22, 65536
    buffer_load_dwordx4 v6, s[8:11], s25 offen lds
    s_add_u32 s24, s23, 5120
    s_mov_b32 m0, s24
    s_add_u32 s25, s22, 81920
    buffer_load_dwordx4 v6, s[8:11], s25 offen lds
    s_add_u32 s24, s23, 6144
    s_mov_b32 m0, s24
    s_add_u32 s25, s22, 98304
    buffer_load_dwordx4 v6, s[8:11], s25 offen lds
    s_add_u32 s24, s23, 7168
    s_mov_b32 m0, s24
    s_add_u32 s25, s22, 114688
    buffer_load_dwordx4 v6, s[8:11], s25 offen lds
    s_waitcnt vmcnt(8)
    v_add_f32 v32, v32, v48
    v_add_f32 v33, v33, v49
    v_add_f32 v34, v34, v50
    v_add_f32 v35, v35, v51
    v_add_f32 v36, v36, v52
    v_add_f32 v37, v37, v53
    v_add_f32 v38, v38, v54
    v_add_f32 v39, v39, v55
    v_add_f32 v40, v40, v56
    v_add_f32 v41, v41, v57
    v_add_f32 v42, v42, v58
    v_add_f32 v43, v43, v59
    v_add_f32 v44, v44, v60
    v_add_f32 v45, v45, v61
    v_add_f32 v46, v46, v62
    v_add_f32 v47, v47, v63
    v_add_f32 v32, v32, v64
    v_add_f32 v33, v33, v65
    v_add_f32 v34, v34, v66
    v_add_f32 v35, v35, v67
    v_add_f32 v36, v36, v68
    v_add_f32 v37, v37, v69
    v_add_f32 v38, v38, v70
    v_add_f32 v39, v39, v71
    v_add_f32 v40, v40, v72
    v_add_f32 v41, v41, v73
    v_add_f32 v42, v42, v74
    v_add_f32 v43, v43, v75
    v_add_f32 v44, v44, v76
    v_add_f32 v45, v45, v77
    v_add_f32 v46, v46, v78
    v_add_f32 v47, v47, v79
    v_add_f32 v32, v32, v80
    v_add_f32 v33, v33, v81
    v_add_f32 v34, v34, v82
    v_add_f32 v35, v35, v83
    v_add_f32 v36, v36, v84
    v_add_f32 v37, v37, v85
    v_add_f32 v38, v38, v86
    v_add_f32 v39, v39, v87
    v_add_f32 v40, v40, v88
    v_add_f32 v41, v41, v89
    v_add_f32 v42, v42, v90
    v_add_f32 v43, v43, v91
    v_add_f32 v44, v44, v92
    v_add_f32 v45, v45, v93
    v_add_f32 v46, v46, v94
    v_add_f32 v47, v47, v95
    v_add_f32 v32, v32, v96
    v_add_f32 v33, v33, v97
    v_add_f32 v34, v34, v98
    v_add_f32 v35, v35, v99
    v_add_f32 v36, v36, v100
    v_add_f32 v37, v37, v101
    v_add_f32 v38, v38, v102
    v_add_f32 v39, v39, v103
    v_add_f32 v40, v40, v104
    v_add_f32 v41, v41, v105
    v_add_f32 v42, v42, v106
    v_add_f32 v43, v43, v107
    v_add_f32 v44, v44, v108
    v_add_f32 v45, v45, v109
    v_add_f32 v46, v46, v110
    v_add_f32 v47, v47, v111
    v_add_f32 v32, v32, v112
    v_add_f32 v33, v33, v113
    v_add_f32 v34, v34, v114
    v_add_f32 v35, v35, v115
    v_add_f32 v36, v36, v116
    v_add_f32 v37, v37, v117
    v_add_f32 v38, v38, v118
    v_add_f32 v39, v39, v119
    v_add_f32 v40, v40, v120
    v_add_f32 v41, v41, v121
    v_add_f32 v42, v42, v122
    v_add_f32 v43, v43, v123
    v_add_f32 v44, v44, v124
    v_add_f32 v45, v45, v125
    v_add_f32 v46, v46, v126
    v_add_f32 v47, v47, v127
    v_add_f32 v32, v32, v128
    v_add_f32 v33, v33, v129
    v_add_f32 v34, v34, v130
    v_add_f32 v35, v35, v131
    v_add_f32 v36, v36, v132
    v_add_f32 v37, v37, v133
    v_add_f32 v38, v38, v134
    v_add_f32 v39, v39, v135
    v_add_f32 v40, v40, v136
    v_add_f32 v41, v41, v137
    v_add_f32 v42, v42, v138
    v_add_f32 v43, v43, v139
    v_add_f32 v44, v44, v140
    v_add_f32 v45, v45, v141
    v_add_f32 v46, v46, v142
    v_add_f32 v47, v47, v143
    v_add_f32 v32, v32, v144
    v_add_f32 v33, v33, v145
    v_add_f32 v34, v34, v146
    v_add_f32 v35, v35, v147
    v_add_f32 v36, v36, v148
    v_add_f32 v37, v37, v149
    v_add_f32 v38, v38, v150
    v_add_f32 v39, v39, v151
    v_add_f32 v40, v40, v152
    v_add_f32 v41, v41, v153
    v_add_f32 v42, v42, v154
    v_add_f32 v43, v43, v155
    v_add_f32 v44, v44, v156
    v_add_f32 v45, v45, v157
    v_add_f32 v46, v46, v158
    v_add_f32 v47, v47, v159
    v_cvt_pk_bf16_f32 v60, v32, v33
    v_lshlrev_b32 v32, 16, v60
    v_and_b32 v33, 0xffff0000, v60
    v_cvt_pk_bf16_f32 v60, v40, v41
    v_lshlrev_b32 v40, 16, v60
    v_and_b32 v41, 0xffff0000, v60
    v_mul_f32 v61, 0xbfb8aa3b, v32
    v_mul_f32 v62, 0xbfb8aa3b, v33
    v_exp_f32 v61, v61
    v_exp_f32 v62, v62
    s_nop 0
    v_add_f32 v61, 1.0, v61
    v_add_f32 v62, 1.0, v62
    v_rcp_f32 v61, v61
    v_rcp_f32 v62, v62
    s_nop 0
    v_mul_f32 v32, v32, v61
    v_mul_f32 v33, v33, v62
    v_cvt_pk_bf16_f32 v60, v32, v33
    v_lshlrev_b32 v32, 16, v60
    v_and_b32 v33, 0xffff0000, v60
    v_mul_f32 v32, v32, v40
    v_mul_f32 v33, v33, v41
    v_cvt_pk_bf16_f32 v48, v32, v33
    v_cvt_pk_bf16_f32 v60, v34, v35
    v_lshlrev_b32 v34, 16, v60
    v_and_b32 v35, 0xffff0000, v60
    v_cvt_pk_bf16_f32 v60, v42, v43
    v_lshlrev_b32 v42, 16, v60
    v_and_b32 v43, 0xffff0000, v60
    v_mul_f32 v61, 0xbfb8aa3b, v34
    v_mul_f32 v62, 0xbfb8aa3b, v35
    v_exp_f32 v61, v61
    v_exp_f32 v62, v62
    s_nop 0
    v_add_f32 v61, 1.0, v61
    v_add_f32 v62, 1.0, v62
    v_rcp_f32 v61, v61
    v_rcp_f32 v62, v62
    s_nop 0
    v_mul_f32 v34, v34, v61
    v_mul_f32 v35, v35, v62
    v_cvt_pk_bf16_f32 v60, v34, v35
    v_lshlrev_b32 v34, 16, v60
    v_and_b32 v35, 0xffff0000, v60
    v_mul_f32 v34, v34, v42
    v_mul_f32 v35, v35, v43
    v_cvt_pk_bf16_f32 v49, v34, v35
    v_cvt_pk_bf16_f32 v60, v36, v37
    v_lshlrev_b32 v36, 16, v60
    v_and_b32 v37, 0xffff0000, v60
    v_cvt_pk_bf16_f32 v60, v44, v45
    v_lshlrev_b32 v44, 16, v60
    v_and_b32 v45, 0xffff0000, v60
    v_mul_f32 v61, 0xbfb8aa3b, v36
    v_mul_f32 v62, 0xbfb8aa3b, v37
    v_exp_f32 v61, v61
    v_exp_f32 v62, v62
    s_nop 0
    v_add_f32 v61, 1.0, v61
    v_add_f32 v62, 1.0, v62
    v_rcp_f32 v61, v61
    v_rcp_f32 v62, v62
    s_nop 0
    v_mul_f32 v36, v36, v61
    v_mul_f32 v37, v37, v62
    v_cvt_pk_bf16_f32 v60, v36, v37
    v_lshlrev_b32 v36, 16, v60
    v_and_b32 v37, 0xffff0000, v60
    v_mul_f32 v36, v36, v44
    v_mul_f32 v37, v37, v45
    v_cvt_pk_bf16_f32 v50, v36, v37
    v_cvt_pk_bf16_f32 v60, v38, v39
    v_lshlrev_b32 v38, 16, v60
    v_and_b32 v39, 0xffff0000, v60
    v_cvt_pk_bf16_f32 v60, v46, v47
    v_lshlrev_b32 v46, 16, v60
    v_and_b32 v47, 0xffff0000, v60
    v_mul_f32 v61, 0xbfb8aa3b, v38
    v_mul_f32 v62, 0xbfb8aa3b, v39
    v_exp_f32 v61, v61
    v_exp_f32 v62, v62
    s_nop 0
    v_add_f32 v61, 1.0, v61
    v_add_f32 v62, 1.0, v62
    v_rcp_f32 v61, v61
    v_rcp_f32 v62, v62
    s_nop 0
    v_mul_f32 v38, v38, v61
    v_mul_f32 v39, v39, v62
    v_cvt_pk_bf16_f32 v60, v38, v39
    v_lshlrev_b32 v38, 16, v60
    v_and_b32 v39, 0xffff0000, v60
    v_mul_f32 v38, v38, v46
    v_mul_f32 v39, v39, v47
    v_cvt_pk_bf16_f32 v51, v38, v39
    v_lshrrev_b32 v4, 5, v0
    v_lshlrev_b32 v4, 9, v4
    v_and_b32 v5, 31, v0
    v_lshlrev_b32 v5, 4, v5
    v_add_u32 v4, v4, v5
    v_add_u32 v4, 32768, v4
    ds_write_b128 v4, v[48:51]
    s_waitcnt vmcnt(0) lgkmcnt(0)
    s_barrier
    v_lshrrev_b32 v60, 4, v2
    v_lshlrev_b32 v60, 3, v60
    v_lshrrev_b32 v61, 2, v2
    v_and_b32 v61, 3, v61
    v_add_u32 v60, v60, v61
    v_lshlrev_b32 v60, 7, v60
    v_lshrrev_b32 v62, 1, v2
    v_and_b32 v62, 1, v62
    s_lshl_b32 s24, s3, 1
    v_add_u32 v62, s24, v62
    v_lshrrev_b32 v63, 1, v61
    v_and_b32 v63, 1, v63
    v_lshlrev_b32 v63, 2, v63
    v_xor_b32 v62, v62, v63
    v_lshlrev_b32 v62, 4, v62
    v_add_u32 v60, v60, v62
    v_and_b32 v62, 1, v2
    v_lshlrev_b32 v62, 3, v62
    v_add_u32 v60, v60, v62
    v_and_b32 v61, 15, v2
    v_lshlrev_b32 v61, 9, v61
    v_lshrrev_b32 v62, 4, v2
    v_lshlrev_b32 v62, 4, v62
    v_add_u32 v61, v61, v62
    v_add_u32 v61, 32768, v61
    v_mov_b32 v96, 0
    v_mov_b32 v97, 0
    v_mov_b32 v98, 0
    v_mov_b32 v99, 0
    ds_read_b128 v[64:67], v61 offset:0
    ds_read_b64_tr_b16 v[128:129], v60 offset:0
    ds_read_b64_tr_b16 v[130:131], v60 offset:512
    ds_read_b128 v[68:71], v61 offset:64
    ds_read_b64_tr_b16 v[132:133], v60 offset:4096
    ds_read_b64_tr_b16 v[134:135], v60 offset:4608
    ds_read_b128 v[72:75], v61 offset:128
    ds_read_b64_tr_b16 v[136:137], v60 offset:8192
    ds_read_b64_tr_b16 v[138:139], v60 offset:8704
    ds_read_b128 v[76:79], v61 offset:192
    ds_read_b64_tr_b16 v[140:141], v60 offset:12288
    ds_read_b64_tr_b16 v[142:143], v60 offset:12800
    ds_read_b128 v[80:83], v61 offset:256
    ds_read_b64_tr_b16 v[144:145], v60 offset:16384
    ds_read_b64_tr_b16 v[146:147], v60 offset:16896
    ds_read_b128 v[84:87], v61 offset:320
    ds_read_b64_tr_b16 v[148:149], v60 offset:20480
    ds_read_b64_tr_b16 v[150:151], v60 offset:20992
    ds_read_b128 v[88:91], v61 offset:384
    ds_read_b64_tr_b16 v[152:153], v60 offset:24576
    ds_read_b64_tr_b16 v[154:155], v60 offset:25088
    ds_read_b128 v[92:95], v61 offset:448
    ds_read_b64_tr_b16 v[156:157], v60 offset:28672
    ds_read_b64_tr_b16 v[158:159], v60 offset:29184
    s_waitcnt lgkmcnt(0)
    s_nop 1
    v_mfma_f32_16x16x32_bf16 v[96:99], v[128:131], v[64:67], v[96:99]
    v_mfma_f32_16x16x32_bf16 v[96:99], v[132:135], v[68:71], v[96:99]
    v_mfma_f32_16x16x32_bf16 v[96:99], v[136:139], v[72:75], v[96:99]
    v_mfma_f32_16x16x32_bf16 v[96:99], v[140:143], v[76:79], v[96:99]
    v_mfma_f32_16x16x32_bf16 v[96:99], v[144:147], v[80:83], v[96:99]
    v_mfma_f32_16x16x32_bf16 v[96:99], v[148:151], v[84:87], v[96:99]
    v_mfma_f32_16x16x32_bf16 v[96:99], v[152:155], v[88:91], v[96:99]
    v_mfma_f32_16x16x32_bf16 v[96:99], v[156:159], v[92:95], v[96:99]
    s_nop 15
    v_and_b32 v60, 15, v2
    v_cmp_gt_u32 vcc, 8, v60
    s_nop 1
    s_and_b64 exec, exec, vcc
    v_lshlrev_b32 v60, 12, v60
    v_lshrrev_b32 v61, 4, v2
    v_lshlrev_b32 v61, 4, v61
    v_add_u32 v60, v60, v61
    s_lshl_b32 s24, s20, 15
    s_lshl_b32 s25, s21, 8
    s_add_u32 s24, s24, s25
    s_lshl_b32 s25, s3, 6
    s_add_u32 s24, s24, s25
    s_add_u32 s24, s24, 27262976
    buffer_store_dwordx4 v[96:99], v60, s[16:19], s24 offen
    s_endpgm
L_end_k4b_kernel:
    s_endpgm
.text
.globl k5b_kernel
.p2align 8
.type k5b_kernel,@function
k5b_kernel:
    s_cmp_ge_u32 s2, 512
    s_cbranch_scc1 L_end_k5b_kernel
    s_load_dwordx2 s[4:5], s[0:1], 80
    s_load_dwordx2 s[6:7], s[0:1], 64
    v_lshrrev_b32 v1, 6, v0
    v_and_b32 v2, 63, v0
    s_nop 0
    v_readfirstlane_b32 s3, v1
    s_lshl_b32 s20, s2, 2
    s_add_u32 s20, s20, s3
    s_lshl_b32 s21, s20, 11
    v_lshlrev_b32 v3, 4, v2
    s_waitcnt lgkmcnt(0)
    s_add_u32 s8, s4, 12582912
    s_addc_u32 s9, s5, 0
    s_mov_b32 s10, 4194304
    s_mov_b32 s11, 0x00020000
    s_mov_b32 s12, s4
    s_mov_b32 s13, s5
    s_mov_b32 s14, 4194304
    s_mov_b32 s15, 0x00020000
    s_mov_b32 s16, s4
    s_mov_b32 s17, s5
    s_mov_b32 s18, 29360128
    s_mov_b32 s19, 0x00020000
    buffer_load_dwordx4 v[4:7], v3, s[8:11], s21 offen
    buffer_load_dwordx4 v[8:11], v3, s[8:11], s21 offen offset:1024
    s_lshl_b32 s22, s20, 2
    v_mov_b32 v12, 0
    s_add_u32 s23, s22, 24117248
    buffer_load_dword v13, v12, s[16:19], s23 offen
    s_add_u32 s23, s22, 24125440
    buffer_load_dword v14, v12, s[16:19], s23 offen
    s_add_u32 s24, s4, 24183808
    s_addc_u32 s25, s5, 0
    s_load_dwordx8 s[32:39], s[24:25], 0
    s_load_dwordx8 s[40:47], s[24:25], 32
    s_waitcnt vmcnt(0)
    v_lshlrev_b32 v16, 16, v4
    v_and_b32 v17, 0xffff0000, v4
    v_lshlrev_b32 v18, 16, v5
    v_and_b32 v19, 0xffff0000, v5
    v_lshlrev_b32 v20, 16, v6
    v_and_b32 v21, 0xffff0000, v6
    v_lshlrev_b32 v22, 16, v7
    v_and_b32 v23, 0xffff0000, v7
    v_lshlrev_b32 v24, 16, v8
    v_and_b32 v25, 0xffff0000, v8
    v_lshlrev_b32 v26, 16, v9
    v_and_b32 v27, 0xffff0000, v9
    v_lshlrev_b32 v28, 16, v10
    v_and_b32 v29, 0xffff0000, v10
    v_lshlrev_b32 v30, 16, v11
    v_and_b32 v31, 0xffff0000, v11
    v_mul_f32 v13, 0x3a800000, v13
    v_mul_f32 v14, 0x3a800000, v14
    v_fma_f32 v14, -v13, v13, v14
    v_max_f32 v14, 0, v14
    v_cvt_pk_bf16_f32 v15, v13, v13
    v_lshlrev_b32 v13, 16, v15
    v_cvt_pk_bf16_f32 v15, v14, v14
    v_lshlrev_b32 v14, 16, v15
    v_add_f32 v14, 0x3727c5ac, v14
    v_cvt_pk_bf16_f32 v15, v14, v14
    v_lshlrev_b32 v14, 16, v15
    v_sqrt_f32 v14, v14
    s_nop 0
    v_cvt_pk_bf16_f32 v15, v14, v14
    v_lshlrev_b32 v14, 16, v15
    v_rcp_f32 v14, v14
    s_nop 0
    v_sub_f32 v32, v16, v13
    v_sub_f32 v33, v17, v13
    v_cvt_pk_bf16_f32 v15, v32, v33
    v_lshlrev_b32 v32, 16, v15
    v_and_b32 v33, 0xffff0000, v15
    v_mul_f32 v32, v32, v14
    v_mul_f32 v33, v33, v14
    v_cvt_pk_bf16_f32 v15, v32, v33
    v_lshlrev_b32 v32, 16, v15
    v_and_b32 v33, 0xffff0000, v15
    v_sub_f32 v34, v18, v13
    v_sub_f32 v35, v19, v13
    v_cvt_pk_bf16_f32 v15, v34, v35
    v_lshlrev_b32 v34, 16, v15
    v_and_b32 v35, 0xffff0000, v15
    v_mul_f32 v34, v34, v14
    v_mul_f32 v35, v35, v14
    v_cvt_pk_bf16_f32 v15, v34, v35
    v_lshlrev_b32 v34, 16, v15
    v_and_b32 v35, 0xffff0000, v15
    v_sub_f32 v36, v20, v13
    v_sub_f32 v37, v21, v13
    v_cvt_pk_bf16_f32 v15, v36, v37
    v_lshlrev_b32 v36, 16, v15
    v_and_b32 v37, 0xffff0000, v15
    v_mul_f32 v36, v36, v14
    v_mul_f32 v37, v37, v14
    v_cvt_pk_bf16_f32 v15, v36, v37
    v_lshlrev_b32 v36, 16, v15
    v_and_b32 v37, 0xffff0000, v15
    v_sub_f32 v38, v22, v13
    v_sub_f32 v39, v23, v13
    v_cvt_pk_bf16_f32 v15, v38, v39
    v_lshlrev_b32 v38, 16, v15
    v_and_b32 v39, 0xffff0000, v15
    v_mul_f32 v38, v38, v14
    v_mul_f32 v39, v39, v14
    v_cvt_pk_bf16_f32 v15, v38, v39
    v_lshlrev_b32 v38, 16, v15
    v_and_b32 v39, 0xffff0000, v15
    v_sub_f32 v40, v24, v13
    v_sub_f32 v41, v25, v13
    v_cvt_pk_bf16_f32 v15, v40, v41
    v_lshlrev_b32 v40, 16, v15
    v_and_b32 v41, 0xffff0000, v15
    v_mul_f32 v40, v40, v14
    v_mul_f32 v41, v41, v14
    v_cvt_pk_bf16_f32 v15, v40, v41
    v_lshlrev_b32 v40, 16, v15
    v_and_b32 v41, 0xffff0000, v15
    v_sub_f32 v42, v26, v13
    v_sub_f32 v43, v27, v13
    v_cvt_pk_bf16_f32 v15, v42, v43
    v_lshlrev_b32 v42, 16, v15
    v_and_b32 v43, 0xffff0000, v15
    v_mul_f32 v42, v42, v14
    v_mul_f32 v43, v43, v14
    v_cvt_pk_bf16_f32 v15, v42, v43
    v_lshlrev_b32 v42, 16, v15
    v_and_b32 v43, 0xffff0000, v15
    v_sub_f32 v44, v28, v13
    v_sub_f32 v45, v29, v13
    v_cvt_pk_bf16_f32 v15, v44, v45
    v_lshlrev_b32 v44, 16, v15
    v_and_b32 v45, 0xffff0000, v15
    v_mul_f32 v44, v44, v14
    v_mul_f32 v45, v45, v14
    v_cvt_pk_bf16_f32 v15, v44, v45
    v_lshlrev_b32 v44, 16, v15
    v_and_b32 v45, 0xffff0000, v15
    v_sub_f32 v46, v30, v13
    v_sub_f32 v47, v31, v13
    v_cvt_pk_bf16_f32 v15, v46, v47
    v_lshlrev_b32 v46, 16, v15
    v_and_b32 v47, 0xffff0000, v15
    v_mul_f32 v46, v46, v14
    v_mul_f32 v47, v47, v14
    v_cvt_pk_bf16_f32 v15, v46, v47
    v_lshlrev_b32 v46, 16, v15
    v_and_b32 v47, 0xffff0000, v15
    s_waitcnt lgkmcnt(0)
    s_mov_b32 s26, -1
    s_cmp_eq_u32 s20, s32
    s_cselect_b32 s26, 0, s26
    s_cmp_eq_u32 s20, s33
    s_cselect_b32 s26, 1, s26
    s_cmp_eq_u32 s20, s34
    s_cselect_b32 s26, 2, s26
    s_cmp_eq_u32 s20, s35
    s_cselect_b32 s26, 3, s26
    s_cmp_eq_u32 s20, s36
    s_cselect_b32 s26, 4, s26
    s_cmp_eq_u32 s20, s37
    s_cselect_b32 s26, 5, s26
    s_cmp_eq_u32 s20, s38
    s_cselect_b32 s26, 6, s26
    s_cmp_eq_u32 s20, s39
    s_cselect_b32 s26, 7, s26
    s_cmp_eq_u32 s26, -1
    s_cbranch_scc1 L_nosel_k5b_kernel
    s_mov_b32 s27, s40
    s_cmp_eq_u32 s26, 1
    s_cselect_b32 s27, s41, s27
    s_cmp_eq_u32 s26, 2
    s_cselect_b32 s27, s42, s27
    s_cmp_eq_u32 s26, 3
    s_cselect_b32 s27, s43, s27
    s_cmp_eq_u32 s26, 4
    s_cselect_b32 s27, s44, s27
    s_cmp_eq_u32 s26, 5
    s_cselect_b32 s27, s45, s27
    s_cmp_eq_u32 s26, 6
    s_cselect_b32 s27, s46, s27
    s_cmp_eq_u32 s26, 7
    s_cselect_b32 s27, s47, s27
    v_lshlrev_b32 v64, 5, v2
    s_lshl_b32 s28, s26, 12
    s_add_u32 s28, s28, 27262976
    v_mov_b32 v48, 0
    v_mov_b32 v49, 0
    v_mov_b32 v50, 0
    v_mov_b32 v51, 0
    v_mov_b32 v52, 0
    v_mov_b32 v53, 0
    v_mov_b32 v54, 0
    v_mov_b32 v55, 0
    v_mov_b32 v56, 0
    v_mov_b32 v57, 0
    v_mov_b32 v58, 0
    v_mov_b32 v59, 0
    v_mov_b32 v60, 0
    v_mov_b32 v61, 0
    v_mov_b32 v62, 0
    v_mov_b32 v63, 0
    buffer_load_dwordx4 v[68:71], v64, s[16:19], s28 offen
    buffer_load_dwordx4 v[72:75], v64, s[16:19], s28 offen offset:16
    buffer_load_dwordx4 v[76:79], v64, s[16:19], s28 offen offset:2048
    buffer_load_dwordx4 v[80:83], v64, s[16:19], s28 offen offset:2064
    s_add_u32 s28, s28, 32768
    s_waitcnt vmcnt(0)
    v_add_f32 v48, v48, v68
    v_add_f32 v49, v49, v69
    v_add_f32 v50, v50, v70
    v_add_f32 v51, v51, v71
    v_add_f32 v52, v52, v72
    v_add_f32 v53, v53, v73
    v_add_f32 v54, v54, v74
    v_add_f32 v55, v55, v75
    v_add_f32 v56, v56, v76
    v_add_f32 v57, v57, v77
    v_add_f32 v58, v58, v78
    v_add_f32 v59, v59, v79
    v_add_f32 v60, v60, v80
    v_add_f32 v61, v61, v81
    v_add_f32 v62, v62, v82
    v_add_f32 v63, v63, v83
    buffer_load_dwordx4 v[68:71], v64, s[16:19], s28 offen
    buffer_load_dwordx4 v[72:75], v64, s[16:19], s28 offen offset:16
    buffer_load_dwordx4 v[76:79], v64, s[16:19], s28 offen offset:2048
    buffer_load_dwordx4 v[80:83], v64, s[16:19], s28 offen offset:2064
    s_add_u32 s28, s28, 32768
    s_waitcnt vmcnt(0)
    v_add_f32 v48, v48, v68
    v_add_f32 v49, v49, v69
    v_add_f32 v50, v50, v70
    v_add_f32 v51, v51, v71
    v_add_f32 v52, v52, v72
    v_add_f32 v53, v53, v73
    v_add_f32 v54, v54, v74
    v_add_f32 v55, v55, v75
    v_add_f32 v56, v56, v76
    v_add_f32 v57, v57, v77
    v_add_f32 v58, v58, v78
    v_add_f32 v59, v59, v79
    v_add_f32 v60, v60, v80
    v_add_f32 v61, v61, v81
    v_add_f32 v62, v62, v82
    v_add_f32 v63, v63, v83
    buffer_load_dwordx4 v[68:71], v64, s[16:19], s28 offen
    buffer_load_dwordx4 v[72:75], v64, s[16:19], s28 offen offset:16
    buffer_load_dwordx4 v[76:79], v64, s[16:19], s28 offen offset:2048
    buffer_load_dwordx4 v[80:83], v64, s[16:19], s28 offen offset:2064
    s_add_u32 s28, s28, 32768
    s_waitcnt vmcnt(0)
    v_add_f32 v48, v48, v68
    v_add_f32 v49, v49, v69
    v_add_f32 v50, v50, v70
    v_add_f32 v51, v51, v71
    v_add_f32 v52, v52, v72
    v_add_f32 v53, v53, v73
    v_add_f32 v54, v54, v74
    v_add_f32 v55, v55, v75
    v_add_f32 v56, v56, v76
    v_add_f32 v57, v57, v77
    v_add_f32 v58, v58, v78
    v_add_f32 v59, v59, v79
    v_add_f32 v60, v60, v80
    v_add_f32 v61, v61, v81
    v_add_f32 v62, v62, v82
    v_add_f32 v63, v63, v83
    buffer_load_dwordx4 v[68:71], v64, s[16:19], s28 offen
    buffer_load_dwordx4 v[72:75], v64, s[16:19], s28 offen offset:16
    buffer_load_dwordx4 v[76:79], v64, s[16:19], s28 offen offset:2048
    buffer_load_dwordx4 v[80:83], v64, s[16:19], s28 offen offset:2064
    s_add_u32 s28, s28, 32768
    s_waitcnt vmcnt(0)
    v_add_f32 v48, v48, v68
    v_add_f32 v49, v49, v69
    v_add_f32 v50, v50, v70
    v_add_f32 v51, v51, v71
    v_add_f32 v52, v52, v72
    v_add_f32 v53, v53, v73
    v_add_f32 v54, v54, v74
    v_add_f32 v55, v55, v75
    v_add_f32 v56, v56, v76
    v_add_f32 v57, v57, v77
    v_add_f32 v58, v58, v78
    v_add_f32 v59, v59, v79
    v_add_f32 v60, v60, v80
    v_add_f32 v61, v61, v81
    v_add_f32 v62, v62, v82
    v_add_f32 v63, v63, v83
    buffer_load_dwordx4 v[68:71], v64, s[16:19], s28 offen
    buffer_load_dwordx4 v[72:75], v64, s[16:19], s28 offen offset:16
    buffer_load_dwordx4 v[76:79], v64, s[16:19], s28 offen offset:2048
    buffer_load_dwordx4 v[80:83], v64, s[16:19], s28 offen offset:2064
    s_add_u32 s28, s28, 32768
    s_waitcnt vmcnt(0)
    v_add_f32 v48, v48, v68
    v_add_f32 v49, v49, v69
    v_add_f32 v50, v50, v70
    v_add_f32 v51, v51, v71
    v_add_f32 v52, v52, v72
    v_add_f32 v53, v53, v73
    v_add_f32 v54, v54, v74
    v_add_f32 v55, v55, v75
    v_add_f32 v56, v56, v76
    v_add_f32 v57, v57, v77
    v_add_f32 v58, v58, v78
    v_add_f32 v59, v59, v79
    v_add_f32 v60, v60, v80
    v_add_f32 v61, v61, v81
    v_add_f32 v62, v62, v82
    v_add_f32 v63, v63, v83
    buffer_load_dwordx4 v[68:71], v64, s[16:19], s28 offen
    buffer_load_dwordx4 v[72:75], v64, s[16:19], s28 offen offset:16
    buffer_load_dwordx4 v[76:79], v64, s[16:19], s28 offen offset:2048
    buffer_load_dwordx4 v[80:83], v64, s[16:19], s28 offen offset:2064
    s_add_u32 s28, s28, 32768
    s_waitcnt vmcnt(0)
    v_add_f32 v48, v48, v68
    v_add_f32 v49, v49, v69
    v_add_f32 v50, v50, v70
    v_add_f32 v51, v51, v71
    v_add_f32 v52, v52, v72
    v_add_f32 v53, v53, v73
    v_add_f32 v54, v54, v74
    v_add_f32 v55, v55, v75
    v_add_f32 v56, v56, v76
    v_add_f32 v57, v57, v77
    v_add_f32 v58, v58, v78
    v_add_f32 v59, v59, v79
    v_add_f32 v60, v60, v80
    v_add_f32 v61, v61, v81
    v_add_f32 v62, v62, v82
    v_add_f32 v63, v63, v83
    buffer_load_dwordx4 v[68:71], v64, s[16:19], s28 offen
    buffer_load_dwordx4 v[72:75], v64, s[16:19], s28 offen offset:16
    buffer_load_dwordx4 v[76:79], v64, s[16:19], s28 offen offset:2048
    buffer_load_dwordx4 v[80:83], v64, s[16:19], s28 offen offset:2064
    s_add_u32 s28, s28, 32768
    s_waitcnt vmcnt(0)
    v_add_f32 v48, v48, v68
    v_add_f32 v49, v49, v69
    v_add_f32 v50, v50, v70
    v_add_f32 v51, v51, v71
    v_add_f32 v52, v52, v72
    v_add_f32 v53, v53, v73
    v_add_f32 v54, v54, v74
    v_add_f32 v55, v55, v75
    v_add_f32 v56, v56, v76
    v_add_f32 v57, v57, v77
    v_add_f32 v58, v58, v78
    v_add_f32 v59, v59, v79
    v_add_f32 v60, v60, v80
    v_add_f32 v61, v61, v81
    v_add_f32 v62, v62, v82
    v_add_f32 v63, v63, v83
    buffer_load_dwordx4 v[68:71], v64, s[16:19], s28 offen
    buffer_load_dwordx4 v[72:75], v64, s[16:19], s28 offen offset:16
    buffer_load_dwordx4 v[76:79], v64, s[16:19], s28 offen offset:2048
    buffer_load_dwordx4 v[80:83], v64, s[16:19], s28 offen offset:2064
    s_add_u32 s28, s28, 32768
    s_waitcnt vmcnt(0)
    v_add_f32 v48, v48, v68
    v_add_f32 v49, v49, v69
    v_add_f32 v50, v50, v70
    v_add_f32 v51, v51, v71
    v_add_f32 v52, v52, v72
    v_add_f32 v53, v53, v73
    v_add_f32 v54, v54, v74
    v_add_f32 v55, v55, v75
    v_add_f32 v56, v56, v76
    v_add_f32 v57, v57, v77
    v_add_f32 v58, v58, v78
    v_add_f32 v59, v59, v79
    v_add_f32 v60, v60, v80
    v_add_f32 v61, v61, v81
    v_add_f32 v62, v62, v82
    v_add_f32 v63, v63, v83
    buffer_load_dwordx4 v[68:71], v64, s[16:19], s28 offen
    buffer_load_dwordx4 v[72:75], v64, s[16:19], s28 offen offset:16
    buffer_load_dwordx4 v[76:79], v64, s[16:19], s28 offen offset:2048
    buffer_load_dwordx4 v[80:83], v64, s[16:19], s28 offen offset:2064
    s_add_u32 s28, s28, 32768
    s_waitcnt vmcnt(0)
    v_add_f32 v48, v48, v68
    v_add_f32 v49, v49, v69
    v_add_f32 v50, v50, v70
    v_add_f32 v51, v51, v71
    v_add_f32 v52, v52, v72
    v_add_f32 v53, v53, v73
    v_add_f32 v54, v54, v74
    v_add_f32 v55, v55, v75
    v_add_f32 v56, v56, v76
    v_add_f32 v57, v57, v77
    v_add_f32 v58, v58, v78
    v_add_f32 v59, v59, v79
    v_add_f32 v60, v60, v80
    v_add_f32 v61, v61, v81
    v_add_f32 v62, v62, v82
    v_add_f32 v63, v63, v83
    buffer_load_dwordx4 v[68:71], v64, s[16:19], s28 offen
    buffer_load_dwordx4 v[72:75], v64, s[16:19], s28 offen offset:16
    buffer_load_dwordx4 v[76:79], v64, s[16:19], s28 offen offset:2048
    buffer_load_dwordx4 v[80:83], v64, s[16:19], s28 offen offset:2064
    s_add_u32 s28, s28, 32768
    s_waitcnt vmcnt(0)
    v_add_f32 v48, v48, v68
    v_add_f32 v49, v49, v69
    v_add_f32 v50, v50, v70
    v_add_f32 v51, v51, v71
    v_add_f32 v52, v52, v72
    v_add_f32 v53, v53, v73
    v_add_f32 v54, v54, v74
    v_add_f32 v55, v55, v75
    v_add_f32 v56, v56, v76
    v_add_f32 v57, v57, v77
    v_add_f32 v58, v58, v78
    v_add_f32 v59, v59, v79
    v_add_f32 v60, v60, v80
    v_add_f32 v61, v61, v81
    v_add_f32 v62, v62, v82
    v_add_f32 v63, v63, v83
    buffer_load_dwordx4 v[68:71], v64, s[16:19], s28 offen
    buffer_load_dwordx4 v[72:75], v64, s[16:19], s28 offen offset:16
    buffer_load_dwordx4 v[76:79], v64, s[16:19], s28 offen offset:2048
    buffer_load_dwordx4 v[80:83], v64, s[16:19], s28 offen offset:2064
    s_add_u32 s28, s28, 32768
    s_waitcnt vmcnt(0)
    v_add_f32 v48, v48, v68
    v_add_f32 v49, v49, v69
    v_add_f32 v50, v50, v70
    v_add_f32 v51, v51, v71
    v_add_f32 v52, v52, v72
    v_add_f32 v53, v53, v73
    v_add_f32 v54, v54, v74
    v_add_f32 v55, v55, v75
    v_add_f32 v56, v56, v76
    v_add_f32 v57, v57, v77
    v_add_f32 v58, v58, v78
    v_add_f32 v59, v59, v79
    v_add_f32 v60, v60, v80
    v_add_f32 v61, v61, v81
    v_add_f32 v62, v62, v82
    v_add_f32 v63, v63, v83
    buffer_load_dwordx4 v[68:71], v64, s[16:19], s28 offen
    buffer_load_dwordx4 v[72:75], v64, s[16:19], s28 offen offset:16
    buffer_load_dwordx4 v[76:79], v64, s[16:19], s28 offen offset:2048
    buffer_load_dwordx4 v[80:83], v64, s[16:19], s28 offen offset:2064
    s_add_u32 s28, s28, 32768
    s_waitcnt vmcnt(0)
    v_add_f32 v48, v48, v68
    v_add_f32 v49, v49, v69
    v_add_f32 v50, v50, v70
    v_add_f32 v51, v51, v71
    v_add_f32 v52, v52, v72
    v_add_f32 v53, v53, v73
    v_add_f32 v54, v54, v74
    v_add_f32 v55, v55, v75
    v_add_f32 v56, v56, v76
    v_add_f32 v57, v57, v77
    v_add_f32 v58, v58, v78
    v_add_f32 v59, v59, v79
    v_add_f32 v60, v60, v80
    v_add_f32 v61, v61, v81
    v_add_f32 v62, v62, v82
    v_add_f32 v63, v63, v83
    buffer_load_dwordx4 v[68:71], v64, s[16:19], s28 offen
    buffer_load_dwordx4 v[72:75], v64, s[16:19], s28 offen offset:16
    buffer_load_dwordx4 v[76:79], v64, s[16:19], s28 offen offset:2048
    buffer_load_dwordx4 v[80:83], v64, s[16:19], s28 offen offset:2064
    s_add_u32 s28, s28, 32768
    s_waitcnt vmcnt(0)
    v_add_f32 v48, v48, v68
    v_add_f32 v49, v49, v69
    v_add_f32 v50, v50, v70
    v_add_f32 v51, v51, v71
    v_add_f32 v52, v52, v72
    v_add_f32 v53, v53, v73
    v_add_f32 v54, v54, v74
    v_add_f32 v55, v55, v75
    v_add_f32 v56, v56, v76
    v_add_f32 v57, v57, v77
    v_add_f32 v58, v58, v78
    v_add_f32 v59, v59, v79
    v_add_f32 v60, v60, v80
    v_add_f32 v61, v61, v81
    v_add_f32 v62, v62, v82
    v_add_f32 v63, v63, v83
    buffer_load_dwordx4 v[68:71], v64, s[16:19], s28 offen
    buffer_load_dwordx4 v[72:75], v64, s[16:19], s28 offen offset:16
    buffer_load_dwordx4 v[76:79], v64, s[16:19], s28 offen offset:2048
    buffer_load_dwordx4 v[80:83], v64, s[16:19], s28 offen offset:2064
    s_add_u32 s28, s28, 32768
    s_waitcnt vmcnt(0)
    v_add_f32 v48, v48, v68
    v_add_f32 v49, v49, v69
    v_add_f32 v50, v50, v70
    v_add_f32 v51, v51, v71
    v_add_f32 v52, v52, v72
    v_add_f32 v53, v53, v73
    v_add_f32 v54, v54, v74
    v_add_f32 v55, v55, v75
    v_add_f32 v56, v56, v76
    v_add_f32 v57, v57, v77
    v_add_f32 v58, v58, v78
    v_add_f32 v59, v59, v79
    v_add_f32 v60, v60, v80
    v_add_f32 v61, v61, v81
    v_add_f32 v62, v62, v82
    v_add_f32 v63, v63, v83
    v_cvt_pk_bf16_f32 v15, v48, v49
    v_lshlrev_b32 v48, 16, v15
    v_and_b32 v49, 0xffff0000, v15
    v_mul_f32 v48, s27, v48
    v_mul_f32 v49, s27, v49
    v_cvt_pk_bf16_f32 v15, v48, v49
    v_lshlrev_b32 v48, 16, v15
    v_and_b32 v49, 0xffff0000, v15
    v_add_f32 v32, v32, v48
    v_add_f32 v33, v33, v49
    v_cvt_pk_bf16_f32 v15, v32, v33
    v_lshlrev_b32 v32, 16, v15
    v_and_b32 v33, 0xffff0000, v15
    v_cvt_pk_bf16_f32 v15, v50, v51
    v_lshlrev_b32 v50, 16, v15
    v_and_b32 v51, 0xffff0000, v15
    v_mul_f32 v50, s27, v50
    v_mul_f32 v51, s27, v51
    v_cvt_pk_bf16_f32 v15, v50, v51
    v_lshlrev_b32 v50, 16, v15
    v_and_b32 v51, 0xffff0000, v15
    v_add_f32 v34, v34, v50
    v_add_f32 v35, v35, v51
    v_cvt_pk_bf16_f32 v15, v34, v35
    v_lshlrev_b32 v34, 16, v15
    v_and_b32 v35, 0xffff0000, v15
    v_cvt_pk_bf16_f32 v15, v52, v53
    v_lshlrev_b32 v52, 16, v15
    v_and_b32 v53, 0xffff0000, v15
    v_mul_f32 v52, s27, v52
    v_mul_f32 v53, s27, v53
    v_cvt_pk_bf16_f32 v15, v52, v53
    v_lshlrev_b32 v52, 16, v15
    v_and_b32 v53, 0xffff0000, v15
    v_add_f32 v36, v36, v52
    v_add_f32 v37, v37, v53
    v_cvt_pk_bf16_f32 v15, v36, v37
    v_lshlrev_b32 v36, 16, v15
    v_and_b32 v37, 0xffff0000, v15
    v_cvt_pk_bf16_f32 v15, v54, v55
    v_lshlrev_b32 v54, 16, v15
    v_and_b32 v55, 0xffff0000, v15
    v_mul_f32 v54, s27, v54
    v_mul_f32 v55, s27, v55
    v_cvt_pk_bf16_f32 v15, v54, v55
    v_lshlrev_b32 v54, 16, v15
    v_and_b32 v55, 0xffff0000, v15
    v_add_f32 v38, v38, v54
    v_add_f32 v39, v39, v55
    v_cvt_pk_bf16_f32 v15, v38, v39
    v_lshlrev_b32 v38, 16, v15
    v_and_b32 v39, 0xffff0000, v15
    v_cvt_pk_bf16_f32 v15, v56, v57
    v_lshlrev_b32 v56, 16, v15
    v_and_b32 v57, 0xffff0000, v15
    v_mul_f32 v56, s27, v56
    v_mul_f32 v57, s27, v57
    v_cvt_pk_bf16_f32 v15, v56, v57
    v_lshlrev_b32 v56, 16, v15
    v_and_b32 v57, 0xffff0000, v15
    v_add_f32 v40, v40, v56
    v_add_f32 v41, v41, v57
    v_cvt_pk_bf16_f32 v15, v40, v41
    v_lshlrev_b32 v40, 16, v15
    v_and_b32 v41, 0xffff0000, v15
    v_cvt_pk_bf16_f32 v15, v58, v59
    v_lshlrev_b32 v58, 16, v15
    v_and_b32 v59, 0xffff0000, v15
    v_mul_f32 v58, s27, v58
    v_mul_f32 v59, s27, v59
    v_cvt_pk_bf16_f32 v15, v58, v59
    v_lshlrev_b32 v58, 16, v15
    v_and_b32 v59, 0xffff0000, v15
    v_add_f32 v42, v42, v58
    v_add_f32 v43, v43, v59
    v_cvt_pk_bf16_f32 v15, v42, v43
    v_lshlrev_b32 v42, 16, v15
    v_and_b32 v43, 0xffff0000, v15
    v_cvt_pk_bf16_f32 v15, v60, v61
    v_lshlrev_b32 v60, 16, v15
    v_and_b32 v61, 0xffff0000, v15
    v_mul_f32 v60, s27, v60
    v_mul_f32 v61, s27, v61
    v_cvt_pk_bf16_f32 v15, v60, v61
    v_lshlrev_b32 v60, 16, v15
    v_and_b32 v61, 0xffff0000, v15
    v_add_f32 v44, v44, v60
    v_add_f32 v45, v45, v61
    v_cvt_pk_bf16_f32 v15, v44, v45
    v_lshlrev_b32 v44, 16, v15
    v_and_b32 v45, 0xffff0000, v15
    v_cvt_pk_bf16_f32 v15, v62, v63
    v_lshlrev_b32 v62, 16, v15
    v_and_b32 v63, 0xffff0000, v15
    v_mul_f32 v62, s27, v62
    v_mul_f32 v63, s27, v63
    v_cvt_pk_bf16_f32 v15, v62, v63
    v_lshlrev_b32 v62, 16, v15
    v_and_b32 v63, 0xffff0000, v15
    v_add_f32 v46, v46, v62
    v_add_f32 v47, v47, v63
    v_cvt_pk_bf16_f32 v15, v46, v47
    v_lshlrev_b32 v46, 16, v15
    v_and_b32 v47, 0xffff0000, v15
L_nosel_k5b_kernel:
    v_add_f32 v16, v16, v32
    v_add_f32 v17, v17, v33
    v_cvt_pk_bf16_f32 v15, v16, v17
    v_lshlrev_b32 v16, 16, v15
    v_and_b32 v17, 0xffff0000, v15
    v_add_f32 v18, v18, v34
    v_add_f32 v19, v19, v35
    v_cvt_pk_bf16_f32 v15, v18, v19
    v_lshlrev_b32 v18, 16, v15
    v_and_b32 v19, 0xffff0000, v15
    v_add_f32 v20, v20, v36
    v_add_f32 v21, v21, v37
    v_cvt_pk_bf16_f32 v15, v20, v21
    v_lshlrev_b32 v20, 16, v15
    v_and_b32 v21, 0xffff0000, v15
    v_add_f32 v22, v22, v38
    v_add_f32 v23, v23, v39
    v_cvt_pk_bf16_f32 v15, v22, v23
    v_lshlrev_b32 v22, 16, v15
    v_and_b32 v23, 0xffff0000, v15
    v_add_f32 v24, v24, v40
    v_add_f32 v25, v25, v41
    v_cvt_pk_bf16_f32 v15, v24, v25
    v_lshlrev_b32 v24, 16, v15
    v_and_b32 v25, 0xffff0000, v15
    v_add_f32 v26, v26, v42
    v_add_f32 v27, v27, v43
    v_cvt_pk_bf16_f32 v15, v26, v27
    v_lshlrev_b32 v26, 16, v15
    v_and_b32 v27, 0xffff0000, v15
    v_add_f32 v28, v28, v44
    v_add_f32 v29, v29, v45
    v_cvt_pk_bf16_f32 v15, v28, v29
    v_lshlrev_b32 v28, 16, v15
    v_and_b32 v29, 0xffff0000, v15
    v_add_f32 v30, v30, v46
    v_add_f32 v31, v31, v47
    v_cvt_pk_bf16_f32 v15, v30, v31
    v_lshlrev_b32 v30, 16, v15
    v_and_b32 v31, 0xffff0000, v15
    v_cvt_pk_bf16_f32 v48, v16, v17
    v_cvt_pk_bf16_f32 v49, v18, v19
    v_cvt_pk_bf16_f32 v50, v20, v21
    v_cvt_pk_bf16_f32 v51, v22, v23
    v_cvt_pk_bf16_f32 v52, v24, v25
    v_cvt_pk_bf16_f32 v53, v26, v27
    v_cvt_pk_bf16_f32 v54, v28, v29
    v_cvt_pk_bf16_f32 v55, v30, v31
    s_mov_b32 s8, s6
    s_mov_b32 s9, s7
    s_mov_b32 s10, 4194304
    s_mov_b32 s11, 0x00020000
    buffer_store_dwordx4 v[48:51], v3, s[8:11], s21 offen
    buffer_store_dwordx4 v[52:55], v3, s[8:11], s21 offen offset:1024
    s_endpgm
L_end_k5b_kernel:
    s_endpgm
.section .rodata,"a"
.p2align 6
.amdhsa_kernel ln0_kernel
  .amdhsa_next_free_vgpr 48
  .amdhsa_next_free_sgpr 100
  .amdhsa_accum_offset 48
  .amdhsa_group_segment_fixed_size 0
  .amdhsa_kernarg_size 88
  .amdhsa_user_sgpr_count 2
  .amdhsa_user_sgpr_kernarg_segment_ptr 1
  .amdhsa_system_sgpr_workgroup_id_x 1
.end_amdhsa_kernel
.section .rodata,"a"
.p2align 6
.amdhsa_kernel k1a_kernel
  .amdhsa_next_free_vgpr 256
  .amdhsa_next_free_sgpr 100
  .amdhsa_accum_offset 256
  .amdhsa_group_segment_fixed_size 0
  .amdhsa_kernarg_size 88
  .amdhsa_user_sgpr_count 2
  .amdhsa_user_sgpr_kernarg_segment_ptr 1
  .amdhsa_system_sgpr_workgroup_id_x 1
.end_amdhsa_kernel
.section .rodata,"a"
.p2align 6
.amdhsa_kernel kmida_kernel
  .amdhsa_next_free_vgpr 144
  .amdhsa_next_free_sgpr 100
  .amdhsa_accum_offset 144
  .amdhsa_group_segment_fixed_size 0
  .amdhsa_kernarg_size 88
  .amdhsa_user_sgpr_count 2
  .amdhsa_user_sgpr_kernarg_segment_ptr 1
  .amdhsa_system_sgpr_workgroup_id_x 1
.end_amdhsa_kernel
.section .rodata,"a"
.p2align 6
.amdhsa_kernel k2a_kernel
  .amdhsa_next_free_vgpr 176
  .amdhsa_next_free_sgpr 100
  .amdhsa_accum_offset 176
  .amdhsa_group_segment_fixed_size 0
  .amdhsa_kernarg_size 88
  .amdhsa_user_sgpr_count 2
  .amdhsa_user_sgpr_kernarg_segment_ptr 1
  .amdhsa_system_sgpr_workgroup_id_x 1
.end_amdhsa_kernel
.section .rodata,"a"
.p2align 6
.amdhsa_kernel k3a_kernel
  .amdhsa_next_free_vgpr 192
  .amdhsa_next_free_sgpr 100
  .amdhsa_accum_offset 192
  .amdhsa_group_segment_fixed_size 0
  .amdhsa_kernarg_size 88
  .amdhsa_user_sgpr_count 2
  .amdhsa_user_sgpr_kernarg_segment_ptr 1
  .amdhsa_system_sgpr_workgroup_id_x 1
.end_amdhsa_kernel
.section .rodata,"a"
.p2align 6
.amdhsa_kernel k4a_kernel
  .amdhsa_next_free_vgpr 168
  .amdhsa_next_free_sgpr 100
  .amdhsa_accum_offset 168
  .amdhsa_group_segment_fixed_size 0
  .amdhsa_kernarg_size 88
  .amdhsa_user_sgpr_count 2
  .amdhsa_user_sgpr_kernarg_segment_ptr 1
  .amdhsa_system_sgpr_workgroup_id_x 1
.end_amdhsa_kernel
.section .rodata,"a"
.p2align 6
.amdhsa_kernel k5a_kernel
  .amdhsa_next_free_vgpr 88
  .amdhsa_next_free_sgpr 100
  .amdhsa_accum_offset 88
  .amdhsa_group_segment_fixed_size 0
  .amdhsa_kernarg_size 88
  .amdhsa_user_sgpr_count 2
  .amdhsa_user_sgpr_kernarg_segment_ptr 1
  .amdhsa_system_sgpr_workgroup_id_x 1
.end_amdhsa_kernel
.section .rodata,"a"
.p2align 6
.amdhsa_kernel k1b_kernel
  .amdhsa_next_free_vgpr 256
  .amdhsa_next_free_sgpr 100
  .amdhsa_accum_offset 256
  .amdhsa_group_segment_fixed_size 0
  .amdhsa_kernarg_size 88
  .amdhsa_user_sgpr_count 2
  .amdhsa_user_sgpr_kernarg_segment_ptr 1
  .amdhsa_system_sgpr_workgroup_id_x 1
.end_amdhsa_kernel
.section .rodata,"a"
.p2align 6
.amdhsa_kernel kmidb_kernel
  .amdhsa_next_free_vgpr 144
  .amdhsa_next_free_sgpr 100
  .amdhsa_accum_offset 144
  .amdhsa_group_segment_fixed_size 0
  .amdhsa_kernarg_size 88
  .amdhsa_user_sgpr_count 2
  .amdhsa_user_sgpr_kernarg_segment_ptr 1
  .amdhsa_system_sgpr_workgroup_id_x 1
.end_amdhsa_kernel
.section .rodata,"a"
.p2align 6
.amdhsa_kernel k2b_kernel
  .amdhsa_next_free_vgpr 176
  .amdhsa_next_free_sgpr 100
  .amdhsa_accum_offset 176
  .amdhsa_group_segment_fixed_size 0
  .amdhsa_kernarg_size 88
  .amdhsa_user_sgpr_count 2
  .amdhsa_user_sgpr_kernarg_segment_ptr 1
  .amdhsa_system_sgpr_workgroup_id_x 1
.end_amdhsa_kernel
.section .rodata,"a"
.p2align 6
.amdhsa_kernel k3b_kernel
  .amdhsa_next_free_vgpr 192
  .amdhsa_next_free_sgpr 100
  .amdhsa_accum_offset 192
  .amdhsa_group_segment_fixed_size 0
  .amdhsa_kernarg_size 88
  .amdhsa_user_sgpr_count 2
  .amdhsa_user_sgpr_kernarg_segment_ptr 1
  .amdhsa_system_sgpr_workgroup_id_x 1
.end_amdhsa_kernel
.section .rodata,"a"
.p2align 6
.amdhsa_kernel k4b_kernel
  .amdhsa_next_free_vgpr 168
  .amdhsa_next_free_sgpr 100
  .amdhsa_accum_offset 168
  .amdhsa_group_segment_fixed_size 0
  .amdhsa_kernarg_size 88
  .amdhsa_user_sgpr_count 2
  .amdhsa_user_sgpr_kernarg_segment_ptr 1
  .amdhsa_system_sgpr_workgroup_id_x 1
.end_amdhsa_kernel
.section .rodata,"a"
.p2align 6
.amdhsa_kernel k5b_kernel
  .amdhsa_next_free_vgpr 88
  .amdhsa_next_free_sgpr 100
  .amdhsa_accum_offset 88
  .amdhsa_group_segment_fixed_size 0
  .amdhsa_kernarg_size 88
  .amdhsa_user_sgpr_count 2
  .amdhsa_user_sgpr_kernarg_segment_ptr 1
  .amdhsa_system_sgpr_workgroup_id_x 1
.end_amdhsa_kernel
```
